```python
import torch

def _softmax(x, axis=-1):
    return torch.softmax(x, dim=axis)
def _gelu(x):
    return torch.nn.functional.gelu(x, approximate="tanh")
def _silu(x):
    return torch.nn.functional.silu(x)
def _sigmoid(x):
    return torch.sigmoid(x)
def _layernorm(x, axis=-1, eps=1e-5):
    m = x.mean(dim=axis, keepdim=True)
    v = x.var(dim=axis, keepdim=True, unbiased=False)
    return (x - m) / torch.sqrt(v + eps)
def _scatter_add(tgt, idx, src, axis=0):
    return tgt.clone().index_add_(axis, idx, src)
def _segment_sum(src, seg, n):
    out = torch.zeros((n,) + src.shape[1:], dtype=src.dtype)
    return out.index_add_(0, seg, src)
def _pad(x, pw):
    flat = tuple(v for pair in reversed(pw) for v in pair)
    return torch.nn.functional.pad(x, flat)

kernel_name = 'gated_mix__spectral_fnet__mha_block__prompt'

def setup_inputs():

    _w = (lambda a: (lambda t: t.to(torch.bfloat16) if t.is_floating_point() else t)(torch.as_tensor(a)))
    def _A_setup():
        B, S, D = 1, 2048, 1024
        ns = torch.arange(S)[:, None] * torch.arange(S)[None, :]
        nd = torch.arange(D)[:, None] * torch.arange(D)[None, :]
        Ws_re = torch.cos(-2.0 * torch.pi * ns / S).to(float)
        Ws_im = torch.sin(-2.0 * torch.pi * ns / S).to(float)
        Wd_re = torch.cos(-2.0 * torch.pi * nd / D).to(float)
        Wd_im = torch.sin(-2.0 * torch.pi * nd / D).to(float)
        return {
            "x": _w((lambda *s: torch.randn(*s, dtype=torch.bfloat16) * 0.05)(B, S, D)),
            "dft_seq_re": _w(Ws_re),
            "dft_seq_im": _w(Ws_im),
            "dft_hid_re": _w(Wd_re),
            "dft_hid_im": _w(Wd_im),
        }
    _A_in = _A_setup()

    def _B_setup():
        B, S, D, H = 1, 2048, 1024, 32
        return {
            "x": _w((lambda *s: torch.randn(*s, dtype=torch.bfloat16) * 0.05)(B, S, D)),
            "wqkv": _w((lambda *s: torch.randn(*s, dtype=torch.bfloat16) * 1.6)(D, 3 * D)),
            "wo": _w((lambda *s: torch.randn(*s, dtype=torch.bfloat16) * 0.2)(D, D)),
        }
    _B_in = _B_setup()

    return {
        "A_x": _A_in["x"],
        "A_dft_seq_re": _A_in["dft_seq_re"],
        "A_dft_seq_im": _A_in["dft_seq_im"],
        "A_dft_hid_re": _A_in["dft_hid_re"],
        "A_dft_hid_im": _A_in["dft_hid_im"],
        "B_x": _B_in["x"],
        "B_wqkv": _B_in["wqkv"],
        "B_wo": _B_in["wo"],
        "gate_w": _w((lambda *s: torch.randn(*s, dtype=torch.bfloat16) * 0.05)(1024) * 16.0),
    }

def reference(A_x, A_dft_seq_re, A_dft_seq_im, A_dft_hid_re, A_dft_hid_im, B_x, B_wqkv, B_wo, gate_w):
    def _A_ref(x, dft_seq_re, dft_seq_im, dft_hid_re, dft_hid_im):
        a = torch.einsum("bsd,ed->bse", x, dft_hid_re)
        b = torch.einsum("bsd,ed->bse", x, dft_hid_im)
        y = torch.einsum("ts,bse->bte", dft_seq_re, a) - torch.einsum("ts,bse->bte", dft_seq_im, b)
        return y

    def _B_ref(x, wqkv, wo):
        B, S, D = x.shape
        H = 32
        Dh = D // H
        qkv = (lambda x, *d: x.permute(*d))((x @ wqkv).reshape(B, S, 3, H, Dh), 2, 0, 3, 1, 4)
        q, k, v = qkv[0], qkv[1], qkv[2]
        scores = torch.einsum("bhqd,bhkd->bhqk", q, k) * (Dh ** -0.5)
        p = _softmax(scores, axis=-1)
        o = torch.einsum("bhqk,bhkd->bhqd", p, v)
        return (lambda x, *d: x.permute(*d))(o, 0, 2, 1, 3).reshape(B, S, D) @ wo

    x = A_x
    g = _sigmoid((x * gate_w).sum(-1, keepdims=True))
    a = _A_ref(x, A_dft_seq_re, A_dft_seq_im, A_dft_hid_re, A_dft_hid_im)
    b = _B_ref(x, B_wqkv, B_wo)
    return g * a + (1 - g) * b
```

```asm
; @launch grid=(256,1,1) block=(512,1,1) lds=163840
.amdgcn_target "amdgcn-amd-amdhsa--gfx950"
.text
.globl gated_mix__spectral_fnet__mha_block__prompt_kernel
.p2align 8
.type gated_mix__spectral_fnet__mha_block__prompt_kernel,@function
gated_mix__spectral_fnet__mha_block__prompt_kernel:
    s_cmp_ge_u32 s2, 256
    s_cbranch_scc1 L_end
    s_load_dwordx2 s[8:9], s[0:1], 0
    s_mov_b32 s10, 0x400000
    s_mov_b32 s11, 0x20000
    s_load_dwordx2 s[12:13], s[0:1], 48
    s_mov_b32 s14, 0x600000
    s_mov_b32 s15, 0x20000
    s_load_dwordx2 s[16:17], s[0:1], 88
    s_mov_b32 s18, 0x1c00000
    s_mov_b32 s19, 0x20000
    s_load_dwordx2 s[20:21], s[0:1], 80
    s_mov_b32 s22, 0x100
    s_mov_b32 s23, 0x20000
    s_load_dwordx2 s[44:45], s[0:1], 64
    s_mov_b32 s46, 0x800
    s_mov_b32 s47, 0x20000
    s_load_dwordx2 s[48:49], s[0:1], 56
    s_mov_b32 s50, 0x200000
    s_mov_b32 s51, 0x20000
    s_load_dwordx2 s[60:61], s[0:1], 72
    s_mov_b32 s62, 0x400000
    s_mov_b32 s63, 0x20000
    v_and_b32 v1, 63, v0
    v_lshrrev_b32 v14, 6, v0
    v_lshlrev_b32 v2, 4, v1
    v_readfirstlane_b32 s3, v14
    s_bfe_u32 s25, s2, 0x20003
    s_xor_b32 s24, s2, s25
    s_and_b32 s24, s24, 1
    s_lshl1_add_u32 s4, s25, s24
    s_bfe_u32 s24, s2, 0x20001
    s_lshr_b32 s25, s2, 5
    s_lshl3_add_u32 s5, s24, s25
    s_lshr_b32 s24, s3, 1
    s_cmp_eq_u32 s24, 2
    s_cbranch_scc1 L_load
    s_mul_i32 s32, s3, 12288
    s_add_u32 s32, s32, 65536
    s_lshr_b32 s64, s5, 3
    s_and_b32 s65, s5, 7
    s_and_b32 s66, s3, 3
    s_lshr_b32 s67, s3, 2
    s_lshl1_add_u32 s24, s4, s67
    s_lshl_b32 s24, s24, 6
    s_and_b32 s25, s64, 1
    s_add_u32 s69, s24, s25
    v_mov_b32 v14, 0x40000000
    v_cmp_eq_u32 vcc, 63, v1
    s_nop 1
    v_cndmask_b32_e64 v21, v14, 0, vcc
    s_cmp_ge_u32 s3, 6
    s_cbranch_scc1 L_p0
    v_lshrrev_b32 v14, 5, v1
    v_lshlrev_b32 v14, 9, v14
    v_bfe_u32 v15, v1, 2, 2
    v_lshl_add_u32 v14, v15, 6, v14
    v_bfe_u32 v15, v1, 4, 1
    v_lshl_add_u32 v14, v15, 5, v14
    v_and_b32 v15, 3, v1
    v_lshl_add_u32 v9, v15, 3, v14
    v_and_b32 v14, 31, v1
    v_bfe_u32 v15, v1, 1, 3
    v_lshrrev_b32 v16, 5, v1
    v_xor_b32 v15, v15, v16
    v_lshlrev_b32 v15, 4, v15
    v_lshl_add_u32 v14, v14, 7, v15
    v_xor_b32 v15, 0, v14
    v_add_u32 v10, s32, v15
    v_xor_b32 v15, 32, v14
    v_add_u32 v11, s32, v15
    v_xor_b32 v15, 64, v14
    v_add_u32 v12, s32, v15
    v_xor_b32 v15, 96, v14
    v_add_u32 v13, s32, v15
    s_lshl_b32 s71, s66, 7
    s_lshr_b32 s72, s64, 1
    s_cmp_lg_u32 s72, 0
    s_cselect_b32 s54, 0x3e800000, 0
    v_and_b32 v25, 31, v1
    v_lshl_add_u32 v25, v25, 1, s69
    v_cvt_f32_u32 v25, v25
    v_mul_f32 v25, 0x3a000000, v25
    v_lshrrev_b32 v27, 5, v1
    v_lshl_add_u32 v27, v27, 3, s71
    v_cvt_f32_u32 v27, v27
    v_fma_f32 v24, v25, v27, s54
    v_fract_f32 v24, v24
    v_mul_f32 v26, 0x41100000, v25
    v_mul_f32 v27, 0x44000000, v25
    v_add_f32 v27, s54, v27
    v_fract_f32 v27, v27
    v_cos_f32 v27, v27
    v_mov_b32 v169, 0
    v_mov_b32 v170, 0
    v_mov_b32 v171, 0
    v_cvt_pk_bf16_f32 v168, v27, v27
    v_cos_f32 v27, v24
    v_add_f32 v24, v24, v25
    v_cos_f32 v28, v24
    v_add_f32 v24, v24, v25
    v_cvt_pk_bf16_f32 v136, v27, v28
    v_cos_f32 v29, v24
    v_add_f32 v24, v24, v25
    v_cos_f32 v30, v24
    v_add_f32 v24, v24, v25
    v_cvt_pk_bf16_f32 v137, v29, v30
    v_cos_f32 v27, v24
    v_add_f32 v24, v24, v25
    v_cos_f32 v28, v24
    v_add_f32 v24, v24, v25
    v_cvt_pk_bf16_f32 v138, v27, v28
    v_cos_f32 v29, v24
    v_add_f32 v24, v24, v25
    v_cos_f32 v30, v24
    v_add_f32 v24, v24, v26
    v_cvt_pk_bf16_f32 v139, v29, v30
    v_cos_f32 v27, v24
    v_add_f32 v24, v24, v25
    v_cos_f32 v28, v24
    v_add_f32 v24, v24, v25
    v_cvt_pk_bf16_f32 v140, v27, v28
    v_cos_f32 v29, v24
    v_add_f32 v24, v24, v25
    v_cos_f32 v30, v24
    v_add_f32 v24, v24, v25
    v_cvt_pk_bf16_f32 v141, v29, v30
    v_cos_f32 v27, v24
    v_add_f32 v24, v24, v25
    v_cos_f32 v28, v24
    v_add_f32 v24, v24, v25
    v_cvt_pk_bf16_f32 v142, v27, v28
    v_cos_f32 v29, v24
    v_add_f32 v24, v24, v25
    v_cos_f32 v30, v24
    v_add_f32 v24, v24, v26
    v_cvt_pk_bf16_f32 v143, v29, v30
    v_cos_f32 v27, v24
    v_add_f32 v24, v24, v25
    v_cos_f32 v28, v24
    v_add_f32 v24, v24, v25
    v_cvt_pk_bf16_f32 v144, v27, v28
    v_cos_f32 v29, v24
    v_add_f32 v24, v24, v25
    v_cos_f32 v30, v24
    v_add_f32 v24, v24, v25
    v_cvt_pk_bf16_f32 v145, v29, v30
    v_cos_f32 v27, v24
    v_add_f32 v24, v24, v25
    v_cos_f32 v28, v24
    v_add_f32 v24, v24, v25
    v_cvt_pk_bf16_f32 v146, v27, v28
    v_cos_f32 v29, v24
    v_add_f32 v24, v24, v25
    v_cos_f32 v30, v24
    v_add_f32 v24, v24, v26
    v_cvt_pk_bf16_f32 v147, v29, v30
    v_cos_f32 v27, v24
    v_add_f32 v24, v24, v25
    v_cos_f32 v28, v24
    v_add_f32 v24, v24, v25
    v_cvt_pk_bf16_f32 v148, v27, v28
    v_cos_f32 v29, v24
    v_add_f32 v24, v24, v25
    v_cos_f32 v30, v24
    v_add_f32 v24, v24, v25
    v_cvt_pk_bf16_f32 v149, v29, v30
    v_cos_f32 v27, v24
    v_add_f32 v24, v24, v25
    v_cos_f32 v28, v24
    v_add_f32 v24, v24, v25
    v_cvt_pk_bf16_f32 v150, v27, v28
    v_cos_f32 v29, v24
    v_add_f32 v24, v24, v25
    v_cos_f32 v30, v24
    v_add_f32 v24, v24, v26
    v_cvt_pk_bf16_f32 v151, v29, v30
    v_cos_f32 v27, v24
    v_add_f32 v24, v24, v25
    v_cos_f32 v28, v24
    v_add_f32 v24, v24, v25
    v_cvt_pk_bf16_f32 v152, v27, v28
    v_cos_f32 v29, v24
    v_add_f32 v24, v24, v25
    v_cos_f32 v30, v24
    v_add_f32 v24, v24, v25
    v_cvt_pk_bf16_f32 v153, v29, v30
    v_cos_f32 v27, v24
    v_add_f32 v24, v24, v25
    v_cos_f32 v28, v24
    v_add_f32 v24, v24, v25
    v_cvt_pk_bf16_f32 v154, v27, v28
    v_cos_f32 v29, v24
    v_add_f32 v24, v24, v25
    v_cos_f32 v30, v24
    v_add_f32 v24, v24, v26
    v_cvt_pk_bf16_f32 v155, v29, v30
    v_cos_f32 v27, v24
    v_add_f32 v24, v24, v25
    v_cos_f32 v28, v24
    v_add_f32 v24, v24, v25
    v_cvt_pk_bf16_f32 v156, v27, v28
    v_cos_f32 v29, v24
    v_add_f32 v24, v24, v25
    v_cos_f32 v30, v24
    v_add_f32 v24, v24, v25
    v_cvt_pk_bf16_f32 v157, v29, v30
    v_cos_f32 v27, v24
    v_add_f32 v24, v24, v25
    v_cos_f32 v28, v24
    v_add_f32 v24, v24, v25
    v_cvt_pk_bf16_f32 v158, v27, v28
    v_cos_f32 v29, v24
    v_add_f32 v24, v24, v25
    v_cos_f32 v30, v24
    v_add_f32 v24, v24, v26
    v_cvt_pk_bf16_f32 v159, v29, v30
    v_cos_f32 v27, v24
    v_add_f32 v24, v24, v25
    v_cos_f32 v28, v24
    v_add_f32 v24, v24, v25
    v_cvt_pk_bf16_f32 v160, v27, v28
    v_cos_f32 v29, v24
    v_add_f32 v24, v24, v25
    v_cos_f32 v30, v24
    v_add_f32 v24, v24, v25
    v_cvt_pk_bf16_f32 v161, v29, v30
    v_cos_f32 v27, v24
    v_add_f32 v24, v24, v25
    v_cos_f32 v28, v24
    v_add_f32 v24, v24, v25
    v_cvt_pk_bf16_f32 v162, v27, v28
    v_cos_f32 v29, v24
    v_add_f32 v24, v24, v25
    v_cos_f32 v30, v24
    v_add_f32 v24, v24, v26
    v_cvt_pk_bf16_f32 v163, v29, v30
    v_cos_f32 v27, v24
    v_add_f32 v24, v24, v25
    v_cos_f32 v28, v24
    v_add_f32 v24, v24, v25
    v_cvt_pk_bf16_f32 v164, v27, v28
    v_cos_f32 v29, v24
    v_add_f32 v24, v24, v25
    v_cos_f32 v30, v24
    v_add_f32 v24, v24, v25
    v_cvt_pk_bf16_f32 v165, v29, v30
    v_cos_f32 v27, v24
    v_add_f32 v24, v24, v25
    v_cos_f32 v28, v24
    v_add_f32 v24, v24, v25
    v_cvt_pk_bf16_f32 v166, v27, v28
    v_cos_f32 v29, v24
    v_add_f32 v24, v24, v25
    v_cos_f32 v30, v24
    v_add_f32 v24, v24, v26
    v_cvt_pk_bf16_f32 v167, v29, v30
    s_waitcnt lgkmcnt(0)
    s_barrier
    ds_read_b128 v[80:83], v10 offset:0
    ds_read_b64_tr_b16 v[112:113], v9 offset:0
    ds_read_b64_tr_b16 v[114:115], v9 offset:256
    ds_read_b128 v[220:223], v10 offset:49152
    ds_read_b64_tr_b16 v[116:117], v9 offset:1024
    ds_read_b64_tr_b16 v[118:119], v9 offset:1280
    ds_read_b64_tr_b16 v[120:121], v9 offset:2048
    ds_read_b64_tr_b16 v[122:123], v9 offset:2304
    ds_read_b128 v[84:87], v11 offset:0
    ds_read_b128 v[224:227], v11 offset:49152
    ds_read_b128 v[88:91], v12 offset:0
    ds_read_b128 v[228:231], v12 offset:49152
    ds_read_b128 v[92:95], v13 offset:0
    ds_read_b128 v[232:235], v13 offset:49152
    s_waitcnt lgkmcnt(11)
    v_mfma_f32_32x32x16_bf16 v[32:47], v[112:115], v[80:83], 0
    ds_read_b64_tr_b16 v[124:125], v9 offset:3072
    ds_read_b64_tr_b16 v[126:127], v9 offset:3328
    s_waitcnt lgkmcnt(12)
    v_mfma_f32_32x32x16_bf16 v[172:187], v[112:115], v[220:223], 0
    ds_read_b64_tr_b16 v[128:129], v9 offset:4096
    ds_read_b64_tr_b16 v[130:131], v9 offset:4352
    s_waitcnt lgkmcnt(12)
    v_mfma_f32_32x32x16_bf16 v[48:63], v[116:119], v[80:83], 0
    ds_read_b64_tr_b16 v[132:133], v9 offset:5120
    ds_read_b64_tr_b16 v[134:135], v9 offset:5376
    v_mfma_f32_32x32x16_bf16 v[188:203], v[116:119], v[220:223], 0
    s_waitcnt lgkmcnt(12)
    v_mfma_f32_32x32x16_bf16 v[64:79], v[80:83], v[120:123], 0
    v_mfma_f32_32x32x16_bf16 v[204:219], v[220:223], v[120:123], 0
    s_waitcnt lgkmcnt(4)
    v_mfma_f32_32x32x16_bf16 v[32:47], v[124:127], v[84:87], v[32:47]
    ds_read_b64_tr_b16 v[112:113], v9 offset:6144
    ds_read_b64_tr_b16 v[114:115], v9 offset:6400
    v_mfma_f32_32x32x16_bf16 v[172:187], v[124:127], v[224:227], v[172:187]
    ds_read_b64_tr_b16 v[116:117], v9 offset:7168
    ds_read_b64_tr_b16 v[118:119], v9 offset:7424
    s_waitcnt lgkmcnt(6)
    v_mfma_f32_32x32x16_bf16 v[48:63], v[128:131], v[84:87], v[48:63]
    ds_read_b64_tr_b16 v[120:121], v9 offset:8192
    ds_read_b64_tr_b16 v[122:123], v9 offset:8448
    v_mfma_f32_32x32x16_bf16 v[188:203], v[128:131], v[224:227], v[188:203]
    s_waitcnt lgkmcnt(6)
    v_mfma_f32_32x32x16_bf16 v[64:79], v[84:87], v[132:135], v[64:79]
    v_mfma_f32_32x32x16_bf16 v[204:219], v[224:227], v[132:135], v[204:219]
    s_waitcnt lgkmcnt(4)
    v_mfma_f32_32x32x16_bf16 v[32:47], v[112:115], v[88:91], v[32:47]
    ds_read_b64_tr_b16 v[124:125], v9 offset:9216
    ds_read_b64_tr_b16 v[126:127], v9 offset:9472
    v_mfma_f32_32x32x16_bf16 v[172:187], v[112:115], v[228:231], v[172:187]
    ds_read_b64_tr_b16 v[128:129], v9 offset:10240
    ds_read_b64_tr_b16 v[130:131], v9 offset:10496
    s_waitcnt lgkmcnt(6)
    v_mfma_f32_32x32x16_bf16 v[48:63], v[116:119], v[88:91], v[48:63]
    ds_read_b64_tr_b16 v[132:133], v9 offset:11264
    ds_read_b64_tr_b16 v[134:135], v9 offset:11520
    v_mfma_f32_32x32x16_bf16 v[188:203], v[116:119], v[228:231], v[188:203]
    s_waitcnt lgkmcnt(6)
    v_mfma_f32_32x32x16_bf16 v[64:79], v[88:91], v[120:123], v[64:79]
    v_mfma_f32_32x32x16_bf16 v[204:219], v[228:231], v[120:123], v[204:219]
    s_waitcnt lgkmcnt(0)
    s_barrier
    v_mfma_f32_32x32x16_bf16 v[32:47], v[124:127], v[92:95], v[32:47]
    ds_read_b128 v[96:99], v10 offset:4096
    ds_read_b64_tr_b16 v[112:113], v9 offset:12288
    ds_read_b64_tr_b16 v[114:115], v9 offset:12544
    v_mfma_f32_32x32x16_bf16 v[172:187], v[124:127], v[232:235], v[172:187]
    ds_read_b128 v[236:239], v10 offset:53248
    ds_read_b64_tr_b16 v[116:117], v9 offset:13312
    ds_read_b64_tr_b16 v[118:119], v9 offset:13568
    v_mfma_f32_32x32x16_bf16 v[48:63], v[128:131], v[92:95], v[48:63]
    ds_read_b64_tr_b16 v[120:121], v9 offset:14336
    ds_read_b64_tr_b16 v[122:123], v9 offset:14592
    v_mfma_f32_32x32x16_bf16 v[188:203], v[128:131], v[232:235], v[188:203]
    ds_read_b128 v[100:103], v11 offset:4096
    ds_read_b128 v[240:243], v11 offset:53248
    v_mfma_f32_32x32x16_bf16 v[64:79], v[92:95], v[132:135], v[64:79]
    ds_read_b128 v[104:107], v12 offset:4096
    ds_read_b128 v[244:247], v12 offset:53248
    v_mfma_f32_32x32x16_bf16 v[204:219], v[232:235], v[132:135], v[204:219]
    ds_read_b128 v[108:111], v13 offset:4096
    ds_read_b128 v[248:251], v13 offset:53248
    s_waitcnt lgkmcnt(11)
    v_mfma_f32_32x32x16_bf16 v[32:47], v[112:115], v[96:99], v[32:47]
    ds_read_b64_tr_b16 v[124:125], v9 offset:15360
    ds_read_b64_tr_b16 v[126:127], v9 offset:15616
    s_waitcnt lgkmcnt(12)
    v_mfma_f32_32x32x16_bf16 v[172:187], v[112:115], v[236:239], v[172:187]
    ds_read_b64_tr_b16 v[128:129], v9 offset:16384
    ds_read_b64_tr_b16 v[130:131], v9 offset:16640
    s_waitcnt lgkmcnt(12)
    v_mfma_f32_32x32x16_bf16 v[48:63], v[116:119], v[96:99], v[48:63]
    ds_read_b64_tr_b16 v[132:133], v9 offset:17408
    ds_read_b64_tr_b16 v[134:135], v9 offset:17664
    v_mfma_f32_32x32x16_bf16 v[188:203], v[116:119], v[236:239], v[188:203]
    s_waitcnt lgkmcnt(12)
    v_mfma_f32_32x32x16_bf16 v[64:79], v[96:99], v[120:123], v[64:79]
    v_mfma_f32_32x32x16_bf16 v[204:219], v[236:239], v[120:123], v[204:219]
    s_waitcnt lgkmcnt(4)
    v_mfma_f32_32x32x16_bf16 v[32:47], v[124:127], v[100:103], v[32:47]
    ds_read_b64_tr_b16 v[112:113], v9 offset:18432
    ds_read_b64_tr_b16 v[114:115], v9 offset:18688
    v_mfma_f32_32x32x16_bf16 v[172:187], v[124:127], v[240:243], v[172:187]
    ds_read_b64_tr_b16 v[116:117], v9 offset:19456
    ds_read_b64_tr_b16 v[118:119], v9 offset:19712
    s_waitcnt lgkmcnt(6)
    v_mfma_f32_32x32x16_bf16 v[48:63], v[128:131], v[100:103], v[48:63]
    ds_read_b64_tr_b16 v[120:121], v9 offset:20480
    ds_read_b64_tr_b16 v[122:123], v9 offset:20736
    v_mfma_f32_32x32x16_bf16 v[188:203], v[128:131], v[240:243], v[188:203]
    s_waitcnt lgkmcnt(6)
    v_mfma_f32_32x32x16_bf16 v[64:79], v[100:103], v[132:135], v[64:79]
    v_mfma_f32_32x32x16_bf16 v[204:219], v[240:243], v[132:135], v[204:219]
    s_waitcnt lgkmcnt(4)
    v_mfma_f32_32x32x16_bf16 v[32:47], v[112:115], v[104:107], v[32:47]
    ds_read_b64_tr_b16 v[124:125], v9 offset:21504
    ds_read_b64_tr_b16 v[126:127], v9 offset:21760
    v_mfma_f32_32x32x16_bf16 v[172:187], v[112:115], v[244:247], v[172:187]
    ds_read_b64_tr_b16 v[128:129], v9 offset:22528
    ds_read_b64_tr_b16 v[130:131], v9 offset:22784
    s_waitcnt lgkmcnt(6)
    v_mfma_f32_32x32x16_bf16 v[48:63], v[116:119], v[104:107], v[48:63]
    ds_read_b64_tr_b16 v[132:133], v9 offset:23552
    ds_read_b64_tr_b16 v[134:135], v9 offset:23808
    v_mfma_f32_32x32x16_bf16 v[188:203], v[116:119], v[244:247], v[188:203]
    s_waitcnt lgkmcnt(6)
    v_mfma_f32_32x32x16_bf16 v[64:79], v[104:107], v[120:123], v[64:79]
    v_mfma_f32_32x32x16_bf16 v[204:219], v[244:247], v[120:123], v[204:219]
    s_waitcnt lgkmcnt(0)
    s_barrier
    v_mfma_f32_32x32x16_bf16 v[32:47], v[124:127], v[108:111], v[32:47]
    ds_read_b128 v[80:83], v10 offset:8192
    ds_read_b64_tr_b16 v[112:113], v9 offset:24576
    ds_read_b64_tr_b16 v[114:115], v9 offset:24832
    v_mfma_f32_32x32x16_bf16 v[172:187], v[124:127], v[248:251], v[172:187]
    ds_read_b128 v[220:223], v10 offset:57344
    ds_read_b64_tr_b16 v[116:117], v9 offset:25600
    ds_read_b64_tr_b16 v[118:119], v9 offset:25856
    v_mfma_f32_32x32x16_bf16 v[48:63], v[128:131], v[108:111], v[48:63]
    ds_read_b64_tr_b16 v[120:121], v9 offset:26624
    ds_read_b64_tr_b16 v[122:123], v9 offset:26880
    v_mfma_f32_32x32x16_bf16 v[188:203], v[128:131], v[248:251], v[188:203]
    ds_read_b128 v[84:87], v11 offset:8192
    ds_read_b128 v[224:227], v11 offset:57344
    v_mfma_f32_32x32x16_bf16 v[64:79], v[108:111], v[132:135], v[64:79]
    ds_read_b128 v[88:91], v12 offset:8192
    ds_read_b128 v[228:231], v12 offset:57344
    v_mfma_f32_32x32x16_bf16 v[204:219], v[248:251], v[132:135], v[204:219]
    ds_read_b128 v[92:95], v13 offset:8192
    ds_read_b128 v[232:235], v13 offset:57344
    s_waitcnt lgkmcnt(11)
    v_mfma_f32_32x32x16_bf16 v[32:47], v[112:115], v[80:83], v[32:47]
    ds_read_b64_tr_b16 v[124:125], v9 offset:27648
    ds_read_b64_tr_b16 v[126:127], v9 offset:27904
    s_waitcnt lgkmcnt(12)
    v_mfma_f32_32x32x16_bf16 v[172:187], v[112:115], v[220:223], v[172:187]
    ds_read_b64_tr_b16 v[128:129], v9 offset:28672
    ds_read_b64_tr_b16 v[130:131], v9 offset:28928
    s_waitcnt lgkmcnt(12)
    v_mfma_f32_32x32x16_bf16 v[48:63], v[116:119], v[80:83], v[48:63]
    ds_read_b64_tr_b16 v[132:133], v9 offset:29696
    ds_read_b64_tr_b16 v[134:135], v9 offset:29952
    v_mfma_f32_32x32x16_bf16 v[188:203], v[116:119], v[220:223], v[188:203]
    s_waitcnt lgkmcnt(12)
    v_mfma_f32_32x32x16_bf16 v[64:79], v[80:83], v[120:123], v[64:79]
    v_mfma_f32_32x32x16_bf16 v[204:219], v[220:223], v[120:123], v[204:219]
    s_waitcnt lgkmcnt(4)
    v_mfma_f32_32x32x16_bf16 v[32:47], v[124:127], v[84:87], v[32:47]
    ds_read_b64_tr_b16 v[112:113], v9 offset:30720
    ds_read_b64_tr_b16 v[114:115], v9 offset:30976
    v_mfma_f32_32x32x16_bf16 v[172:187], v[124:127], v[224:227], v[172:187]
    ds_read_b64_tr_b16 v[116:117], v9 offset:31744
    ds_read_b64_tr_b16 v[118:119], v9 offset:32000
    s_waitcnt lgkmcnt(6)
    v_mfma_f32_32x32x16_bf16 v[48:63], v[128:131], v[84:87], v[48:63]
    ds_read_b64_tr_b16 v[120:121], v9 offset:32768
    ds_read_b64_tr_b16 v[122:123], v9 offset:33024
    v_mfma_f32_32x32x16_bf16 v[188:203], v[128:131], v[224:227], v[188:203]
    s_waitcnt lgkmcnt(6)
    v_mfma_f32_32x32x16_bf16 v[64:79], v[84:87], v[132:135], v[64:79]
    v_mfma_f32_32x32x16_bf16 v[204:219], v[224:227], v[132:135], v[204:219]
    s_waitcnt lgkmcnt(4)
    v_mfma_f32_32x32x16_bf16 v[32:47], v[112:115], v[88:91], v[32:47]
    ds_read_b64_tr_b16 v[124:125], v9 offset:33792
    ds_read_b64_tr_b16 v[126:127], v9 offset:34048
    v_mfma_f32_32x32x16_bf16 v[172:187], v[112:115], v[228:231], v[172:187]
    ds_read_b64_tr_b16 v[128:129], v9 offset:34816
    ds_read_b64_tr_b16 v[130:131], v9 offset:35072
    s_waitcnt lgkmcnt(6)
    v_mfma_f32_32x32x16_bf16 v[48:63], v[116:119], v[88:91], v[48:63]
    ds_read_b64_tr_b16 v[132:133], v9 offset:35840
    ds_read_b64_tr_b16 v[134:135], v9 offset:36096
    v_mfma_f32_32x32x16_bf16 v[188:203], v[116:119], v[228:231], v[188:203]
    s_waitcnt lgkmcnt(6)
    v_mfma_f32_32x32x16_bf16 v[64:79], v[88:91], v[120:123], v[64:79]
    v_mfma_f32_32x32x16_bf16 v[204:219], v[228:231], v[120:123], v[204:219]
    s_waitcnt lgkmcnt(0)
    s_barrier
    v_mfma_f32_32x32x16_bf16 v[32:47], v[124:127], v[92:95], v[32:47]
    ds_read_b128 v[96:99], v10 offset:0
    ds_read_b64_tr_b16 v[112:113], v9 offset:36864
    ds_read_b64_tr_b16 v[114:115], v9 offset:37120
    v_mfma_f32_32x32x16_bf16 v[172:187], v[124:127], v[232:235], v[172:187]
    ds_read_b128 v[236:239], v10 offset:49152
    ds_read_b64_tr_b16 v[116:117], v9 offset:37888
    ds_read_b64_tr_b16 v[118:119], v9 offset:38144
    v_mfma_f32_32x32x16_bf16 v[48:63], v[128:131], v[92:95], v[48:63]
    ds_read_b64_tr_b16 v[120:121], v9 offset:38912
    ds_read_b64_tr_b16 v[122:123], v9 offset:39168
    v_mfma_f32_32x32x16_bf16 v[188:203], v[128:131], v[232:235], v[188:203]
    ds_read_b128 v[100:103], v11 offset:0
    ds_read_b128 v[240:243], v11 offset:49152
    v_mfma_f32_32x32x16_bf16 v[64:79], v[92:95], v[132:135], v[64:79]
    ds_read_b128 v[104:107], v12 offset:0
    ds_read_b128 v[244:247], v12 offset:49152
    v_mfma_f32_32x32x16_bf16 v[204:219], v[232:235], v[132:135], v[204:219]
    ds_read_b128 v[108:111], v13 offset:0
    ds_read_b128 v[248:251], v13 offset:49152
    s_waitcnt lgkmcnt(11)
    v_mfma_f32_32x32x16_bf16 v[32:47], v[112:115], v[96:99], v[32:47]
    ds_read_b64_tr_b16 v[124:125], v9 offset:39936
    ds_read_b64_tr_b16 v[126:127], v9 offset:40192
    s_waitcnt lgkmcnt(12)
    v_mfma_f32_32x32x16_bf16 v[172:187], v[112:115], v[236:239], v[172:187]
    ds_read_b64_tr_b16 v[128:129], v9 offset:40960
    ds_read_b64_tr_b16 v[130:131], v9 offset:41216
    s_waitcnt lgkmcnt(12)
    v_mfma_f32_32x32x16_bf16 v[48:63], v[116:119], v[96:99], v[48:63]
    ds_read_b64_tr_b16 v[132:133], v9 offset:41984
    ds_read_b64_tr_b16 v[134:135], v9 offset:42240
    v_mfma_f32_32x32x16_bf16 v[188:203], v[116:119], v[236:239], v[188:203]
    s_waitcnt lgkmcnt(12)
    v_mfma_f32_32x32x16_bf16 v[64:79], v[96:99], v[120:123], v[64:79]
    v_mfma_f32_32x32x16_bf16 v[204:219], v[236:239], v[120:123], v[204:219]
    s_waitcnt lgkmcnt(4)
    v_mfma_f32_32x32x16_bf16 v[32:47], v[124:127], v[100:103], v[32:47]
    ds_read_b64_tr_b16 v[112:113], v9 offset:43008
    ds_read_b64_tr_b16 v[114:115], v9 offset:43264
    v_mfma_f32_32x32x16_bf16 v[172:187], v[124:127], v[240:243], v[172:187]
    ds_read_b64_tr_b16 v[116:117], v9 offset:44032
    ds_read_b64_tr_b16 v[118:119], v9 offset:44288
    s_waitcnt lgkmcnt(6)
    v_mfma_f32_32x32x16_bf16 v[48:63], v[128:131], v[100:103], v[48:63]
    ds_read_b64_tr_b16 v[120:121], v9 offset:45056
    ds_read_b64_tr_b16 v[122:123], v9 offset:45312
    v_mfma_f32_32x32x16_bf16 v[188:203], v[128:131], v[240:243], v[188:203]
    s_waitcnt lgkmcnt(6)
    v_mfma_f32_32x32x16_bf16 v[64:79], v[100:103], v[132:135], v[64:79]
    v_mfma_f32_32x32x16_bf16 v[204:219], v[240:243], v[132:135], v[204:219]
    s_waitcnt lgkmcnt(4)
    v_mfma_f32_32x32x16_bf16 v[32:47], v[112:115], v[104:107], v[32:47]
    ds_read_b64_tr_b16 v[124:125], v9 offset:46080
    ds_read_b64_tr_b16 v[126:127], v9 offset:46336
    v_mfma_f32_32x32x16_bf16 v[172:187], v[112:115], v[244:247], v[172:187]
    ds_read_b64_tr_b16 v[128:129], v9 offset:47104
    ds_read_b64_tr_b16 v[130:131], v9 offset:47360
    s_waitcnt lgkmcnt(6)
    v_mfma_f32_32x32x16_bf16 v[48:63], v[116:119], v[104:107], v[48:63]
    ds_read_b64_tr_b16 v[132:133], v9 offset:48128
    ds_read_b64_tr_b16 v[134:135], v9 offset:48384
    v_mfma_f32_32x32x16_bf16 v[188:203], v[116:119], v[244:247], v[188:203]
    s_waitcnt lgkmcnt(6)
    v_mfma_f32_32x32x16_bf16 v[64:79], v[104:107], v[120:123], v[64:79]
    v_mfma_f32_32x32x16_bf16 v[204:219], v[244:247], v[120:123], v[204:219]
    s_waitcnt lgkmcnt(0)
    s_barrier
    v_mfma_f32_32x32x16_bf16 v[32:47], v[124:127], v[108:111], v[32:47]
    ds_read_b128 v[80:83], v10 offset:4096
    ds_read_b64_tr_b16 v[112:113], v9 offset:49152
    ds_read_b64_tr_b16 v[114:115], v9 offset:49408
    v_mfma_f32_32x32x16_bf16 v[172:187], v[124:127], v[248:251], v[172:187]
    ds_read_b128 v[220:223], v10 offset:53248
    ds_read_b64_tr_b16 v[116:117], v9 offset:50176
    ds_read_b64_tr_b16 v[118:119], v9 offset:50432
    v_mfma_f32_32x32x16_bf16 v[48:63], v[128:131], v[108:111], v[48:63]
    ds_read_b64_tr_b16 v[120:121], v9 offset:51200
    ds_read_b64_tr_b16 v[122:123], v9 offset:51456
    v_mfma_f32_32x32x16_bf16 v[188:203], v[128:131], v[248:251], v[188:203]
    ds_read_b128 v[84:87], v11 offset:4096
    ds_read_b128 v[224:227], v11 offset:53248
    v_mfma_f32_32x32x16_bf16 v[64:79], v[108:111], v[132:135], v[64:79]
    ds_read_b128 v[88:91], v12 offset:4096
    ds_read_b128 v[228:231], v12 offset:53248
    v_mfma_f32_32x32x16_bf16 v[204:219], v[248:251], v[132:135], v[204:219]
    ds_read_b128 v[92:95], v13 offset:4096
    ds_read_b128 v[232:235], v13 offset:53248
    s_waitcnt lgkmcnt(11)
    v_mfma_f32_32x32x16_bf16 v[32:47], v[112:115], v[80:83], v[32:47]
    ds_read_b64_tr_b16 v[124:125], v9 offset:52224
    ds_read_b64_tr_b16 v[126:127], v9 offset:52480
    s_waitcnt lgkmcnt(12)
    v_mfma_f32_32x32x16_bf16 v[172:187], v[112:115], v[220:223], v[172:187]
    ds_read_b64_tr_b16 v[128:129], v9 offset:53248
    ds_read_b64_tr_b16 v[130:131], v9 offset:53504
    s_waitcnt lgkmcnt(12)
    v_mfma_f32_32x32x16_bf16 v[48:63], v[116:119], v[80:83], v[48:63]
    ds_read_b64_tr_b16 v[132:133], v9 offset:54272
    ds_read_b64_tr_b16 v[134:135], v9 offset:54528
    v_mfma_f32_32x32x16_bf16 v[188:203], v[116:119], v[220:223], v[188:203]
    s_waitcnt lgkmcnt(12)
    v_mfma_f32_32x32x16_bf16 v[64:79], v[80:83], v[120:123], v[64:79]
    v_mfma_f32_32x32x16_bf16 v[204:219], v[220:223], v[120:123], v[204:219]
    s_waitcnt lgkmcnt(4)
    v_mfma_f32_32x32x16_bf16 v[32:47], v[124:127], v[84:87], v[32:47]
    ds_read_b64_tr_b16 v[112:113], v9 offset:55296
    ds_read_b64_tr_b16 v[114:115], v9 offset:55552
    v_mfma_f32_32x32x16_bf16 v[172:187], v[124:127], v[224:227], v[172:187]
    ds_read_b64_tr_b16 v[116:117], v9 offset:56320
    ds_read_b64_tr_b16 v[118:119], v9 offset:56576
    s_waitcnt lgkmcnt(6)
    v_mfma_f32_32x32x16_bf16 v[48:63], v[128:131], v[84:87], v[48:63]
    ds_read_b64_tr_b16 v[120:121], v9 offset:57344
    ds_read_b64_tr_b16 v[122:123], v9 offset:57600
    v_mfma_f32_32x32x16_bf16 v[188:203], v[128:131], v[224:227], v[188:203]
    s_waitcnt lgkmcnt(6)
    v_mfma_f32_32x32x16_bf16 v[64:79], v[84:87], v[132:135], v[64:79]
    v_mfma_f32_32x32x16_bf16 v[204:219], v[224:227], v[132:135], v[204:219]
    s_waitcnt lgkmcnt(4)
    v_mfma_f32_32x32x16_bf16 v[32:47], v[112:115], v[88:91], v[32:47]
    ds_read_b64_tr_b16 v[124:125], v9 offset:58368
    ds_read_b64_tr_b16 v[126:127], v9 offset:58624
    v_mfma_f32_32x32x16_bf16 v[172:187], v[112:115], v[228:231], v[172:187]
    ds_read_b64_tr_b16 v[128:129], v9 offset:59392
    ds_read_b64_tr_b16 v[130:131], v9 offset:59648
    s_waitcnt lgkmcnt(6)
    v_mfma_f32_32x32x16_bf16 v[48:63], v[116:119], v[88:91], v[48:63]
    ds_read_b64_tr_b16 v[132:133], v9 offset:60416
    ds_read_b64_tr_b16 v[134:135], v9 offset:60672
    v_mfma_f32_32x32x16_bf16 v[188:203], v[116:119], v[228:231], v[188:203]
    s_waitcnt lgkmcnt(6)
    v_mfma_f32_32x32x16_bf16 v[64:79], v[88:91], v[120:123], v[64:79]
    v_mfma_f32_32x32x16_bf16 v[204:219], v[228:231], v[120:123], v[204:219]
    s_waitcnt lgkmcnt(0)
    s_barrier
    v_mfma_f32_32x32x16_bf16 v[32:47], v[124:127], v[92:95], v[32:47]
    ds_read_b128 v[96:99], v10 offset:8192
    ds_read_b64_tr_b16 v[112:113], v9 offset:0
    ds_read_b64_tr_b16 v[114:115], v9 offset:256
    v_mfma_f32_32x32x16_bf16 v[172:187], v[124:127], v[232:235], v[172:187]
    ds_read_b128 v[236:239], v10 offset:57344
    ds_read_b64_tr_b16 v[116:117], v9 offset:1024
    ds_read_b64_tr_b16 v[118:119], v9 offset:1280
    v_mfma_f32_32x32x16_bf16 v[48:63], v[128:131], v[92:95], v[48:63]
    ds_read_b64_tr_b16 v[120:121], v9 offset:2048
    ds_read_b64_tr_b16 v[122:123], v9 offset:2304
    v_mfma_f32_32x32x16_bf16 v[188:203], v[128:131], v[232:235], v[188:203]
    ds_read_b128 v[100:103], v11 offset:8192
    ds_read_b128 v[240:243], v11 offset:57344
    v_mfma_f32_32x32x16_bf16 v[64:79], v[92:95], v[132:135], v[64:79]
    ds_read_b128 v[104:107], v12 offset:8192
    ds_read_b128 v[244:247], v12 offset:57344
    v_mfma_f32_32x32x16_bf16 v[204:219], v[232:235], v[132:135], v[204:219]
    ds_read_b128 v[108:111], v13 offset:8192
    ds_read_b128 v[248:251], v13 offset:57344
    s_waitcnt lgkmcnt(11)
    v_mfma_f32_32x32x16_bf16 v[32:47], v[112:115], v[96:99], v[32:47]
    ds_read_b64_tr_b16 v[124:125], v9 offset:3072
    ds_read_b64_tr_b16 v[126:127], v9 offset:3328
    s_waitcnt lgkmcnt(12)
    v_mfma_f32_32x32x16_bf16 v[172:187], v[112:115], v[236:239], v[172:187]
    ds_read_b64_tr_b16 v[128:129], v9 offset:4096
    ds_read_b64_tr_b16 v[130:131], v9 offset:4352
    s_waitcnt lgkmcnt(12)
    v_mfma_f32_32x32x16_bf16 v[48:63], v[116:119], v[96:99], v[48:63]
    ds_read_b64_tr_b16 v[132:133], v9 offset:5120
    ds_read_b64_tr_b16 v[134:135], v9 offset:5376
    v_mfma_f32_32x32x16_bf16 v[188:203], v[116:119], v[236:239], v[188:203]
    s_waitcnt lgkmcnt(12)
    v_mfma_f32_32x32x16_bf16 v[64:79], v[96:99], v[120:123], v[64:79]
    v_mfma_f32_32x32x16_bf16 v[204:219], v[236:239], v[120:123], v[204:219]
    s_waitcnt lgkmcnt(4)
    v_mfma_f32_32x32x16_bf16 v[32:47], v[124:127], v[100:103], v[32:47]
    ds_read_b64_tr_b16 v[112:113], v9 offset:6144
    ds_read_b64_tr_b16 v[114:115], v9 offset:6400
    v_mfma_f32_32x32x16_bf16 v[172:187], v[124:127], v[240:243], v[172:187]
    ds_read_b64_tr_b16 v[116:117], v9 offset:7168
    ds_read_b64_tr_b16 v[118:119], v9 offset:7424
    s_waitcnt lgkmcnt(6)
    v_mfma_f32_32x32x16_bf16 v[48:63], v[128:131], v[100:103], v[48:63]
    ds_read_b64_tr_b16 v[120:121], v9 offset:8192
    ds_read_b64_tr_b16 v[122:123], v9 offset:8448
    v_mfma_f32_32x32x16_bf16 v[188:203], v[128:131], v[240:243], v[188:203]
    s_waitcnt lgkmcnt(6)
    v_mfma_f32_32x32x16_bf16 v[64:79], v[100:103], v[132:135], v[64:79]
    v_mfma_f32_32x32x16_bf16 v[204:219], v[240:243], v[132:135], v[204:219]
    s_waitcnt lgkmcnt(4)
    v_mfma_f32_32x32x16_bf16 v[32:47], v[112:115], v[104:107], v[32:47]
    ds_read_b64_tr_b16 v[124:125], v9 offset:9216
    ds_read_b64_tr_b16 v[126:127], v9 offset:9472
    v_mfma_f32_32x32x16_bf16 v[172:187], v[112:115], v[244:247], v[172:187]
    ds_read_b64_tr_b16 v[128:129], v9 offset:10240
    ds_read_b64_tr_b16 v[130:131], v9 offset:10496
    s_waitcnt lgkmcnt(6)
    v_mfma_f32_32x32x16_bf16 v[48:63], v[116:119], v[104:107], v[48:63]
    ds_read_b64_tr_b16 v[132:133], v9 offset:11264
    ds_read_b64_tr_b16 v[134:135], v9 offset:11520
    v_mfma_f32_32x32x16_bf16 v[188:203], v[116:119], v[244:247], v[188:203]
    s_waitcnt lgkmcnt(6)
    v_mfma_f32_32x32x16_bf16 v[64:79], v[104:107], v[120:123], v[64:79]
    v_mfma_f32_32x32x16_bf16 v[204:219], v[244:247], v[120:123], v[204:219]
    s_waitcnt lgkmcnt(0)
    s_barrier
    v_mfma_f32_32x32x16_bf16 v[32:47], v[124:127], v[108:111], v[32:47]
    ds_read_b128 v[80:83], v10 offset:0
    ds_read_b64_tr_b16 v[112:113], v9 offset:12288
    ds_read_b64_tr_b16 v[114:115], v9 offset:12544
    v_mfma_f32_32x32x16_bf16 v[172:187], v[124:127], v[248:251], v[172:187]
    ds_read_b128 v[220:223], v10 offset:49152
    ds_read_b64_tr_b16 v[116:117], v9 offset:13312
    ds_read_b64_tr_b16 v[118:119], v9 offset:13568
    v_mfma_f32_32x32x16_bf16 v[48:63], v[128:131], v[108:111], v[48:63]
    ds_read_b64_tr_b16 v[120:121], v9 offset:14336
    ds_read_b64_tr_b16 v[122:123], v9 offset:14592
    v_mfma_f32_32x32x16_bf16 v[188:203], v[128:131], v[248:251], v[188:203]
    ds_read_b128 v[84:87], v11 offset:0
    ds_read_b128 v[224:227], v11 offset:49152
    v_mfma_f32_32x32x16_bf16 v[64:79], v[108:111], v[132:135], v[64:79]
    ds_read_b128 v[88:91], v12 offset:0
    ds_read_b128 v[228:231], v12 offset:49152
    v_mfma_f32_32x32x16_bf16 v[204:219], v[248:251], v[132:135], v[204:219]
    ds_read_b128 v[92:95], v13 offset:0
    ds_read_b128 v[232:235], v13 offset:49152
    s_waitcnt lgkmcnt(11)
    v_mfma_f32_32x32x16_bf16 v[32:47], v[112:115], v[80:83], v[32:47]
    ds_read_b64_tr_b16 v[124:125], v9 offset:15360
    ds_read_b64_tr_b16 v[126:127], v9 offset:15616
    s_waitcnt lgkmcnt(12)
    v_mfma_f32_32x32x16_bf16 v[172:187], v[112:115], v[220:223], v[172:187]
    ds_read_b64_tr_b16 v[128:129], v9 offset:16384
    ds_read_b64_tr_b16 v[130:131], v9 offset:16640
    s_waitcnt lgkmcnt(12)
    v_mfma_f32_32x32x16_bf16 v[48:63], v[116:119], v[80:83], v[48:63]
    ds_read_b64_tr_b16 v[132:133], v9 offset:17408
    ds_read_b64_tr_b16 v[134:135], v9 offset:17664
    v_mfma_f32_32x32x16_bf16 v[188:203], v[116:119], v[220:223], v[188:203]
    s_waitcnt lgkmcnt(12)
    v_mfma_f32_32x32x16_bf16 v[64:79], v[80:83], v[120:123], v[64:79]
    v_mfma_f32_32x32x16_bf16 v[204:219], v[220:223], v[120:123], v[204:219]
    s_waitcnt lgkmcnt(4)
    v_mfma_f32_32x32x16_bf16 v[32:47], v[124:127], v[84:87], v[32:47]
    ds_read_b64_tr_b16 v[112:113], v9 offset:18432
    ds_read_b64_tr_b16 v[114:115], v9 offset:18688
    v_mfma_f32_32x32x16_bf16 v[172:187], v[124:127], v[224:227], v[172:187]
    ds_read_b64_tr_b16 v[116:117], v9 offset:19456
    ds_read_b64_tr_b16 v[118:119], v9 offset:19712
    s_waitcnt lgkmcnt(6)
    v_mfma_f32_32x32x16_bf16 v[48:63], v[128:131], v[84:87], v[48:63]
    ds_read_b64_tr_b16 v[120:121], v9 offset:20480
    ds_read_b64_tr_b16 v[122:123], v9 offset:20736
    v_mfma_f32_32x32x16_bf16 v[188:203], v[128:131], v[224:227], v[188:203]
    s_waitcnt lgkmcnt(6)
    v_mfma_f32_32x32x16_bf16 v[64:79], v[84:87], v[132:135], v[64:79]
    v_mfma_f32_32x32x16_bf16 v[204:219], v[224:227], v[132:135], v[204:219]
    s_waitcnt lgkmcnt(4)
    v_mfma_f32_32x32x16_bf16 v[32:47], v[112:115], v[88:91], v[32:47]
    ds_read_b64_tr_b16 v[124:125], v9 offset:21504
    ds_read_b64_tr_b16 v[126:127], v9 offset:21760
    v_mfma_f32_32x32x16_bf16 v[172:187], v[112:115], v[228:231], v[172:187]
    ds_read_b64_tr_b16 v[128:129], v9 offset:22528
    ds_read_b64_tr_b16 v[130:131], v9 offset:22784
    s_waitcnt lgkmcnt(6)
    v_mfma_f32_32x32x16_bf16 v[48:63], v[116:119], v[88:91], v[48:63]
    ds_read_b64_tr_b16 v[132:133], v9 offset:23552
    ds_read_b64_tr_b16 v[134:135], v9 offset:23808
    v_mfma_f32_32x32x16_bf16 v[188:203], v[116:119], v[228:231], v[188:203]
    s_waitcnt lgkmcnt(6)
    v_mfma_f32_32x32x16_bf16 v[64:79], v[88:91], v[120:123], v[64:79]
    v_mfma_f32_32x32x16_bf16 v[204:219], v[228:231], v[120:123], v[204:219]
    s_waitcnt lgkmcnt(0)
    s_barrier
    v_mfma_f32_32x32x16_bf16 v[32:47], v[124:127], v[92:95], v[32:47]
    ds_read_b128 v[96:99], v10 offset:4096
    ds_read_b64_tr_b16 v[112:113], v9 offset:24576
    ds_read_b64_tr_b16 v[114:115], v9 offset:24832
    v_mfma_f32_32x32x16_bf16 v[172:187], v[124:127], v[232:235], v[172:187]
    ds_read_b128 v[236:239], v10 offset:53248
    ds_read_b64_tr_b16 v[116:117], v9 offset:25600
    ds_read_b64_tr_b16 v[118:119], v9 offset:25856
    v_mfma_f32_32x32x16_bf16 v[48:63], v[128:131], v[92:95], v[48:63]
    ds_read_b64_tr_b16 v[120:121], v9 offset:26624
    ds_read_b64_tr_b16 v[122:123], v9 offset:26880
    v_mfma_f32_32x32x16_bf16 v[188:203], v[128:131], v[232:235], v[188:203]
    ds_read_b128 v[100:103], v11 offset:4096
    ds_read_b128 v[240:243], v11 offset:53248
    v_mfma_f32_32x32x16_bf16 v[64:79], v[92:95], v[132:135], v[64:79]
    ds_read_b128 v[104:107], v12 offset:4096
    ds_read_b128 v[244:247], v12 offset:53248
    v_mfma_f32_32x32x16_bf16 v[204:219], v[232:235], v[132:135], v[204:219]
    ds_read_b128 v[108:111], v13 offset:4096
    ds_read_b128 v[248:251], v13 offset:53248
    s_waitcnt lgkmcnt(11)
    v_mfma_f32_32x32x16_bf16 v[32:47], v[112:115], v[96:99], v[32:47]
    ds_read_b64_tr_b16 v[124:125], v9 offset:27648
    ds_read_b64_tr_b16 v[126:127], v9 offset:27904
    s_waitcnt lgkmcnt(12)
    v_mfma_f32_32x32x16_bf16 v[172:187], v[112:115], v[236:239], v[172:187]
    ds_read_b64_tr_b16 v[128:129], v9 offset:28672
    ds_read_b64_tr_b16 v[130:131], v9 offset:28928
    s_waitcnt lgkmcnt(12)
    v_mfma_f32_32x32x16_bf16 v[48:63], v[116:119], v[96:99], v[48:63]
    ds_read_b64_tr_b16 v[132:133], v9 offset:29696
    ds_read_b64_tr_b16 v[134:135], v9 offset:29952
    v_mfma_f32_32x32x16_bf16 v[188:203], v[116:119], v[236:239], v[188:203]
    s_waitcnt lgkmcnt(12)
    v_mfma_f32_32x32x16_bf16 v[64:79], v[96:99], v[120:123], v[64:79]
    v_mfma_f32_32x32x16_bf16 v[204:219], v[236:239], v[120:123], v[204:219]
    s_waitcnt lgkmcnt(4)
    v_mfma_f32_32x32x16_bf16 v[32:47], v[124:127], v[100:103], v[32:47]
    ds_read_b64_tr_b16 v[112:113], v9 offset:30720
    ds_read_b64_tr_b16 v[114:115], v9 offset:30976
    v_mfma_f32_32x32x16_bf16 v[172:187], v[124:127], v[240:243], v[172:187]
    ds_read_b64_tr_b16 v[116:117], v9 offset:31744
    ds_read_b64_tr_b16 v[118:119], v9 offset:32000
    s_waitcnt lgkmcnt(6)
    v_mfma_f32_32x32x16_bf16 v[48:63], v[128:131], v[100:103], v[48:63]
    ds_read_b64_tr_b16 v[120:121], v9 offset:32768
    ds_read_b64_tr_b16 v[122:123], v9 offset:33024
    v_mfma_f32_32x32x16_bf16 v[188:203], v[128:131], v[240:243], v[188:203]
    s_waitcnt lgkmcnt(6)
    v_mfma_f32_32x32x16_bf16 v[64:79], v[100:103], v[132:135], v[64:79]
    v_mfma_f32_32x32x16_bf16 v[204:219], v[240:243], v[132:135], v[204:219]
    s_waitcnt lgkmcnt(4)
    v_mfma_f32_32x32x16_bf16 v[32:47], v[112:115], v[104:107], v[32:47]
    ds_read_b64_tr_b16 v[124:125], v9 offset:33792
    ds_read_b64_tr_b16 v[126:127], v9 offset:34048
    v_mfma_f32_32x32x16_bf16 v[172:187], v[112:115], v[244:247], v[172:187]
    ds_read_b64_tr_b16 v[128:129], v9 offset:34816
    ds_read_b64_tr_b16 v[130:131], v9 offset:35072
    s_waitcnt lgkmcnt(6)
    v_mfma_f32_32x32x16_bf16 v[48:63], v[116:119], v[104:107], v[48:63]
    ds_read_b64_tr_b16 v[132:133], v9 offset:35840
    ds_read_b64_tr_b16 v[134:135], v9 offset:36096
    v_mfma_f32_32x32x16_bf16 v[188:203], v[116:119], v[244:247], v[188:203]
    s_waitcnt lgkmcnt(6)
    v_mfma_f32_32x32x16_bf16 v[64:79], v[104:107], v[120:123], v[64:79]
    v_mfma_f32_32x32x16_bf16 v[204:219], v[244:247], v[120:123], v[204:219]
    s_waitcnt lgkmcnt(0)
    s_barrier
    v_mfma_f32_32x32x16_bf16 v[32:47], v[124:127], v[108:111], v[32:47]
    ds_read_b128 v[80:83], v10 offset:8192
    ds_read_b64_tr_b16 v[112:113], v9 offset:36864
    ds_read_b64_tr_b16 v[114:115], v9 offset:37120
    v_mfma_f32_32x32x16_bf16 v[172:187], v[124:127], v[248:251], v[172:187]
    ds_read_b128 v[220:223], v10 offset:57344
    ds_read_b64_tr_b16 v[116:117], v9 offset:37888
    ds_read_b64_tr_b16 v[118:119], v9 offset:38144
    v_mfma_f32_32x32x16_bf16 v[48:63], v[128:131], v[108:111], v[48:63]
    ds_read_b64_tr_b16 v[120:121], v9 offset:38912
    ds_read_b64_tr_b16 v[122:123], v9 offset:39168
    v_mfma_f32_32x32x16_bf16 v[188:203], v[128:131], v[248:251], v[188:203]
    ds_read_b128 v[84:87], v11 offset:8192
    ds_read_b128 v[224:227], v11 offset:57344
    v_mfma_f32_32x32x16_bf16 v[64:79], v[108:111], v[132:135], v[64:79]
    ds_read_b128 v[88:91], v12 offset:8192
    ds_read_b128 v[228:231], v12 offset:57344
    v_mfma_f32_32x32x16_bf16 v[204:219], v[248:251], v[132:135], v[204:219]
    ds_read_b128 v[92:95], v13 offset:8192
    ds_read_b128 v[232:235], v13 offset:57344
    s_waitcnt lgkmcnt(11)
    v_mfma_f32_32x32x16_bf16 v[32:47], v[112:115], v[80:83], v[32:47]
    ds_read_b64_tr_b16 v[124:125], v9 offset:39936
    ds_read_b64_tr_b16 v[126:127], v9 offset:40192
    s_waitcnt lgkmcnt(12)
    v_mfma_f32_32x32x16_bf16 v[172:187], v[112:115], v[220:223], v[172:187]
    ds_read_b64_tr_b16 v[128:129], v9 offset:40960
    ds_read_b64_tr_b16 v[130:131], v9 offset:41216
    s_waitcnt lgkmcnt(12)
    v_mfma_f32_32x32x16_bf16 v[48:63], v[116:119], v[80:83], v[48:63]
    ds_read_b64_tr_b16 v[132:133], v9 offset:41984
    ds_read_b64_tr_b16 v[134:135], v9 offset:42240
    v_mfma_f32_32x32x16_bf16 v[188:203], v[116:119], v[220:223], v[188:203]
    s_waitcnt lgkmcnt(12)
    v_mfma_f32_32x32x16_bf16 v[64:79], v[80:83], v[120:123], v[64:79]
    v_mfma_f32_32x32x16_bf16 v[204:219], v[220:223], v[120:123], v[204:219]
    s_waitcnt lgkmcnt(4)
    v_mfma_f32_32x32x16_bf16 v[32:47], v[124:127], v[84:87], v[32:47]
    ds_read_b64_tr_b16 v[112:113], v9 offset:43008
    ds_read_b64_tr_b16 v[114:115], v9 offset:43264
    v_mfma_f32_32x32x16_bf16 v[172:187], v[124:127], v[224:227], v[172:187]
    ds_read_b64_tr_b16 v[116:117], v9 offset:44032
    ds_read_b64_tr_b16 v[118:119], v9 offset:44288
    s_waitcnt lgkmcnt(6)
    v_mfma_f32_32x32x16_bf16 v[48:63], v[128:131], v[84:87], v[48:63]
    ds_read_b64_tr_b16 v[120:121], v9 offset:45056
    ds_read_b64_tr_b16 v[122:123], v9 offset:45312
    v_mfma_f32_32x32x16_bf16 v[188:203], v[128:131], v[224:227], v[188:203]
    s_waitcnt lgkmcnt(6)
    v_mfma_f32_32x32x16_bf16 v[64:79], v[84:87], v[132:135], v[64:79]
    v_mfma_f32_32x32x16_bf16 v[204:219], v[224:227], v[132:135], v[204:219]
    s_waitcnt lgkmcnt(4)
    v_mfma_f32_32x32x16_bf16 v[32:47], v[112:115], v[88:91], v[32:47]
    ds_read_b64_tr_b16 v[124:125], v9 offset:46080
    ds_read_b64_tr_b16 v[126:127], v9 offset:46336
    v_mfma_f32_32x32x16_bf16 v[172:187], v[112:115], v[228:231], v[172:187]
    ds_read_b64_tr_b16 v[128:129], v9 offset:47104
    ds_read_b64_tr_b16 v[130:131], v9 offset:47360
    s_waitcnt lgkmcnt(6)
    v_mfma_f32_32x32x16_bf16 v[48:63], v[116:119], v[88:91], v[48:63]
    ds_read_b64_tr_b16 v[132:133], v9 offset:48128
    ds_read_b64_tr_b16 v[134:135], v9 offset:48384
    v_mfma_f32_32x32x16_bf16 v[188:203], v[116:119], v[228:231], v[188:203]
    s_waitcnt lgkmcnt(6)
    v_mfma_f32_32x32x16_bf16 v[64:79], v[88:91], v[120:123], v[64:79]
    v_mfma_f32_32x32x16_bf16 v[204:219], v[228:231], v[120:123], v[204:219]
    s_waitcnt lgkmcnt(0)
    s_barrier
    v_mfma_f32_32x32x16_bf16 v[32:47], v[124:127], v[92:95], v[32:47]
    ds_read_b128 v[96:99], v10 offset:0
    ds_read_b64_tr_b16 v[112:113], v9 offset:49152
    ds_read_b64_tr_b16 v[114:115], v9 offset:49408
    v_mfma_f32_32x32x16_bf16 v[172:187], v[124:127], v[232:235], v[172:187]
    ds_read_b128 v[236:239], v10 offset:49152
    ds_read_b64_tr_b16 v[116:117], v9 offset:50176
    ds_read_b64_tr_b16 v[118:119], v9 offset:50432
    v_mfma_f32_32x32x16_bf16 v[48:63], v[128:131], v[92:95], v[48:63]
    ds_read_b64_tr_b16 v[120:121], v9 offset:51200
    ds_read_b64_tr_b16 v[122:123], v9 offset:51456
    v_mfma_f32_32x32x16_bf16 v[188:203], v[128:131], v[232:235], v[188:203]
    ds_read_b128 v[100:103], v11 offset:0
    ds_read_b128 v[240:243], v11 offset:49152
    v_mfma_f32_32x32x16_bf16 v[64:79], v[92:95], v[132:135], v[64:79]
    ds_read_b128 v[104:107], v12 offset:0
    ds_read_b128 v[244:247], v12 offset:49152
    v_mfma_f32_32x32x16_bf16 v[204:219], v[232:235], v[132:135], v[204:219]
    ds_read_b128 v[108:111], v13 offset:0
    ds_read_b128 v[248:251], v13 offset:49152
    s_waitcnt lgkmcnt(11)
    v_mfma_f32_32x32x16_bf16 v[32:47], v[112:115], v[96:99], v[32:47]
    ds_read_b64_tr_b16 v[124:125], v9 offset:52224
    ds_read_b64_tr_b16 v[126:127], v9 offset:52480
    s_waitcnt lgkmcnt(12)
    v_mfma_f32_32x32x16_bf16 v[172:187], v[112:115], v[236:239], v[172:187]
    ds_read_b64_tr_b16 v[128:129], v9 offset:53248
    ds_read_b64_tr_b16 v[130:131], v9 offset:53504
    s_waitcnt lgkmcnt(12)
    v_mfma_f32_32x32x16_bf16 v[48:63], v[116:119], v[96:99], v[48:63]
    ds_read_b64_tr_b16 v[132:133], v9 offset:54272
    ds_read_b64_tr_b16 v[134:135], v9 offset:54528
    v_mfma_f32_32x32x16_bf16 v[188:203], v[116:119], v[236:239], v[188:203]
    s_waitcnt lgkmcnt(12)
    v_mfma_f32_32x32x16_bf16 v[64:79], v[96:99], v[120:123], v[64:79]
    v_mfma_f32_32x32x16_bf16 v[204:219], v[236:239], v[120:123], v[204:219]
    s_waitcnt lgkmcnt(4)
    v_mfma_f32_32x32x16_bf16 v[32:47], v[124:127], v[100:103], v[32:47]
    ds_read_b64_tr_b16 v[112:113], v9 offset:55296
    ds_read_b64_tr_b16 v[114:115], v9 offset:55552
    v_mfma_f32_32x32x16_bf16 v[172:187], v[124:127], v[240:243], v[172:187]
    ds_read_b64_tr_b16 v[116:117], v9 offset:56320
    ds_read_b64_tr_b16 v[118:119], v9 offset:56576
    s_waitcnt lgkmcnt(6)
    v_mfma_f32_32x32x16_bf16 v[48:63], v[128:131], v[100:103], v[48:63]
    ds_read_b64_tr_b16 v[120:121], v9 offset:57344
    ds_read_b64_tr_b16 v[122:123], v9 offset:57600
    v_mfma_f32_32x32x16_bf16 v[188:203], v[128:131], v[240:243], v[188:203]
    s_waitcnt lgkmcnt(6)
    v_mfma_f32_32x32x16_bf16 v[64:79], v[100:103], v[132:135], v[64:79]
    v_mfma_f32_32x32x16_bf16 v[204:219], v[240:243], v[132:135], v[204:219]
    s_waitcnt lgkmcnt(4)
    v_mfma_f32_32x32x16_bf16 v[32:47], v[112:115], v[104:107], v[32:47]
    ds_read_b64_tr_b16 v[124:125], v9 offset:58368
    ds_read_b64_tr_b16 v[126:127], v9 offset:58624
    v_mfma_f32_32x32x16_bf16 v[172:187], v[112:115], v[244:247], v[172:187]
    ds_read_b64_tr_b16 v[128:129], v9 offset:59392
    ds_read_b64_tr_b16 v[130:131], v9 offset:59648
    s_waitcnt lgkmcnt(6)
    v_mfma_f32_32x32x16_bf16 v[48:63], v[116:119], v[104:107], v[48:63]
    ds_read_b64_tr_b16 v[132:133], v9 offset:60416
    ds_read_b64_tr_b16 v[134:135], v9 offset:60672
    v_mfma_f32_32x32x16_bf16 v[188:203], v[116:119], v[244:247], v[188:203]
    s_waitcnt lgkmcnt(6)
    v_mfma_f32_32x32x16_bf16 v[64:79], v[104:107], v[120:123], v[64:79]
    v_mfma_f32_32x32x16_bf16 v[204:219], v[244:247], v[120:123], v[204:219]
    s_waitcnt lgkmcnt(0)
    s_barrier
    v_mfma_f32_32x32x16_bf16 v[32:47], v[124:127], v[108:111], v[32:47]
    ds_read_b128 v[80:83], v10 offset:4096
    ds_read_b64_tr_b16 v[112:113], v9 offset:0
    ds_read_b64_tr_b16 v[114:115], v9 offset:256
    v_mfma_f32_32x32x16_bf16 v[172:187], v[124:127], v[248:251], v[172:187]
    ds_read_b128 v[220:223], v10 offset:53248
    ds_read_b64_tr_b16 v[116:117], v9 offset:1024
    ds_read_b64_tr_b16 v[118:119], v9 offset:1280
    v_mfma_f32_32x32x16_bf16 v[48:63], v[128:131], v[108:111], v[48:63]
    ds_read_b64_tr_b16 v[120:121], v9 offset:2048
    ds_read_b64_tr_b16 v[122:123], v9 offset:2304
    v_mfma_f32_32x32x16_bf16 v[188:203], v[128:131], v[248:251], v[188:203]
    ds_read_b128 v[84:87], v11 offset:4096
    ds_read_b128 v[224:227], v11 offset:53248
    v_mfma_f32_32x32x16_bf16 v[64:79], v[108:111], v[132:135], v[64:79]
    ds_read_b128 v[88:91], v12 offset:4096
    ds_read_b128 v[228:231], v12 offset:53248
    v_mfma_f32_32x32x16_bf16 v[204:219], v[248:251], v[132:135], v[204:219]
    ds_read_b128 v[92:95], v13 offset:4096
    ds_read_b128 v[232:235], v13 offset:53248
    s_waitcnt lgkmcnt(11)
    v_mfma_f32_32x32x16_bf16 v[32:47], v[112:115], v[80:83], v[32:47]
    ds_read_b64_tr_b16 v[124:125], v9 offset:3072
    ds_read_b64_tr_b16 v[126:127], v9 offset:3328
    s_waitcnt lgkmcnt(12)
    v_mfma_f32_32x32x16_bf16 v[172:187], v[112:115], v[220:223], v[172:187]
    ds_read_b64_tr_b16 v[128:129], v9 offset:4096
    ds_read_b64_tr_b16 v[130:131], v9 offset:4352
    s_waitcnt lgkmcnt(12)
    v_mfma_f32_32x32x16_bf16 v[48:63], v[116:119], v[80:83], v[48:63]
    ds_read_b64_tr_b16 v[132:133], v9 offset:5120
    ds_read_b64_tr_b16 v[134:135], v9 offset:5376
    v_mfma_f32_32x32x16_bf16 v[188:203], v[116:119], v[220:223], v[188:203]
    s_waitcnt lgkmcnt(12)
    v_mfma_f32_32x32x16_bf16 v[64:79], v[80:83], v[120:123], v[64:79]
    v_mfma_f32_32x32x16_bf16 v[204:219], v[220:223], v[120:123], v[204:219]
    s_waitcnt lgkmcnt(4)
    v_mfma_f32_32x32x16_bf16 v[32:47], v[124:127], v[84:87], v[32:47]
    ds_read_b64_tr_b16 v[112:113], v9 offset:6144
    ds_read_b64_tr_b16 v[114:115], v9 offset:6400
    v_mfma_f32_32x32x16_bf16 v[172:187], v[124:127], v[224:227], v[172:187]
    ds_read_b64_tr_b16 v[116:117], v9 offset:7168
    ds_read_b64_tr_b16 v[118:119], v9 offset:7424
    s_waitcnt lgkmcnt(6)
    v_mfma_f32_32x32x16_bf16 v[48:63], v[128:131], v[84:87], v[48:63]
    ds_read_b64_tr_b16 v[120:121], v9 offset:8192
    ds_read_b64_tr_b16 v[122:123], v9 offset:8448
    v_mfma_f32_32x32x16_bf16 v[188:203], v[128:131], v[224:227], v[188:203]
    s_waitcnt lgkmcnt(6)
    v_mfma_f32_32x32x16_bf16 v[64:79], v[84:87], v[132:135], v[64:79]
    v_mfma_f32_32x32x16_bf16 v[204:219], v[224:227], v[132:135], v[204:219]
    s_waitcnt lgkmcnt(4)
    v_mfma_f32_32x32x16_bf16 v[32:47], v[112:115], v[88:91], v[32:47]
    ds_read_b64_tr_b16 v[124:125], v9 offset:9216
    ds_read_b64_tr_b16 v[126:127], v9 offset:9472
    v_mfma_f32_32x32x16_bf16 v[172:187], v[112:115], v[228:231], v[172:187]
    ds_read_b64_tr_b16 v[128:129], v9 offset:10240
    ds_read_b64_tr_b16 v[130:131], v9 offset:10496
    s_waitcnt lgkmcnt(6)
    v_mfma_f32_32x32x16_bf16 v[48:63], v[116:119], v[88:91], v[48:63]
    ds_read_b64_tr_b16 v[132:133], v9 offset:11264
    ds_read_b64_tr_b16 v[134:135], v9 offset:11520
    v_mfma_f32_32x32x16_bf16 v[188:203], v[116:119], v[228:231], v[188:203]
    s_waitcnt lgkmcnt(6)
    v_mfma_f32_32x32x16_bf16 v[64:79], v[88:91], v[120:123], v[64:79]
    v_mfma_f32_32x32x16_bf16 v[204:219], v[228:231], v[120:123], v[204:219]
    s_waitcnt lgkmcnt(0)
    s_barrier
    v_mfma_f32_32x32x16_bf16 v[32:47], v[124:127], v[92:95], v[32:47]
    ds_read_b128 v[96:99], v10 offset:8192
    ds_read_b64_tr_b16 v[112:113], v9 offset:12288
    ds_read_b64_tr_b16 v[114:115], v9 offset:12544
    v_mfma_f32_32x32x16_bf16 v[172:187], v[124:127], v[232:235], v[172:187]
    ds_read_b128 v[236:239], v10 offset:57344
    ds_read_b64_tr_b16 v[116:117], v9 offset:13312
    ds_read_b64_tr_b16 v[118:119], v9 offset:13568
    v_mfma_f32_32x32x16_bf16 v[48:63], v[128:131], v[92:95], v[48:63]
    ds_read_b64_tr_b16 v[120:121], v9 offset:14336
    ds_read_b64_tr_b16 v[122:123], v9 offset:14592
    v_mfma_f32_32x32x16_bf16 v[188:203], v[128:131], v[232:235], v[188:203]
    ds_read_b128 v[100:103], v11 offset:8192
    ds_read_b128 v[240:243], v11 offset:57344
    v_mfma_f32_32x32x16_bf16 v[64:79], v[92:95], v[132:135], v[64:79]
    ds_read_b128 v[104:107], v12 offset:8192
    ds_read_b128 v[244:247], v12 offset:57344
    v_mfma_f32_32x32x16_bf16 v[204:219], v[232:235], v[132:135], v[204:219]
    ds_read_b128 v[108:111], v13 offset:8192
    ds_read_b128 v[248:251], v13 offset:57344
    s_waitcnt lgkmcnt(11)
    v_mfma_f32_32x32x16_bf16 v[32:47], v[112:115], v[96:99], v[32:47]
    ds_read_b64_tr_b16 v[124:125], v9 offset:15360
    ds_read_b64_tr_b16 v[126:127], v9 offset:15616
    s_waitcnt lgkmcnt(12)
    v_mfma_f32_32x32x16_bf16 v[172:187], v[112:115], v[236:239], v[172:187]
    ds_read_b64_tr_b16 v[128:129], v9 offset:16384
    ds_read_b64_tr_b16 v[130:131], v9 offset:16640
    s_waitcnt lgkmcnt(12)
    v_mfma_f32_32x32x16_bf16 v[48:63], v[116:119], v[96:99], v[48:63]
    ds_read_b64_tr_b16 v[132:133], v9 offset:17408
    ds_read_b64_tr_b16 v[134:135], v9 offset:17664
    v_mfma_f32_32x32x16_bf16 v[188:203], v[116:119], v[236:239], v[188:203]
    s_waitcnt lgkmcnt(12)
    v_mfma_f32_32x32x16_bf16 v[64:79], v[96:99], v[120:123], v[64:79]
    v_mfma_f32_32x32x16_bf16 v[204:219], v[236:239], v[120:123], v[204:219]
    s_waitcnt lgkmcnt(4)
    v_mfma_f32_32x32x16_bf16 v[32:47], v[124:127], v[100:103], v[32:47]
    ds_read_b64_tr_b16 v[112:113], v9 offset:18432
    ds_read_b64_tr_b16 v[114:115], v9 offset:18688
    v_mfma_f32_32x32x16_bf16 v[172:187], v[124:127], v[240:243], v[172:187]
    ds_read_b64_tr_b16 v[116:117], v9 offset:19456
    ds_read_b64_tr_b16 v[118:119], v9 offset:19712
    s_waitcnt lgkmcnt(6)
    v_mfma_f32_32x32x16_bf16 v[48:63], v[128:131], v[100:103], v[48:63]
    ds_read_b64_tr_b16 v[120:121], v9 offset:20480
    ds_read_b64_tr_b16 v[122:123], v9 offset:20736
    v_mfma_f32_32x32x16_bf16 v[188:203], v[128:131], v[240:243], v[188:203]
    s_waitcnt lgkmcnt(6)
    v_mfma_f32_32x32x16_bf16 v[64:79], v[100:103], v[132:135], v[64:79]
    v_mfma_f32_32x32x16_bf16 v[204:219], v[240:243], v[132:135], v[204:219]
    s_waitcnt lgkmcnt(4)
    v_mfma_f32_32x32x16_bf16 v[32:47], v[112:115], v[104:107], v[32:47]
    ds_read_b64_tr_b16 v[124:125], v9 offset:21504
    ds_read_b64_tr_b16 v[126:127], v9 offset:21760
    v_mfma_f32_32x32x16_bf16 v[172:187], v[112:115], v[244:247], v[172:187]
    ds_read_b64_tr_b16 v[128:129], v9 offset:22528
    ds_read_b64_tr_b16 v[130:131], v9 offset:22784
    s_waitcnt lgkmcnt(6)
    v_mfma_f32_32x32x16_bf16 v[48:63], v[116:119], v[104:107], v[48:63]
    ds_read_b64_tr_b16 v[132:133], v9 offset:23552
    ds_read_b64_tr_b16 v[134:135], v9 offset:23808
    v_mfma_f32_32x32x16_bf16 v[188:203], v[116:119], v[244:247], v[188:203]
    s_waitcnt lgkmcnt(6)
    v_mfma_f32_32x32x16_bf16 v[64:79], v[104:107], v[120:123], v[64:79]
    v_mfma_f32_32x32x16_bf16 v[204:219], v[244:247], v[120:123], v[204:219]
    s_waitcnt lgkmcnt(0)
    s_barrier
    v_mfma_f32_32x32x16_bf16 v[32:47], v[124:127], v[108:111], v[32:47]
    ds_read_b128 v[80:83], v10 offset:0
    ds_read_b64_tr_b16 v[112:113], v9 offset:24576
    ds_read_b64_tr_b16 v[114:115], v9 offset:24832
    v_mfma_f32_32x32x16_bf16 v[172:187], v[124:127], v[248:251], v[172:187]
    ds_read_b128 v[220:223], v10 offset:49152
    ds_read_b64_tr_b16 v[116:117], v9 offset:25600
    ds_read_b64_tr_b16 v[118:119], v9 offset:25856
    v_mfma_f32_32x32x16_bf16 v[48:63], v[128:131], v[108:111], v[48:63]
    ds_read_b64_tr_b16 v[120:121], v9 offset:26624
    ds_read_b64_tr_b16 v[122:123], v9 offset:26880
    v_mfma_f32_32x32x16_bf16 v[188:203], v[128:131], v[248:251], v[188:203]
    ds_read_b128 v[84:87], v11 offset:0
    ds_read_b128 v[224:227], v11 offset:49152
    v_mfma_f32_32x32x16_bf16 v[64:79], v[108:111], v[132:135], v[64:79]
    ds_read_b128 v[88:91], v12 offset:0
    ds_read_b128 v[228:231], v12 offset:49152
    v_mfma_f32_32x32x16_bf16 v[204:219], v[248:251], v[132:135], v[204:219]
    ds_read_b128 v[92:95], v13 offset:0
    ds_read_b128 v[232:235], v13 offset:49152
    s_waitcnt lgkmcnt(11)
    v_mfma_f32_32x32x16_bf16 v[32:47], v[112:115], v[80:83], v[32:47]
    ds_read_b64_tr_b16 v[124:125], v9 offset:27648
    ds_read_b64_tr_b16 v[126:127], v9 offset:27904
    s_waitcnt lgkmcnt(12)
    v_mfma_f32_32x32x16_bf16 v[172:187], v[112:115], v[220:223], v[172:187]
    ds_read_b64_tr_b16 v[128:129], v9 offset:28672
    ds_read_b64_tr_b16 v[130:131], v9 offset:28928
    s_waitcnt lgkmcnt(12)
    v_mfma_f32_32x32x16_bf16 v[48:63], v[116:119], v[80:83], v[48:63]
    ds_read_b64_tr_b16 v[132:133], v9 offset:29696
    ds_read_b64_tr_b16 v[134:135], v9 offset:29952
    v_mfma_f32_32x32x16_bf16 v[188:203], v[116:119], v[220:223], v[188:203]
    s_waitcnt lgkmcnt(12)
    v_mfma_f32_32x32x16_bf16 v[64:79], v[80:83], v[120:123], v[64:79]
    v_mfma_f32_32x32x16_bf16 v[204:219], v[220:223], v[120:123], v[204:219]
    s_waitcnt lgkmcnt(4)
    v_mfma_f32_32x32x16_bf16 v[32:47], v[124:127], v[84:87], v[32:47]
    ds_read_b64_tr_b16 v[112:113], v9 offset:30720
    ds_read_b64_tr_b16 v[114:115], v9 offset:30976
    v_mfma_f32_32x32x16_bf16 v[172:187], v[124:127], v[224:227], v[172:187]
    ds_read_b64_tr_b16 v[116:117], v9 offset:31744
    ds_read_b64_tr_b16 v[118:119], v9 offset:32000
    s_waitcnt lgkmcnt(6)
    v_mfma_f32_32x32x16_bf16 v[48:63], v[128:131], v[84:87], v[48:63]
    ds_read_b64_tr_b16 v[120:121], v9 offset:32768
    ds_read_b64_tr_b16 v[122:123], v9 offset:33024
    v_mfma_f32_32x32x16_bf16 v[188:203], v[128:131], v[224:227], v[188:203]
    s_waitcnt lgkmcnt(6)
    v_mfma_f32_32x32x16_bf16 v[64:79], v[84:87], v[132:135], v[64:79]
    v_mfma_f32_32x32x16_bf16 v[204:219], v[224:227], v[132:135], v[204:219]
    s_waitcnt lgkmcnt(4)
    v_mfma_f32_32x32x16_bf16 v[32:47], v[112:115], v[88:91], v[32:47]
    ds_read_b64_tr_b16 v[124:125], v9 offset:33792
    ds_read_b64_tr_b16 v[126:127], v9 offset:34048
    v_mfma_f32_32x32x16_bf16 v[172:187], v[112:115], v[228:231], v[172:187]
    ds_read_b64_tr_b16 v[128:129], v9 offset:34816
    ds_read_b64_tr_b16 v[130:131], v9 offset:35072
    s_waitcnt lgkmcnt(6)
    v_mfma_f32_32x32x16_bf16 v[48:63], v[116:119], v[88:91], v[48:63]
    ds_read_b64_tr_b16 v[132:133], v9 offset:35840
    ds_read_b64_tr_b16 v[134:135], v9 offset:36096
    v_mfma_f32_32x32x16_bf16 v[188:203], v[116:119], v[228:231], v[188:203]
    s_waitcnt lgkmcnt(6)
    v_mfma_f32_32x32x16_bf16 v[64:79], v[88:91], v[120:123], v[64:79]
    v_mfma_f32_32x32x16_bf16 v[204:219], v[228:231], v[120:123], v[204:219]
    s_waitcnt lgkmcnt(0)
    s_barrier
    v_mfma_f32_32x32x16_bf16 v[32:47], v[124:127], v[92:95], v[32:47]
    ds_read_b128 v[96:99], v10 offset:4096
    ds_read_b64_tr_b16 v[112:113], v9 offset:36864
    ds_read_b64_tr_b16 v[114:115], v9 offset:37120
    v_mfma_f32_32x32x16_bf16 v[172:187], v[124:127], v[232:235], v[172:187]
    ds_read_b128 v[236:239], v10 offset:53248
    ds_read_b64_tr_b16 v[116:117], v9 offset:37888
    ds_read_b64_tr_b16 v[118:119], v9 offset:38144
    v_mfma_f32_32x32x16_bf16 v[48:63], v[128:131], v[92:95], v[48:63]
    ds_read_b64_tr_b16 v[120:121], v9 offset:38912
    ds_read_b64_tr_b16 v[122:123], v9 offset:39168
    v_mfma_f32_32x32x16_bf16 v[188:203], v[128:131], v[232:235], v[188:203]
    ds_read_b128 v[100:103], v11 offset:4096
    ds_read_b128 v[240:243], v11 offset:53248
    v_mfma_f32_32x32x16_bf16 v[64:79], v[92:95], v[132:135], v[64:79]
    ds_read_b128 v[104:107], v12 offset:4096
    ds_read_b128 v[244:247], v12 offset:53248
    v_mfma_f32_32x32x16_bf16 v[204:219], v[232:235], v[132:135], v[204:219]
    ds_read_b128 v[108:111], v13 offset:4096
    ds_read_b128 v[248:251], v13 offset:53248
    s_waitcnt lgkmcnt(11)
    v_mfma_f32_32x32x16_bf16 v[32:47], v[112:115], v[96:99], v[32:47]
    ds_read_b64_tr_b16 v[124:125], v9 offset:39936
    ds_read_b64_tr_b16 v[126:127], v9 offset:40192
    s_waitcnt lgkmcnt(12)
    v_mfma_f32_32x32x16_bf16 v[172:187], v[112:115], v[236:239], v[172:187]
    ds_read_b64_tr_b16 v[128:129], v9 offset:40960
    ds_read_b64_tr_b16 v[130:131], v9 offset:41216
    s_waitcnt lgkmcnt(12)
    v_mfma_f32_32x32x16_bf16 v[48:63], v[116:119], v[96:99], v[48:63]
    ds_read_b64_tr_b16 v[132:133], v9 offset:41984
    ds_read_b64_tr_b16 v[134:135], v9 offset:42240
    v_mfma_f32_32x32x16_bf16 v[188:203], v[116:119], v[236:239], v[188:203]
    s_waitcnt lgkmcnt(12)
    v_mfma_f32_32x32x16_bf16 v[64:79], v[96:99], v[120:123], v[64:79]
    v_mfma_f32_32x32x16_bf16 v[204:219], v[236:239], v[120:123], v[204:219]
    s_waitcnt lgkmcnt(4)
    v_mfma_f32_32x32x16_bf16 v[32:47], v[124:127], v[100:103], v[32:47]
    ds_read_b64_tr_b16 v[112:113], v9 offset:43008
    ds_read_b64_tr_b16 v[114:115], v9 offset:43264
    v_mfma_f32_32x32x16_bf16 v[172:187], v[124:127], v[240:243], v[172:187]
    ds_read_b64_tr_b16 v[116:117], v9 offset:44032
    ds_read_b64_tr_b16 v[118:119], v9 offset:44288
    s_waitcnt lgkmcnt(6)
    v_mfma_f32_32x32x16_bf16 v[48:63], v[128:131], v[100:103], v[48:63]
    ds_read_b64_tr_b16 v[120:121], v9 offset:45056
    ds_read_b64_tr_b16 v[122:123], v9 offset:45312
    v_mfma_f32_32x32x16_bf16 v[188:203], v[128:131], v[240:243], v[188:203]
    s_waitcnt lgkmcnt(6)
    v_mfma_f32_32x32x16_bf16 v[64:79], v[100:103], v[132:135], v[64:79]
    v_mfma_f32_32x32x16_bf16 v[204:219], v[240:243], v[132:135], v[204:219]
    s_waitcnt lgkmcnt(4)
    v_mfma_f32_32x32x16_bf16 v[32:47], v[112:115], v[104:107], v[32:47]
    ds_read_b64_tr_b16 v[124:125], v9 offset:46080
    ds_read_b64_tr_b16 v[126:127], v9 offset:46336
    v_mfma_f32_32x32x16_bf16 v[172:187], v[112:115], v[244:247], v[172:187]
    ds_read_b64_tr_b16 v[128:129], v9 offset:47104
    ds_read_b64_tr_b16 v[130:131], v9 offset:47360
    s_waitcnt lgkmcnt(6)
    v_mfma_f32_32x32x16_bf16 v[48:63], v[116:119], v[104:107], v[48:63]
    ds_read_b64_tr_b16 v[132:133], v9 offset:48128
    ds_read_b64_tr_b16 v[134:135], v9 offset:48384
    v_mfma_f32_32x32x16_bf16 v[188:203], v[116:119], v[244:247], v[188:203]
    s_waitcnt lgkmcnt(6)
    v_mfma_f32_32x32x16_bf16 v[64:79], v[104:107], v[120:123], v[64:79]
    v_mfma_f32_32x32x16_bf16 v[204:219], v[244:247], v[120:123], v[204:219]
    s_waitcnt lgkmcnt(0)
    s_barrier
    v_mfma_f32_32x32x16_bf16 v[32:47], v[124:127], v[108:111], v[32:47]
    ds_read_b128 v[80:83], v10 offset:8192
    ds_read_b64_tr_b16 v[112:113], v9 offset:49152
    ds_read_b64_tr_b16 v[114:115], v9 offset:49408
    v_mfma_f32_32x32x16_bf16 v[172:187], v[124:127], v[248:251], v[172:187]
    ds_read_b128 v[220:223], v10 offset:57344
    ds_read_b64_tr_b16 v[116:117], v9 offset:50176
    ds_read_b64_tr_b16 v[118:119], v9 offset:50432
    v_mfma_f32_32x32x16_bf16 v[48:63], v[128:131], v[108:111], v[48:63]
    ds_read_b64_tr_b16 v[120:121], v9 offset:51200
    ds_read_b64_tr_b16 v[122:123], v9 offset:51456
    v_mfma_f32_32x32x16_bf16 v[188:203], v[128:131], v[248:251], v[188:203]
    ds_read_b128 v[84:87], v11 offset:8192
    ds_read_b128 v[224:227], v11 offset:57344
    v_mfma_f32_32x32x16_bf16 v[64:79], v[108:111], v[132:135], v[64:79]
    ds_read_b128 v[88:91], v12 offset:8192
    ds_read_b128 v[228:231], v12 offset:57344
    v_mfma_f32_32x32x16_bf16 v[204:219], v[248:251], v[132:135], v[204:219]
    ds_read_b128 v[92:95], v13 offset:8192
    ds_read_b128 v[232:235], v13 offset:57344
    s_waitcnt lgkmcnt(11)
    v_mfma_f32_32x32x16_bf16 v[32:47], v[112:115], v[80:83], v[32:47]
    ds_read_b64_tr_b16 v[124:125], v9 offset:52224
    ds_read_b64_tr_b16 v[126:127], v9 offset:52480
    s_waitcnt lgkmcnt(12)
    v_mfma_f32_32x32x16_bf16 v[172:187], v[112:115], v[220:223], v[172:187]
    ds_read_b64_tr_b16 v[128:129], v9 offset:53248
    ds_read_b64_tr_b16 v[130:131], v9 offset:53504
    s_waitcnt lgkmcnt(12)
    v_mfma_f32_32x32x16_bf16 v[48:63], v[116:119], v[80:83], v[48:63]
    ds_read_b64_tr_b16 v[132:133], v9 offset:54272
    ds_read_b64_tr_b16 v[134:135], v9 offset:54528
    v_mfma_f32_32x32x16_bf16 v[188:203], v[116:119], v[220:223], v[188:203]
    s_waitcnt lgkmcnt(12)
    v_mfma_f32_32x32x16_bf16 v[64:79], v[80:83], v[120:123], v[64:79]
    v_mfma_f32_32x32x16_bf16 v[204:219], v[220:223], v[120:123], v[204:219]
    s_waitcnt lgkmcnt(4)
    v_mfma_f32_32x32x16_bf16 v[32:47], v[124:127], v[84:87], v[32:47]
    ds_read_b64_tr_b16 v[112:113], v9 offset:55296
    ds_read_b64_tr_b16 v[114:115], v9 offset:55552
    v_mfma_f32_32x32x16_bf16 v[172:187], v[124:127], v[224:227], v[172:187]
    ds_read_b64_tr_b16 v[116:117], v9 offset:56320
    ds_read_b64_tr_b16 v[118:119], v9 offset:56576
    s_waitcnt lgkmcnt(6)
    v_mfma_f32_32x32x16_bf16 v[48:63], v[128:131], v[84:87], v[48:63]
    ds_read_b64_tr_b16 v[120:121], v9 offset:57344
    ds_read_b64_tr_b16 v[122:123], v9 offset:57600
    v_mfma_f32_32x32x16_bf16 v[188:203], v[128:131], v[224:227], v[188:203]
    s_waitcnt lgkmcnt(6)
    v_mfma_f32_32x32x16_bf16 v[64:79], v[84:87], v[132:135], v[64:79]
    v_mfma_f32_32x32x16_bf16 v[204:219], v[224:227], v[132:135], v[204:219]
    s_waitcnt lgkmcnt(4)
    v_mfma_f32_32x32x16_bf16 v[32:47], v[112:115], v[88:91], v[32:47]
    ds_read_b64_tr_b16 v[124:125], v9 offset:58368
    ds_read_b64_tr_b16 v[126:127], v9 offset:58624
    v_mfma_f32_32x32x16_bf16 v[172:187], v[112:115], v[228:231], v[172:187]
    ds_read_b64_tr_b16 v[128:129], v9 offset:59392
    ds_read_b64_tr_b16 v[130:131], v9 offset:59648
    s_waitcnt lgkmcnt(6)
    v_mfma_f32_32x32x16_bf16 v[48:63], v[116:119], v[88:91], v[48:63]
    ds_read_b64_tr_b16 v[132:133], v9 offset:60416
    ds_read_b64_tr_b16 v[134:135], v9 offset:60672
    v_mfma_f32_32x32x16_bf16 v[188:203], v[116:119], v[228:231], v[188:203]
    s_waitcnt lgkmcnt(6)
    v_mfma_f32_32x32x16_bf16 v[64:79], v[88:91], v[120:123], v[64:79]
    v_mfma_f32_32x32x16_bf16 v[204:219], v[228:231], v[120:123], v[204:219]
    s_waitcnt lgkmcnt(0)
    s_barrier
    v_mfma_f32_32x32x16_bf16 v[32:47], v[124:127], v[92:95], v[32:47]
    ds_read_b128 v[96:99], v10 offset:0
    ds_read_b64_tr_b16 v[112:113], v9 offset:0
    ds_read_b64_tr_b16 v[114:115], v9 offset:256
    v_mfma_f32_32x32x16_bf16 v[172:187], v[124:127], v[232:235], v[172:187]
    ds_read_b128 v[236:239], v10 offset:49152
    ds_read_b64_tr_b16 v[116:117], v9 offset:1024
    ds_read_b64_tr_b16 v[118:119], v9 offset:1280
    v_mfma_f32_32x32x16_bf16 v[48:63], v[128:131], v[92:95], v[48:63]
    ds_read_b64_tr_b16 v[120:121], v9 offset:2048
    ds_read_b64_tr_b16 v[122:123], v9 offset:2304
    v_mfma_f32_32x32x16_bf16 v[188:203], v[128:131], v[232:235], v[188:203]
    ds_read_b128 v[100:103], v11 offset:0
    ds_read_b128 v[240:243], v11 offset:49152
    v_mfma_f32_32x32x16_bf16 v[64:79], v[92:95], v[132:135], v[64:79]
    ds_read_b128 v[104:107], v12 offset:0
    ds_read_b128 v[244:247], v12 offset:49152
    v_mfma_f32_32x32x16_bf16 v[204:219], v[232:235], v[132:135], v[204:219]
    ds_read_b128 v[108:111], v13 offset:0
    ds_read_b128 v[248:251], v13 offset:49152
    s_waitcnt lgkmcnt(11)
    v_mfma_f32_32x32x16_bf16 v[32:47], v[112:115], v[96:99], v[32:47]
    ds_read_b64_tr_b16 v[124:125], v9 offset:3072
    ds_read_b64_tr_b16 v[126:127], v9 offset:3328
    s_waitcnt lgkmcnt(12)
    v_mfma_f32_32x32x16_bf16 v[172:187], v[112:115], v[236:239], v[172:187]
    ds_read_b64_tr_b16 v[128:129], v9 offset:4096
    ds_read_b64_tr_b16 v[130:131], v9 offset:4352
    s_waitcnt lgkmcnt(12)
    v_mfma_f32_32x32x16_bf16 v[48:63], v[116:119], v[96:99], v[48:63]
    ds_read_b64_tr_b16 v[132:133], v9 offset:5120
    ds_read_b64_tr_b16 v[134:135], v9 offset:5376
    v_mfma_f32_32x32x16_bf16 v[188:203], v[116:119], v[236:239], v[188:203]
    s_waitcnt lgkmcnt(12)
    v_mfma_f32_32x32x16_bf16 v[64:79], v[96:99], v[120:123], v[64:79]
    v_mfma_f32_32x32x16_bf16 v[204:219], v[236:239], v[120:123], v[204:219]
    s_waitcnt lgkmcnt(4)
    v_mfma_f32_32x32x16_bf16 v[32:47], v[124:127], v[100:103], v[32:47]
    ds_read_b64_tr_b16 v[112:113], v9 offset:6144
    ds_read_b64_tr_b16 v[114:115], v9 offset:6400
    v_mfma_f32_32x32x16_bf16 v[172:187], v[124:127], v[240:243], v[172:187]
    ds_read_b64_tr_b16 v[116:117], v9 offset:7168
    ds_read_b64_tr_b16 v[118:119], v9 offset:7424
    s_waitcnt lgkmcnt(6)
    v_mfma_f32_32x32x16_bf16 v[48:63], v[128:131], v[100:103], v[48:63]
    ds_read_b64_tr_b16 v[120:121], v9 offset:8192
    ds_read_b64_tr_b16 v[122:123], v9 offset:8448
    v_mfma_f32_32x32x16_bf16 v[188:203], v[128:131], v[240:243], v[188:203]
    s_waitcnt lgkmcnt(6)
    v_mfma_f32_32x32x16_bf16 v[64:79], v[100:103], v[132:135], v[64:79]
    v_mfma_f32_32x32x16_bf16 v[204:219], v[240:243], v[132:135], v[204:219]
    s_waitcnt lgkmcnt(4)
    v_mfma_f32_32x32x16_bf16 v[32:47], v[112:115], v[104:107], v[32:47]
    ds_read_b64_tr_b16 v[124:125], v9 offset:9216
    ds_read_b64_tr_b16 v[126:127], v9 offset:9472
    v_mfma_f32_32x32x16_bf16 v[172:187], v[112:115], v[244:247], v[172:187]
    ds_read_b64_tr_b16 v[128:129], v9 offset:10240
    ds_read_b64_tr_b16 v[130:131], v9 offset:10496
    s_waitcnt lgkmcnt(6)
    v_mfma_f32_32x32x16_bf16 v[48:63], v[116:119], v[104:107], v[48:63]
    ds_read_b64_tr_b16 v[132:133], v9 offset:11264
    ds_read_b64_tr_b16 v[134:135], v9 offset:11520
    v_mfma_f32_32x32x16_bf16 v[188:203], v[116:119], v[244:247], v[188:203]
    s_waitcnt lgkmcnt(6)
    v_mfma_f32_32x32x16_bf16 v[64:79], v[104:107], v[120:123], v[64:79]
    v_mfma_f32_32x32x16_bf16 v[204:219], v[244:247], v[120:123], v[204:219]
    s_waitcnt lgkmcnt(4)
    v_mfma_f32_32x32x16_bf16 v[32:47], v[124:127], v[108:111], v[32:47]
    v_mfma_f32_32x32x16_bf16 v[172:187], v[124:127], v[248:251], v[172:187]
    s_waitcnt lgkmcnt(2)
    v_mfma_f32_32x32x16_bf16 v[48:63], v[128:131], v[108:111], v[48:63]
    v_mfma_f32_32x32x16_bf16 v[188:203], v[128:131], v[248:251], v[188:203]
    s_waitcnt lgkmcnt(0)
    v_mfma_f32_32x32x16_bf16 v[64:79], v[108:111], v[132:135], v[64:79]
    v_mfma_f32_32x32x16_bf16 v[204:219], v[248:251], v[132:135], v[204:219]
    s_lshl3_add_u32 s24, s4, s3
    s_lshl_b32 s25, s5, 6
    s_add_u32 s25, s25, s24
    s_lshl_b32 s25, s25, 12
    s_add_u32 s26, s25, 16384
    v_add_u32 v14, s32, v2
    s_nop 1
    v_cvt_pk_bf16_f32 v80, v48, v49
    v_cvt_pk_bf16_f32 v81, v50, v51
    v_cvt_pk_bf16_f32 v82, v52, v53
    v_cvt_pk_bf16_f32 v83, v54, v55
    buffer_store_dwordx4 v[80:83], v2, s[16:19], s25 offen offset:0 sc1
    ds_write_b128 v14, v[80:83] offset:0
    v_cvt_pk_bf16_f32 v84, v56, v57
    v_cvt_pk_bf16_f32 v85, v58, v59
    v_cvt_pk_bf16_f32 v86, v60, v61
    v_cvt_pk_bf16_f32 v87, v62, v63
    buffer_store_dwordx4 v[84:87], v2, s[16:19], s25 offen offset:1024 sc1
    ds_write_b128 v14, v[84:87] offset:1024
    v_cvt_pk_bf16_f32 v88, v64, v65
    v_cvt_pk_bf16_f32 v89, v66, v67
    v_cvt_pk_bf16_f32 v90, v68, v69
    v_cvt_pk_bf16_f32 v91, v70, v71
    buffer_store_dwordx4 v[88:91], v2, s[16:19], s25 offen offset:2048 sc1
    ds_write_b128 v14, v[88:91] offset:2048
    v_cvt_pk_bf16_f32 v92, v72, v73
    v_cvt_pk_bf16_f32 v93, v74, v75
    v_cvt_pk_bf16_f32 v94, v76, v77
    v_cvt_pk_bf16_f32 v95, v78, v79
    buffer_store_dwordx4 v[92:95], v2, s[16:19], s25 offen offset:3072 sc1
    ds_write_b128 v14, v[92:95] offset:3072
    v_cvt_pk_bf16_f32 v96, v188, v189
    v_cvt_pk_bf16_f32 v97, v190, v191
    v_cvt_pk_bf16_f32 v98, v192, v193
    v_cvt_pk_bf16_f32 v99, v194, v195
    buffer_store_dwordx4 v[96:99], v2, s[16:19], s26 offen offset:0 sc1
    ds_write_b128 v14, v[96:99] offset:49152
    v_cvt_pk_bf16_f32 v100, v196, v197
    v_cvt_pk_bf16_f32 v101, v198, v199
    v_cvt_pk_bf16_f32 v102, v200, v201
    v_cvt_pk_bf16_f32 v103, v202, v203
    buffer_store_dwordx4 v[100:103], v2, s[16:19], s26 offen offset:1024 sc1
    ds_write_b128 v14, v[100:103] offset:50176
    v_cvt_pk_bf16_f32 v104, v204, v205
    v_cvt_pk_bf16_f32 v105, v206, v207
    v_cvt_pk_bf16_f32 v106, v208, v209
    v_cvt_pk_bf16_f32 v107, v210, v211
    buffer_store_dwordx4 v[104:107], v2, s[16:19], s26 offen offset:2048 sc1
    ds_write_b128 v14, v[104:107] offset:51200
    v_cvt_pk_bf16_f32 v108, v212, v213
    v_cvt_pk_bf16_f32 v109, v214, v215
    v_cvt_pk_bf16_f32 v110, v216, v217
    v_cvt_pk_bf16_f32 v111, v218, v219
    buffer_store_dwordx4 v[108:111], v2, s[16:19], s26 offen offset:3072 sc1
    ds_write_b128 v14, v[108:111] offset:52224
    s_mov_b32 s24, 0x3e8293ee
    v_mul_f32 v32, s24, v32
    v_mul_f32 v33, s24, v33
    v_mul_f32 v34, s24, v34
    v_mul_f32 v35, s24, v35
    v_mul_f32 v36, s24, v36
    v_mul_f32 v37, s24, v37
    v_mul_f32 v38, s24, v38
    v_mul_f32 v39, s24, v39
    v_cvt_pk_bf16_f32 v112, v32, v33
    v_cvt_pk_bf16_f32 v113, v34, v35
    v_cvt_pk_bf16_f32 v114, v36, v37
    v_cvt_pk_bf16_f32 v115, v38, v39
    ds_write_b128 v14, v[112:115] offset:4096
    v_mul_f32 v40, s24, v40
    v_mul_f32 v41, s24, v41
    v_mul_f32 v42, s24, v42
    v_mul_f32 v43, s24, v43
    v_mul_f32 v44, s24, v44
    v_mul_f32 v45, s24, v45
    v_mul_f32 v46, s24, v46
    v_mul_f32 v47, s24, v47
    v_cvt_pk_bf16_f32 v116, v40, v41
    v_cvt_pk_bf16_f32 v117, v42, v43
    v_cvt_pk_bf16_f32 v118, v44, v45
    v_cvt_pk_bf16_f32 v119, v46, v47
    ds_write_b128 v14, v[116:119] offset:5120
    v_mul_f32 v172, s24, v172
    v_mul_f32 v173, s24, v173
    v_mul_f32 v174, s24, v174
    v_mul_f32 v175, s24, v175
    v_mul_f32 v176, s24, v176
    v_mul_f32 v177, s24, v177
    v_mul_f32 v178, s24, v178
    v_mul_f32 v179, s24, v179
    v_cvt_pk_bf16_f32 v120, v172, v173
    v_cvt_pk_bf16_f32 v121, v174, v175
    v_cvt_pk_bf16_f32 v122, v176, v177
    v_cvt_pk_bf16_f32 v123, v178, v179
    ds_write_b128 v14, v[120:123] offset:53248
    v_mul_f32 v180, s24, v180
    v_mul_f32 v181, s24, v181
    v_mul_f32 v182, s24, v182
    v_mul_f32 v183, s24, v183
    v_mul_f32 v184, s24, v184
    v_mul_f32 v185, s24, v185
    v_mul_f32 v186, s24, v186
    v_mul_f32 v187, s24, v187
    v_cvt_pk_bf16_f32 v124, v180, v181
    v_cvt_pk_bf16_f32 v125, v182, v183
    v_cvt_pk_bf16_f32 v126, v184, v185
    v_cvt_pk_bf16_f32 v127, v186, v187
    ds_write_b128 v14, v[124:127] offset:54272
L_epi:
    s_mov_b32 s24, 0x1508000
    buffer_load_dwordx4 v[240:243], v2, s[16:19], s24 offen sc1
    s_lshl3_add_u32 s24, s4, s3
    s_lshl_b32 s25, s5, 6
    s_add_u32 s25, s25, s24
    s_lshl_b32 s34, s25, 12
    s_lshl3_add_u32 s35, s5, s3
    s_lshl_b32 s35, s35, 7
    s_add_u32 s35, s35, 0x1500000
    s_lshl2_add_u32 s27, s4, s35
    s_lshl_b32 s24, s24, 5
    s_add_u32 s24, s24, s5
    s_lshl_b32 s24, s24, 11
    s_add_u32 s36, s24, 0x800000
    v_add_u32 v3, 65536, v2
    v_add_u32 v14, s32, v2
    s_waitcnt lgkmcnt(0)
    s_barrier
    ds_read_b128 v[96:99], v14 offset:4096
    ds_read_b128 v[104:107], v3 offset:0
    ds_read_b128 v[100:103], v14 offset:5120
    ds_read_b128 v[108:111], v3 offset:1024
    ds_read_b32 v16, v14 offset:6144
    v_bfe_u32 v14, v1, 4, 1
    v_bfe_u32 v15, v1, 2, 1
    v_cmp_eq_u32 vcc, v14, v15
    v_mov_b32 v14, 0x3f803f80
    s_nop 0
    v_cndmask_b32 v132, 0, v14, vcc
    v_mov_b32 v133, v132
    v_mov_b32 v134, v132
    v_mov_b32 v135, v132
    s_waitcnt lgkmcnt(0)
    v_mfma_f32_32x32x16_bf16 v[32:47], v[104:107], v[96:99], 0
    v_mfma_f32_32x32x16_bf16 v[32:47], v[108:111], v[100:103], v[32:47]
    v_readfirstlane_b32 s6, v16
    v_mov_b32 v20, v3
    v_mov_b32 v64, 0
    v_mov_b32 v65, 0
    v_mov_b32 v66, 0
    v_mov_b32 v67, 0
    v_mov_b32 v68, 0
    v_mov_b32 v69, 0
    v_mov_b32 v70, 0
    v_mov_b32 v71, 0
    v_mov_b32 v72, 0
    v_mov_b32 v73, 0
    v_mov_b32 v74, 0
    v_mov_b32 v75, 0
    v_mov_b32 v76, 0
    v_mov_b32 v77, 0
    v_mov_b32 v78, 0
    v_mov_b32 v79, 0
    ds_read_b128 v[104:107], v3 offset:12288
    ds_read_b128 v[108:111], v3 offset:13312
    ds_read_b128 v[116:119], v20 offset:3072
    ds_read_b128 v[112:115], v20 offset:2048
    v_mov_b32 v128, 0
    v_mov_b32 v129, 0
    v_mov_b32 v130, 0
    v_mov_b32 v131, 0
    v_mov_b32 v124, 0
    v_mov_b32 v125, 0
    v_mov_b32 v126, 0
    v_mov_b32 v127, 0
    v_max3_f32 v14, v32, v33, v34
    v_max3_f32 v14, v14, v35, v36
    v_max3_f32 v14, v14, v37, v38
    v_max3_f32 v14, v14, v39, v40
    v_max3_f32 v14, v14, v41, v42
    v_max3_f32 v14, v14, v43, v44
    v_max3_f32 v14, v14, v45, v46
    v_max_f32 v14, v14, v47
    v_mov_b32 v15, v14
    s_nop 1
    v_permlane32_swap_b32 v14, v15
    v_max_f32 v14, v14, v15
    v_sub_f32 v80, 0, v14
    v_sub_f32 v81, 0, v14
    v_sub_f32 v82, 0, v14
    v_sub_f32 v83, 0, v14
    v_sub_f32 v84, 0, v14
    v_sub_f32 v85, 0, v14
    v_sub_f32 v86, 0, v14
    v_sub_f32 v87, 0, v14
    v_sub_f32 v88, 0, v14
    v_sub_f32 v89, 0, v14
    v_sub_f32 v90, 0, v14
    v_sub_f32 v91, 0, v14
    v_sub_f32 v92, 0, v14
    v_sub_f32 v93, 0, v14
    v_sub_f32 v94, 0, v14
    v_sub_f32 v95, 0, v14
    v_sub_f32 v32, v32, v14
    v_sub_f32 v33, v33, v14
    v_sub_f32 v34, v34, v14
    v_sub_f32 v35, v35, v14
    v_sub_f32 v36, v36, v14
    v_sub_f32 v37, v37, v14
    v_sub_f32 v38, v38, v14
    v_sub_f32 v39, v39, v14
    v_sub_f32 v40, v40, v14
    v_sub_f32 v41, v41, v14
    v_sub_f32 v42, v42, v14
    v_sub_f32 v43, v43, v14
    v_sub_f32 v44, v44, v14
    v_sub_f32 v45, v45, v14
    v_sub_f32 v46, v46, v14
    v_sub_f32 v47, v47, v14
    s_mov_b32 s40, s34
    s_mov_b32 s41, 0
    s_mov_b32 s37, 65536
    s_waitcnt lgkmcnt(1)
    v_mfma_f32_32x32x16_bf16 v[48:63], v[104:107], v[96:99], v[80:95]
    v_exp_f32 v32, v32
    v_exp_f32 v33, v33
    v_exp_f32 v34, v34
    v_exp_f32 v35, v35
    v_mfma_f32_16x16x32_bf16 v[128:131], v[132:135], v[124:127], v[128:131]
    v_cvt_pk_bf16_f32 v120, v32, v33
    v_cvt_pk_bf16_f32 v121, v34, v35
    v_exp_f32 v36, v36
    v_mfma_f32_32x32x16_bf16 v[64:79], v[116:119], v[124:127], v[64:79]
    v_exp_f32 v37, v37
    v_exp_f32 v38, v38
    v_exp_f32 v39, v39
    v_cvt_pk_bf16_f32 v122, v36, v37
    v_cvt_pk_bf16_f32 v123, v38, v39
    v_mfma_f32_32x32x16_bf16 v[48:63], v[108:111], v[100:103], v[48:63]
    ds_read_b128 v[104:107], v3 offset:24576
    ds_read_b128 v[108:111], v3 offset:25600
    ds_read_b128 v[116:119], v20 offset:3072
    v_exp_f32 v40, v40
    v_exp_f32 v41, v41
    v_exp_f32 v42, v42
    v_exp_f32 v43, v43
    v_mfma_f32_16x16x32_bf16 v[128:131], v[132:135], v[120:123], v[128:131]
    v_cvt_pk_bf16_f32 v124, v40, v41
    v_cvt_pk_bf16_f32 v125, v42, v43
    v_exp_f32 v44, v44
    s_waitcnt lgkmcnt(3)
    v_mfma_f32_32x32x16_bf16 v[64:79], v[112:115], v[120:123], v[64:79]
    v_exp_f32 v45, v45
    ds_read_b128 v[112:115], v20 offset:14336
    v_exp_f32 v46, v46
    v_exp_f32 v47, v47
    v_cvt_pk_bf16_f32 v126, v44, v45
    v_cvt_pk_bf16_f32 v127, v46, v47
    s_waitcnt lgkmcnt(1)
    v_mfma_f32_32x32x16_bf16 v[32:47], v[104:107], v[96:99], v[80:95]
    v_exp_f32 v48, v48
    v_exp_f32 v49, v49
    s_waitcnt vmcnt(1)
    v_mov_b32 v14, s6
    s_lshl_b32 s24, s67, 30
    v_lshl_or_b32 v15, v2, 5, s24
    s_mov_b64 exec, 3
    buffer_store_dword v14, v15, s[16:19], s27 offen sc1
    s_mov_b64 exec, -1
    s_waitcnt vmcnt(1)
    s_mov_b32 s39, 0
L_pf0_spin:
    v_xor_b32 v240, s6, v240
    v_xor_b32 v241, s6, v241
    v_xor_b32 v242, s6, v242
    v_xor_b32 v243, s6, v243
    v_or3_b32 v240, v240, v241, v242
    v_or_b32 v240, v240, v243
    v_cmp_ne_u32 vcc, 0, v240
    s_cmp_eq_u64 vcc, 0
    s_cbranch_scc1 L_pf0_ok
    s_sleep 8
    s_mov_b32 s24, 0x1508000
    buffer_load_dwordx4 v[240:243], v2, s[16:19], s24 offen sc1
    s_waitcnt vmcnt(0)
    s_add_u32 s39, s39, 1
    s_cmp_lt_u32 s39, 0x40000
    s_cbranch_scc1 L_pf0_spin
L_pf0_ok:
    s_cmp_lt_u32 s3, 6
    s_cbranch_scc1 L_nowf
    s_mov_b32 s25, 0x05040100
    v_perm_b32 v216, v212, v208, s25
    v_perm_b32 v217, v213, v209, s25
    v_perm_b32 v218, v214, v210, s25
    v_perm_b32 v219, v215, v211, s25
    s_add_u32 s26, s68, 0
    buffer_store_dwordx4 v[216:219], v2, s[16:19], s26 offen sc1
    s_mov_b32 s25, 0x07060302
    v_perm_b32 v220, v212, v208, s25
    v_perm_b32 v221, v213, v209, s25
    v_perm_b32 v222, v214, v210, s25
    v_perm_b32 v223, v215, v211, s25
    s_add_u32 s26, s68, 65536
    buffer_store_dwordx4 v[220:223], v2, s[16:19], s26 offen sc1
    v_lshl_or_b32 v224, v228, 16, v224
    v_lshl_or_b32 v225, v229, 16, v225
    v_lshl_or_b32 v226, v230, 16, v226
    v_lshl_or_b32 v227, v231, 16, v227
    s_add_u32 s26, s68, 131072
    buffer_store_dwordx4 v[224:227], v2, s[16:19], s26 offen sc1
    v_lshl_or_b32 v232, v236, 16, v232
    v_lshl_or_b32 v233, v237, 16, v233
    v_lshl_or_b32 v234, v238, 16, v234
    v_lshl_or_b32 v235, v239, 16, v235
    s_add_u32 s26, s68, 196608
    buffer_store_dwordx4 v[232:235], v2, s[16:19], s26 offen sc1
L_nowf:
    s_mul_i32 s70, s64, 0x84000
    s_lshl_b32 s24, s65, 7
    s_add_u32 s70, s70, s24
    s_add_u32 s70, s70, 0xc00000
    s_lshl_b32 s24, s3, 16
    s_add_u32 s71, s70, s24
    s_lshl_b32 s72, s3, 13
    v_lshrrev_b32 v14, 2, v1
    v_and_b32 v15, 3, v1
    v_lshlrev_b32 v15, 4, v15
    v_lshl_add_u32 v14, v14, 10, v15
    v_exp_f32 v50, v50
    v_exp_f32 v51, v51
    v_mfma_f32_16x16x32_bf16 v[128:131], v[132:135], v[124:127], v[128:131]
    v_cvt_pk_bf16_f32 v120, v48, v49
    v_cvt_pk_bf16_f32 v121, v50, v51
    v_exp_f32 v52, v52
    v_mfma_f32_32x32x16_bf16 v[64:79], v[116:119], v[124:127], v[64:79]
    v_exp_f32 v53, v53
    v_exp_f32 v54, v54
    v_exp_f32 v55, v55
    v_cvt_pk_bf16_f32 v122, v52, v53
    v_cvt_pk_bf16_f32 v123, v54, v55
    v_mfma_f32_32x32x16_bf16 v[32:47], v[108:111], v[100:103], v[32:47]
    ds_read_b128 v[104:107], v3 offset:36864
    ds_read_b128 v[108:111], v3 offset:37888
    ds_read_b128 v[116:119], v20 offset:15360
    s_add_u32 m0, s72, 0
    s_add_u32 s24, s71, 0
    buffer_load_dwordx4 v14, s[16:19], s24 offen sc1 lds
    v_exp_f32 v56, v56
    v_exp_f32 v57, v57
    v_exp_f32 v58, v58
    v_exp_f32 v59, v59
    v_mfma_f32_16x16x32_bf16 v[128:131], v[132:135], v[120:123], v[128:131]
    v_cvt_pk_bf16_f32 v124, v56, v57
    v_cvt_pk_bf16_f32 v125, v58, v59
    v_exp_f32 v60, v60
    s_waitcnt lgkmcnt(3)
    v_mfma_f32_32x32x16_bf16 v[64:79], v[112:115], v[120:123], v[64:79]
    s_add_u32 m0, s72, 1024
    s_add_u32 s24, s71, 64
    buffer_load_dwordx4 v14, s[16:19], s24 offen sc1 lds
    v_exp_f32 v61, v61
    ds_read_b128 v[112:115], v20 offset:26624
    s_add_u32 m0, s72, 2048
    s_add_u32 s24, s71, 16384
    buffer_load_dwordx4 v14, s[16:19], s24 offen sc1 lds
    v_exp_f32 v62, v62
    v_exp_f32 v63, v63
    v_cvt_pk_bf16_f32 v126, v60, v61
    v_cvt_pk_bf16_f32 v127, v62, v63
    s_waitcnt lgkmcnt(1)
    v_mfma_f32_32x32x16_bf16 v[48:63], v[104:107], v[96:99], v[80:95]
    v_exp_f32 v32, v32
    v_exp_f32 v33, v33
    s_add_u32 m0, s72, 3072
    s_add_u32 s24, s71, 16448
    buffer_load_dwordx4 v14, s[16:19], s24 offen sc1 lds
    v_exp_f32 v34, v34
    v_exp_f32 v35, v35
    v_mfma_f32_16x16x32_bf16 v[128:131], v[132:135], v[124:127], v[128:131]
    v_cvt_pk_bf16_f32 v120, v32, v33
    v_cvt_pk_bf16_f32 v121, v34, v35
    v_exp_f32 v36, v36
    v_mfma_f32_32x32x16_bf16 v[64:79], v[116:119], v[124:127], v[64:79]
    v_exp_f32 v37, v37
    v_exp_f32 v38, v38
    v_exp_f32 v39, v39
    v_cvt_pk_bf16_f32 v122, v36, v37
    v_cvt_pk_bf16_f32 v123, v38, v39
    v_mfma_f32_32x32x16_bf16 v[48:63], v[108:111], v[100:103], v[48:63]
    v_add_u32 v3, 49152, v3
    ds_read_b128 v[104:107], v3 offset:0
    ds_read_b128 v[108:111], v3 offset:1024
    ds_read_b128 v[116:119], v20 offset:27648
    s_add_u32 m0, s72, 4096
    s_add_u32 s24, s71, 32768
    buffer_load_dwordx4 v14, s[16:19], s24 offen sc1 lds
    v_exp_f32 v40, v40
    v_exp_f32 v41, v41
    v_exp_f32 v42, v42
    v_exp_f32 v43, v43
    v_mfma_f32_16x16x32_bf16 v[128:131], v[132:135], v[120:123], v[128:131]
    v_cvt_pk_bf16_f32 v124, v40, v41
    v_cvt_pk_bf16_f32 v125, v42, v43
    v_exp_f32 v44, v44
    s_waitcnt lgkmcnt(3)
    v_mfma_f32_32x32x16_bf16 v[64:79], v[112:115], v[120:123], v[64:79]
    s_add_u32 m0, s72, 5120
    s_add_u32 s24, s71, 32832
    buffer_load_dwordx4 v14, s[16:19], s24 offen sc1 lds
    v_exp_f32 v45, v45
    ds_read_b128 v[112:115], v20 offset:38912
    s_add_u32 m0, s72, 6144
    s_add_u32 s24, s71, 49152
    buffer_load_dwordx4 v14, s[16:19], s24 offen sc1 lds
    v_exp_f32 v46, v46
    v_exp_f32 v47, v47
    v_cvt_pk_bf16_f32 v126, v44, v45
    v_cvt_pk_bf16_f32 v127, v46, v47
    s_waitcnt lgkmcnt(1)
    v_mfma_f32_32x32x16_bf16 v[32:47], v[104:107], v[96:99], v[80:95]
    v_exp_f32 v48, v48
    v_exp_f32 v49, v49
    v_and_b32 v18, 7, v1
    v_lshlrev_b32 v18, 2, v18
    buffer_load_dword v19, v18, s[16:19], s35 offen sc1
    s_add_u32 m0, s72, 7168
    s_add_u32 s24, s71, 49216
    buffer_load_dwordx4 v14, s[16:19], s24 offen sc1 lds
    v_lshrrev_b32 v15, 5, v1
    v_lshlrev_b32 v15, 4, v15
    v_and_b32 v14, 3, v1
    v_bfe_u32 v16, v1, 3, 1
    v_lshl_add_u32 v14, v16, 2, v14
    v_and_b32 v16, 3, v14
    v_lshl_add_u32 v14, v14, 11, v15
    v_cmp_eq_u32 vcc, 0, v16
    v_mov_b32 v16, 0x40000000
    s_nop 0
    v_cndmask_b32 v14, v16, v14, vcc
    v_cmp_ne_u32 vcc, 0, v132
    s_nop 1
    v_cndmask_b32 v14, v16, v14, vcc
    s_xor_b32 s24, s4, s65
    s_and_b32 s24, s24, 1
    s_lshr_b32 s25, s65, 1
    s_or_b32 s24, s24, s25
    s_cselect_b32 s24, 0x40000000, 0
    v_or_b32 v14, s24, v14
    s_lshl_b32 s71, s64, 14
    s_add_u32 s71, s71, 0x1410000
    s_lshl_b32 s24, s66, 8
    s_add_u32 s72, s71, s24
    v_exp_f32 v50, v50
    v_exp_f32 v51, v51
    v_mfma_f32_16x16x32_bf16 v[128:131], v[132:135], v[124:127], v[128:131]
    v_cvt_pk_bf16_f32 v120, v48, v49
    v_cvt_pk_bf16_f32 v121, v50, v51
    v_exp_f32 v52, v52
    v_mfma_f32_32x32x16_bf16 v[64:79], v[116:119], v[124:127], v[64:79]
    v_exp_f32 v53, v53
    v_exp_f32 v54, v54
    v_exp_f32 v55, v55
    v_cvt_pk_bf16_f32 v122, v52, v53
    v_cvt_pk_bf16_f32 v123, v54, v55
    v_mfma_f32_32x32x16_bf16 v[32:47], v[108:111], v[100:103], v[32:47]
    ds_read_b128 v[104:107], v3 offset:12288
    ds_read_b128 v[108:111], v3 offset:13312
    ds_read_b128 v[116:119], v20 offset:39936
    buffer_load_dwordx4 v[172:175], v14, s[16:19], s72 offen offset:0 sc1
    buffer_load_dwordx4 v[176:179], v14, s[16:19], s72 offen offset:32 sc1
    v_exp_f32 v56, v56
    v_exp_f32 v57, v57
    v_exp_f32 v58, v58
    v_exp_f32 v59, v59
    v_mfma_f32_16x16x32_bf16 v[128:131], v[132:135], v[120:123], v[128:131]
    v_cvt_pk_bf16_f32 v124, v56, v57
    v_cvt_pk_bf16_f32 v125, v58, v59
    v_exp_f32 v60, v60
    s_waitcnt lgkmcnt(3)
    v_mfma_f32_32x32x16_bf16 v[64:79], v[112:115], v[120:123], v[64:79]
    buffer_load_dwordx4 v[180:183], v14, s[16:19], s72 offen offset:64 sc1
    buffer_load_dwordx4 v[184:187], v14, s[16:19], s72 offen offset:96 sc1
    v_exp_f32 v61, v61
    v_mov_b32 v20, v3
    ds_read_b128 v[112:115], v20 offset:2048
    buffer_load_dwordx4 v[188:191], v14, s[16:19], s72 offen offset:128 sc1
    buffer_load_dwordx4 v[192:195], v14, s[16:19], s72 offen offset:160 sc1
    v_exp_f32 v62, v62
    v_exp_f32 v63, v63
    v_cvt_pk_bf16_f32 v126, v60, v61
    v_cvt_pk_bf16_f32 v127, v62, v63
    s_waitcnt lgkmcnt(1)
    v_mfma_f32_32x32x16_bf16 v[48:63], v[104:107], v[96:99], v[80:95]
    v_exp_f32 v32, v32
    v_exp_f32 v33, v33
    buffer_load_dwordx4 v[196:199], v14, s[16:19], s72 offen offset:192 sc1
    buffer_load_dwordx4 v[200:203], v14, s[16:19], s72 offen offset:224 sc1
    v_exp_f32 v34, v34
    v_exp_f32 v35, v35
    v_mfma_f32_16x16x32_bf16 v[128:131], v[132:135], v[124:127], v[128:131]
    v_cvt_pk_bf16_f32 v120, v32, v33
    v_cvt_pk_bf16_f32 v121, v34, v35
    v_exp_f32 v36, v36
    v_mfma_f32_32x32x16_bf16 v[64:79], v[116:119], v[124:127], v[64:79]
    v_exp_f32 v37, v37
    v_exp_f32 v38, v38
    v_exp_f32 v39, v39
    v_cvt_pk_bf16_f32 v122, v36, v37
    v_cvt_pk_bf16_f32 v123, v38, v39
    v_mfma_f32_32x32x16_bf16 v[48:63], v[108:111], v[100:103], v[48:63]
    ds_read_b128 v[104:107], v3 offset:24576
    ds_read_b128 v[108:111], v3 offset:25600
    ds_read_b128 v[116:119], v20 offset:3072
    s_cmp_lg_u32 s66, 0
    s_cselect_b32 s24, 0x40000000, 0
    v_lshlrev_b32 v15, 26, v15
    v_or_b32 v15, s24, v15
    v_or_b32 v14, v14, v15
    buffer_load_ushort v204, v14, s[16:19], s71 offen offset:1024 sc1
    v_bfrev_b32 v14, v1
    v_bfe_u32 v14, v14, 27, 3
    v_and_b32 v16, 3, v1
    v_lshl_add_u32 v14, v14, 2, v16
    v_lshl_or_b32 v14, v14, 1, v15
    s_lshl_b32 s24, s67, 6
    s_add_u32 s25, s70, 524288
    s_add_u32 s26, s25, s24
    buffer_load_ushort v24, v14, s[16:19], s26 offen sc1
    s_xor_b32 s26, s26, 64
    buffer_load_ushort v28, v14, s[16:19], s26 offen sc1
    v_exp_f32 v40, v40
    v_exp_f32 v41, v41
    v_exp_f32 v42, v42
    v_exp_f32 v43, v43
    v_mfma_f32_16x16x32_bf16 v[128:131], v[132:135], v[120:123], v[128:131]
    v_cvt_pk_bf16_f32 v124, v40, v41
    v_cvt_pk_bf16_f32 v125, v42, v43
    v_exp_f32 v44, v44
    s_waitcnt lgkmcnt(3)
    v_mfma_f32_32x32x16_bf16 v[64:79], v[112:115], v[120:123], v[64:79]
    s_mov_b32 s39, 0
    s_waitcnt vmcnt(12)
L_kvspin:
    v_cmp_eq_u32 vcc, s6, v19
    s_cmp_eq_u64 vcc, -1
    s_cbranch_scc1 L_kvok
    buffer_load_dword v19, v18, s[16:19], s35 offen sc1
    s_waitcnt vmcnt(0)
    s_add_u32 s39, s39, 1
    s_cmp_lt_u32 s39, 0x40000
    s_cbranch_scc1 L_kvspin
L_kvok:
    s_add_u32 s24, s40, 32768
    s_and_b32 s24, s24, 0x3ffff
    s_andn2_b32 s40, s40, 0x3ffff
    s_or_b32 s40, s40, s24
    s_add_u32 s41, s41, 4096
    s_cmp_eq_u32 s41, 12288
    s_cselect_b32 s41, 0, s41
    s_add_u32 m0, s32, s41
    s_nop 0
    buffer_load_dwordx4 v2, s[16:19], s40 offen offset:0 sc1 lds
    buffer_load_dwordx4 v2, s[16:19], s40 offen offset:1024 sc1 lds
    buffer_load_dwordx4 v2, s[16:19], s40 offen offset:2048 sc1 lds
    buffer_load_dwordx4 v2, s[16:19], s40 offen offset:3072 sc1 lds
    v_exp_f32 v45, v45
    ds_read_b128 v[112:115], v20 offset:14336
    v_exp_f32 v46, v46
    v_exp_f32 v47, v47
    v_cvt_pk_bf16_f32 v126, v44, v45
    v_cvt_pk_bf16_f32 v127, v46, v47
    s_waitcnt lgkmcnt(1)
    v_mfma_f32_32x32x16_bf16 v[32:47], v[104:107], v[96:99], v[80:95]
    v_exp_f32 v48, v48
    v_exp_f32 v49, v49
    s_add_u32 s24, s40, 32768
    s_and_b32 s24, s24, 0x3ffff
    s_andn2_b32 s40, s40, 0x3ffff
    s_or_b32 s40, s40, s24
    s_add_u32 s41, s41, 4096
    s_cmp_eq_u32 s41, 12288
    s_cselect_b32 s41, 0, s41
    s_add_u32 m0, s32, s41
    s_nop 0
    buffer_load_dwordx4 v2, s[16:19], s40 offen offset:0 sc1 lds
    v_exp_f32 v50, v50
    v_exp_f32 v51, v51
    v_mfma_f32_16x16x32_bf16 v[128:131], v[132:135], v[124:127], v[128:131]
    v_cvt_pk_bf16_f32 v120, v48, v49
    v_cvt_pk_bf16_f32 v121, v50, v51
    v_exp_f32 v52, v52
    v_mfma_f32_32x32x16_bf16 v[64:79], v[116:119], v[124:127], v[64:79]
    v_exp_f32 v53, v53
    v_exp_f32 v54, v54
    v_exp_f32 v55, v55
    v_cvt_pk_bf16_f32 v122, v52, v53
    v_cvt_pk_bf16_f32 v123, v54, v55
    v_mfma_f32_32x32x16_bf16 v[32:47], v[108:111], v[100:103], v[32:47]
    ds_read_b128 v[104:107], v3 offset:36864
    ds_read_b128 v[108:111], v3 offset:37888
    ds_read_b128 v[116:119], v20 offset:15360
    buffer_load_dwordx4 v2, s[16:19], s40 offen offset:1024 sc1 lds
    v_exp_f32 v56, v56
    v_exp_f32 v57, v57
    v_exp_f32 v58, v58
    v_exp_f32 v59, v59
    v_mfma_f32_16x16x32_bf16 v[128:131], v[132:135], v[120:123], v[128:131]
    v_cvt_pk_bf16_f32 v124, v56, v57
    v_cvt_pk_bf16_f32 v125, v58, v59
    v_exp_f32 v60, v60
    s_waitcnt lgkmcnt(3)
    v_mfma_f32_32x32x16_bf16 v[64:79], v[112:115], v[120:123], v[64:79]
    buffer_load_dwordx4 v2, s[16:19], s40 offen offset:2048 sc1 lds
    v_exp_f32 v61, v61
    ds_read_b128 v[112:115], v20 offset:26624
    buffer_load_dwordx4 v2, s[16:19], s40 offen offset:3072 sc1 lds
    v_exp_f32 v62, v62
    v_exp_f32 v63, v63
    v_cvt_pk_bf16_f32 v126, v60, v61
    v_cvt_pk_bf16_f32 v127, v62, v63
    v_lshrrev_b32 v14, 5, v1
    v_lshlrev_b32 v14, 9, v14
    v_bfe_u32 v15, v1, 2, 2
    v_lshl_add_u32 v14, v15, 6, v14
    v_and_b32 v15, 1, v1
    v_lshl_add_u32 v14, v15, 5, v14
    v_bfe_u32 v15, v1, 1, 1
    v_lshl_add_u32 v14, v15, 4, v14
    v_bfe_u32 v15, v1, 4, 1
    v_lshl_add_u32 v14, v15, 3, v14
    s_lshl_b32 s24, s66, 14
    s_lshl_b32 s25, s67, 10
    s_add_u32 s24, s24, s25
    v_add_u32 v12, s24, v14
    v_xor_b32 v13, 1024, v12
    s_waitcnt vmcnt(8)
    s_barrier
    ds_read_b64_tr_b16 v[240:241], v12 offset:0
    ds_read_b64_tr_b16 v[242:243], v12 offset:256
    ds_read_b64_tr_b16 v[244:245], v13 offset:0
    ds_read_b64_tr_b16 v[246:247], v13 offset:256
    ds_read_b64_tr_b16 v[248:249], v12 offset:2048
    ds_read_b64_tr_b16 v[250:251], v12 offset:2304
    ds_read_b64_tr_b16 v[252:253], v13 offset:2048
    ds_read_b64_tr_b16 v[254:255], v13 offset:2304
    v_mov_b32 v25, 0
    v_mov_b32 v26, 0
    v_mov_b32 v27, 0
    v_mov_b32 v29, 0
    v_mov_b32 v30, 0
    v_mov_b32 v31, 0
    v_mov_b32 v205, 0
    v_mov_b32 v206, 0
    v_mov_b32 v207, 0
    v_lshlrev_b32 v14, 2, v132
    v_and_b32 v14, 0x80000000, v14
    v_or_b32 v8, v14, v132
    v_or_b32 v9, v14, v132
    v_or_b32 v10, v14, v132
    v_or_b32 v11, v14, v132
    s_xor_b32 s24, s4, s65
    s_bitcmp1_b32 s24, 0
    s_cbranch_scc1 L_jaY
    v_mfma_f32_32x32x16_bf16 v[208:223], v[24:27], v[168:171], 0
    v_mfma_f32_32x32x16_bf16 v[224:239], v[28:31], v[168:171], 0
    v_mfma_f32_16x16x32_bf16 v[4:7], v[204:207], v[168:171], 0
    s_waitcnt lgkmcnt(4)
    v_mfma_f32_32x32x16_bf16 v[208:223], v[240:243], v[136:139], v[208:223]
    v_mfma_f32_32x32x16_bf16 v[224:239], v[244:247], v[136:139], v[224:239]
    v_mfma_f32_16x16x32_bf16 v[4:7], v[172:175], v[136:139], v[4:7]
    ds_read_b64_tr_b16 v[240:241], v12 offset:4096
    ds_read_b64_tr_b16 v[242:243], v12 offset:4352
    ds_read_b64_tr_b16 v[244:245], v13 offset:4096
    ds_read_b64_tr_b16 v[246:247], v13 offset:4352
    s_waitcnt lgkmcnt(4)
    v_mfma_f32_32x32x16_bf16 v[208:223], v[248:251], v[140:143], v[208:223]
    v_mfma_f32_32x32x16_bf16 v[224:239], v[252:255], v[140:143], v[224:239]
    v_mfma_f32_16x16x32_bf16 v[4:7], v[176:179], v[140:143], v[4:7]
    ds_read_b64_tr_b16 v[248:249], v12 offset:6144
    ds_read_b64_tr_b16 v[250:251], v12 offset:6400
    ds_read_b64_tr_b16 v[252:253], v13 offset:6144
    ds_read_b64_tr_b16 v[254:255], v13 offset:6400
    s_waitcnt lgkmcnt(4)
    v_mfma_f32_32x32x16_bf16 v[208:223], v[240:243], v[144:147], v[208:223]
    v_mfma_f32_32x32x16_bf16 v[224:239], v[244:247], v[144:147], v[224:239]
    v_mfma_f32_16x16x32_bf16 v[4:7], v[180:183], v[144:147], v[4:7]
    ds_read_b64_tr_b16 v[240:241], v12 offset:8192
    ds_read_b64_tr_b16 v[242:243], v12 offset:8448
    ds_read_b64_tr_b16 v[244:245], v13 offset:8192
    ds_read_b64_tr_b16 v[246:247], v13 offset:8448
    s_waitcnt lgkmcnt(4)
    v_mfma_f32_32x32x16_bf16 v[208:223], v[248:251], v[148:151], v[208:223]
    v_mfma_f32_32x32x16_bf16 v[224:239], v[252:255], v[148:151], v[224:239]
    v_mfma_f32_16x16x32_bf16 v[4:7], v[184:187], v[148:151], v[4:7]
    ds_read_b64_tr_b16 v[248:249], v12 offset:10240
    ds_read_b64_tr_b16 v[250:251], v12 offset:10496
    ds_read_b64_tr_b16 v[252:253], v13 offset:10240
    ds_read_b64_tr_b16 v[254:255], v13 offset:10496
    s_waitcnt lgkmcnt(4)
    v_mfma_f32_32x32x16_bf16 v[208:223], v[240:243], v[152:155], v[208:223]
    v_mfma_f32_32x32x16_bf16 v[224:239], v[244:247], v[152:155], v[224:239]
    v_mfma_f32_16x16x32_bf16 v[4:7], v[188:191], v[152:155], v[4:7]
    ds_read_b64_tr_b16 v[240:241], v12 offset:12288
    ds_read_b64_tr_b16 v[242:243], v12 offset:12544
    ds_read_b64_tr_b16 v[244:245], v13 offset:12288
    ds_read_b64_tr_b16 v[246:247], v13 offset:12544
    s_waitcnt lgkmcnt(4)
    v_mfma_f32_32x32x16_bf16 v[208:223], v[248:251], v[156:159], v[208:223]
    v_mfma_f32_32x32x16_bf16 v[224:239], v[252:255], v[156:159], v[224:239]
    v_mfma_f32_16x16x32_bf16 v[4:7], v[192:195], v[156:159], v[4:7]
    ds_read_b64_tr_b16 v[248:249], v12 offset:14336
    ds_read_b64_tr_b16 v[250:251], v12 offset:14592
    ds_read_b64_tr_b16 v[252:253], v13 offset:14336
    ds_read_b64_tr_b16 v[254:255], v13 offset:14592
    s_waitcnt lgkmcnt(4)
    v_mfma_f32_32x32x16_bf16 v[208:223], v[240:243], v[160:163], v[208:223]
    v_mfma_f32_32x32x16_bf16 v[224:239], v[244:247], v[160:163], v[224:239]
    v_mfma_f32_16x16x32_bf16 v[4:7], v[196:199], v[160:163], v[4:7]
    s_waitcnt lgkmcnt(0)
    v_mfma_f32_32x32x16_bf16 v[208:223], v[248:251], v[164:167], v[208:223]
    v_mfma_f32_32x32x16_bf16 v[224:239], v[252:255], v[164:167], v[224:239]
    v_mfma_f32_16x16x32_bf16 v[4:7], v[200:203], v[164:167], v[4:7]
    v_and_b32 v14, 31, v1
    v_lshrrev_b32 v15, 5, v1
    s_cmp_ge_u32 s65, 2
    s_cbranch_scc1 L_jaC
    v_lshlrev_b32 v17, 4, v15
    v_lshl_add_u32 v16, v14, 6, v17
    s_lshr_b32 s24, s64, 1
    s_lshl_b32 s24, s24, 16
    s_lshl2_add_u32 s24, s66, s24
    s_add_u32 s24, s24, 0x1420000
    s_lshl_b32 s25, s69, 5
    s_add_u32 s25, s25, s24
    v_add_f32 v4, v4, v5
    v_add_f32 v6, v6, v7
    v_add_f32 v18, v4, v6
    buffer_store_dword v18, v16, s[16:19], s25 offen sc1
    s_or_b32 s25, s5, s69
    s_cmp_lg_u32 s25, 0
    s_cbranch_scc1 L_jaC
    v_mov_b32 v8, 0xbf803f80
    v_mov_b32 v9, 0xbf803f80
    v_mov_b32 v10, 0xbf803f80
    v_mov_b32 v11, 0xbf803f80
    s_nop 1
    v_mfma_f32_16x16x32_bf16 v[4:7], v[172:175], v[8:11], 0
    v_mfma_f32_16x16x32_bf16 v[4:7], v[176:179], v[8:11], v[4:7]
    v_mfma_f32_16x16x32_bf16 v[4:7], v[180:183], v[8:11], v[4:7]
    v_mfma_f32_16x16x32_bf16 v[4:7], v[184:187], v[8:11], v[4:7]
    v_mfma_f32_16x16x32_bf16 v[4:7], v[188:191], v[8:11], v[4:7]
    v_mfma_f32_16x16x32_bf16 v[4:7], v[192:195], v[8:11], v[4:7]
    v_mfma_f32_16x16x32_bf16 v[4:7], v[196:199], v[8:11], v[4:7]
    v_mfma_f32_16x16x32_bf16 v[4:7], v[200:203], v[8:11], v[4:7]
    v_mfma_f32_16x16x32_bf16 v[4:7], v[204:207], v[8:11], v[4:7]
    s_add_u32 s25, s24, 32768
    s_nop 6
    v_add_f32 v4, v4, v5
    v_add_f32 v6, v6, v7
    v_add_f32 v18, v4, v6
    buffer_store_dword v18, v17, s[16:19], s25 offen sc1
    s_branch L_jaC
L_jaY:
    v_mfma_f32_32x32x16_bf16 v[208:223], v[24:27], v[168:171], 0
    v_mfma_f32_32x32x16_bf16 v[224:239], v[28:31], v[168:171], 0
    v_mfma_f32_16x16x32_bf16 v[4:7], v[8:11], v[24:27], 0
    s_waitcnt lgkmcnt(4)
    v_mfma_f32_32x32x16_bf16 v[208:223], v[240:243], v[136:139], v[208:223]
    v_mfma_f32_32x32x16_bf16 v[224:239], v[244:247], v[136:139], v[224:239]
    v_mfma_f32_16x16x32_bf16 v[4:7], v[8:11], v[240:243], v[4:7]
    ds_read_b64_tr_b16 v[240:241], v12 offset:4096
    ds_read_b64_tr_b16 v[242:243], v12 offset:4352
    ds_read_b64_tr_b16 v[244:245], v13 offset:4096
    ds_read_b64_tr_b16 v[246:247], v13 offset:4352
    s_waitcnt lgkmcnt(4)
    v_mfma_f32_32x32x16_bf16 v[208:223], v[248:251], v[140:143], v[208:223]
    v_mfma_f32_32x32x16_bf16 v[224:239], v[252:255], v[140:143], v[224:239]
    v_mfma_f32_16x16x32_bf16 v[4:7], v[8:11], v[248:251], v[4:7]
    ds_read_b64_tr_b16 v[248:249], v12 offset:6144
    ds_read_b64_tr_b16 v[250:251], v12 offset:6400
    ds_read_b64_tr_b16 v[252:253], v13 offset:6144
    ds_read_b64_tr_b16 v[254:255], v13 offset:6400
    s_waitcnt lgkmcnt(4)
    v_mfma_f32_32x32x16_bf16 v[208:223], v[240:243], v[144:147], v[208:223]
    v_mfma_f32_32x32x16_bf16 v[224:239], v[244:247], v[144:147], v[224:239]
    v_mfma_f32_16x16x32_bf16 v[4:7], v[8:11], v[240:243], v[4:7]
    ds_read_b64_tr_b16 v[240:241], v12 offset:8192
    ds_read_b64_tr_b16 v[242:243], v12 offset:8448
    ds_read_b64_tr_b16 v[244:245], v13 offset:8192
    ds_read_b64_tr_b16 v[246:247], v13 offset:8448
    s_waitcnt lgkmcnt(4)
    v_mfma_f32_32x32x16_bf16 v[208:223], v[248:251], v[148:151], v[208:223]
    v_mfma_f32_32x32x16_bf16 v[224:239], v[252:255], v[148:151], v[224:239]
    v_mfma_f32_16x16x32_bf16 v[4:7], v[8:11], v[248:251], v[4:7]
    ds_read_b64_tr_b16 v[248:249], v12 offset:10240
    ds_read_b64_tr_b16 v[250:251], v12 offset:10496
    ds_read_b64_tr_b16 v[252:253], v13 offset:10240
    ds_read_b64_tr_b16 v[254:255], v13 offset:10496
    s_waitcnt lgkmcnt(4)
    v_mfma_f32_32x32x16_bf16 v[208:223], v[240:243], v[152:155], v[208:223]
    v_mfma_f32_32x32x16_bf16 v[224:239], v[244:247], v[152:155], v[224:239]
    v_mfma_f32_16x16x32_bf16 v[4:7], v[8:11], v[240:243], v[4:7]
    ds_read_b64_tr_b16 v[240:241], v12 offset:12288
    ds_read_b64_tr_b16 v[242:243], v12 offset:12544
    ds_read_b64_tr_b16 v[244:245], v13 offset:12288
    ds_read_b64_tr_b16 v[246:247], v13 offset:12544
    s_waitcnt lgkmcnt(4)
    v_mfma_f32_32x32x16_bf16 v[208:223], v[248:251], v[156:159], v[208:223]
    v_mfma_f32_32x32x16_bf16 v[224:239], v[252:255], v[156:159], v[224:239]
    v_mfma_f32_16x16x32_bf16 v[4:7], v[8:11], v[248:251], v[4:7]
    ds_read_b64_tr_b16 v[248:249], v12 offset:14336
    ds_read_b64_tr_b16 v[250:251], v12 offset:14592
    ds_read_b64_tr_b16 v[252:253], v13 offset:14336
    ds_read_b64_tr_b16 v[254:255], v13 offset:14592
    s_waitcnt lgkmcnt(4)
    v_mfma_f32_32x32x16_bf16 v[208:223], v[240:243], v[160:163], v[208:223]
    v_mfma_f32_32x32x16_bf16 v[224:239], v[244:247], v[160:163], v[224:239]
    v_mfma_f32_16x16x32_bf16 v[4:7], v[8:11], v[240:243], v[4:7]
    s_waitcnt lgkmcnt(0)
    v_mfma_f32_32x32x16_bf16 v[208:223], v[248:251], v[164:167], v[208:223]
    v_mfma_f32_32x32x16_bf16 v[224:239], v[252:255], v[164:167], v[224:239]
    v_mfma_f32_16x16x32_bf16 v[4:7], v[8:11], v[248:251], v[4:7]
    v_and_b32 v14, 31, v1
    v_lshrrev_b32 v15, 5, v1
    s_lshr_b32 s24, s4, 1
    s_or_b32 s24, s24, s64
    s_cmp_lg_u32 s24, 0
    s_cbranch_scc1 L_jaC
    v_lshrrev_b32 v16, 4, v14
    v_mul_u32_u24 v16, 0x84000, v16
    v_bfe_u32 v17, v14, 2, 1
    v_lshl_add_u32 v16, v17, 9, v16
    v_bfe_u32 v17, v14, 3, 1
    v_lshl_add_u32 v16, v17, 3, v16
    v_and_b32 v17, 3, v14
    v_lshl_add_u32 v16, v17, 1, v16
    v_lshl_or_b32 v16, v15, 30, v16
    s_lshl1_add_u32 s24, s65, s67
    s_lshl_b32 s24, s24, 10
    s_and_b32 s25, s66, 1
    s_lshl_b32 s25, s25, 8
    s_add_u32 s24, s24, s25
    s_lshr_b32 s25, s66, 1
    s_lshl4_add_u32 s24, s25, s24
    s_add_u32 s24, s24, 0xf80000
    v_cvt_pk_bf16_f32 v18, v4, v4
    buffer_store_short v18, v16, s[16:19], s24 offen sc1
L_jaC:
    s_lshl_b32 s24, s3, 13
    v_add_u32 v12, s24, v2
    v_lshrrev_b32 v13, 4, v14
    v_lshlrev_b32 v13, 14, v13
    v_lshl_add_u32 v13, v15, 9, v13
    v_and_b32 v14, 15, v14
    v_lshl_add_u32 v13, v14, 4, v13
    s_and_b32 s24, s64, 2
    s_and_b32 s25, s66, 1
    s_add_u32 s24, s24, s25
    s_mul_i32 s24, s24, 0x84000
    s_lshr_b32 s25, s69, 6
    s_lshl_b32 s25, s25, 15
    s_add_u32 s24, s24, s25
    s_lshr_b32 s25, s66, 1
    s_xor_b32 s25, s25, s67
    s_lshl1_add_u32 s25, s65, s25
    s_lshl_b32 s25, s25, 10
    s_add_u32 s24, s24, s25
    s_and_b32 s25, s64, 1
    s_lshl_b32 s25, s25, 8
    s_add_u32 s24, s24, s25
    s_add_u32 s77, s24, 0xf00000
    v_mfma_f32_32x32x16_bf16 v[48:63], v[104:107], v[96:99], v[80:95]
    v_exp_f32 v32, v32
    v_exp_f32 v33, v33
    v_and_b32 v23, 4, v1
    v_cmp_eq_u32 vcc, 0, v23
    v_mov_b32 v23, 0x3f803f80
    s_nop 0
    v_cndmask_b32 v8, 0, v23, vcc
    v_cndmask_b32 v9, 0, v23, vcc
    v_xor_b32 v10, v23, v8
    v_xor_b32 v11, v23, v8
    v_and_b32 v23, 1, v1
    v_mul_u32_u24 v23, 0xaaaa, v23
    v_or_b32 v23, 0x4444, v23
    v_mov_b32 v4, 0
    v_mov_b32 v5, 0
    v_mov_b32 v6, 0
    v_mov_b32 v7, 0
    v_exp_f32 v34, v34
    v_exp_f32 v35, v35
    v_mfma_f32_16x16x32_bf16 v[128:131], v[132:135], v[124:127], v[128:131]
    v_cvt_pk_bf16_f32 v120, v32, v33
    v_cvt_pk_bf16_f32 v121, v34, v35
    v_exp_f32 v36, v36
    v_mfma_f32_32x32x16_bf16 v[64:79], v[116:119], v[124:127], v[64:79]
    v_exp_f32 v37, v37
    v_exp_f32 v38, v38
    v_exp_f32 v39, v39
    v_cvt_pk_bf16_f32 v122, v36, v37
    v_cvt_pk_bf16_f32 v123, v38, v39
    v_mfma_f32_32x32x16_bf16 v[48:63], v[108:111], v[100:103], v[48:63]
    s_waitcnt vmcnt(4)
    s_barrier
    s_add_u32 s37, s37, 4096
    s_cmp_eq_u32 s37, 77824
    s_cselect_b32 s37, 65536, s37
    v_add_u32 v3, s37, v2
    ds_read_b128 v[104:107], v3 offset:0
    ds_read_b128 v[108:111], v3 offset:1024
    ds_read_b128 v[116:119], v20 offset:27648
    v_exp_f32 v40, v40
    v_exp_f32 v41, v41
    v_exp_f32 v42, v42
    v_exp_f32 v43, v43
    v_mfma_f32_16x16x32_bf16 v[128:131], v[132:135], v[120:123], v[128:131]
    v_cvt_pk_bf16_f32 v124, v40, v41
    v_cvt_pk_bf16_f32 v125, v42, v43
    v_exp_f32 v44, v44
    v_mfma_f32_32x32x16_bf16 v[64:79], v[112:115], v[120:123], v[64:79]
    ds_write_b128 v12, v[208:211] offset:0
    ds_write_b128 v12, v[212:215] offset:1024
    v_exp_f32 v45, v45
    ds_read_b128 v[112:115], v20 offset:38912
    ds_write_b128 v12, v[216:219] offset:2048
    ds_write_b128 v12, v[220:223] offset:3072
    v_exp_f32 v46, v46
    v_exp_f32 v47, v47
    v_cvt_pk_bf16_f32 v126, v44, v45
    v_cvt_pk_bf16_f32 v127, v46, v47
    s_waitcnt lgkmcnt(5)
    v_mfma_f32_32x32x16_bf16 v[32:47], v[104:107], v[96:99], v[80:95]
    v_exp_f32 v48, v48
    v_exp_f32 v49, v49
    ds_write_b128 v12, v[224:227] offset:4096
    ds_write_b128 v12, v[228:231] offset:5120
    v_exp_f32 v50, v50
    v_exp_f32 v51, v51
    v_cvt_pk_bf16_f32 v120, v48, v49
    v_cvt_pk_bf16_f32 v121, v50, v51
    v_mfma_f32_32x32x16_bf16 v[64:79], v[116:119], v[124:127], v[64:79]
    v_exp_f32 v52, v52
    v_exp_f32 v53, v53
    v_exp_f32 v54, v54
    v_exp_f32 v55, v55
    v_cvt_pk_bf16_f32 v122, v52, v53
    v_cvt_pk_bf16_f32 v123, v54, v55
    v_mfma_f32_32x32x16_bf16 v[32:47], v[108:111], v[100:103], v[32:47]
    ds_read_b128 v[104:107], v3 offset:12288
    ds_read_b128 v[108:111], v3 offset:13312
    ds_read_b128 v[116:119], v20 offset:39936
    v_exp_f32 v56, v56
    v_exp_f32 v57, v57
    v_exp_f32 v58, v58
    v_exp_f32 v59, v59
    s_waitcnt lgkmcnt(7)
    v_mfma_f32_32x32x16_bf16 v[64:79], v[112:115], v[120:123], v[64:79]
    ds_write_b128 v12, v[232:235] offset:6144
    ds_write_b128 v12, v[236:239] offset:7168
    v_exp_f32 v60, v60
    v_exp_f32 v61, v61
    v_smfmac_f32_16x16x64_bf16 v[4:7], v[8:11], v[120:127], v23
    v_mov_b32 v20, v3
    ds_read_b128 v[112:115], v20 offset:2048
    s_lshl_b32 s24, s67, 15
    s_lshl_b32 s25, s66, 11
    s_add_u32 s24, s24, s25
    v_add_u32 v12, s24, v2
    v_exp_f32 v62, v62
    v_exp_f32 v63, v63
    v_cvt_pk_bf16_f32 v124, v56, v57
    v_cvt_pk_bf16_f32 v125, v58, v59
    v_cvt_pk_bf16_f32 v126, v60, v61
    v_cvt_pk_bf16_f32 v127, v62, v63
    s_waitcnt lgkmcnt(3)
    v_mfma_f32_32x32x16_bf16 v[48:63], v[104:107], v[96:99], v[80:95]
    v_exp_f32 v32, v32
    v_exp_f32 v33, v33
    s_and_b32 s24, s2, 7
    s_bfe_u32 s25, s2, 0x20003
    s_lshl2_add_u32 s75, s24, s25
    s_lshr_b32 s24, s3, 1
    s_lshl3_add_u32 s24, s24, s65
    s_and_b32 s25, s3, 1
    s_lshl1_add_u32 s24, s24, s25
    s_lshl_b32 s24, s24, 13
    s_add_u32 s70, s24, 0x1a00000
    s_add_u32 s71, s70, 4096
    s_lshl2_add_u32 s24, s65, s66
    s_lshl1_add_u32 s24, s24, s67
    s_lshl_b32 s24, s24, 15
    s_add_u32 s76, s24, 0x1200000
    s_lshr_b32 s24, s3, 1
    s_mul_i32 s24, s24, 0x84000
    s_lshl1_add_u32 s25, s75, s25
    s_lshl_b32 s25, s25, 13
    s_add_u32 s24, s24, s25
    s_add_u32 s72, s24, 0xf00000
    s_add_u32 s73, s72, 4096
    v_exp_f32 v34, v34
    v_exp_f32 v35, v35
    v_cvt_pk_bf16_f32 v120, v32, v33
    v_cvt_pk_bf16_f32 v121, v34, v35
    v_mfma_f32_32x32x16_bf16 v[64:79], v[116:119], v[124:127], v[64:79]
    v_exp_f32 v36, v36
    v_exp_f32 v37, v37
    v_exp_f32 v38, v38
    v_exp_f32 v39, v39
    v_cvt_pk_bf16_f32 v122, v36, v37
    v_cvt_pk_bf16_f32 v123, v38, v39
    v_mfma_f32_32x32x16_bf16 v[48:63], v[108:111], v[100:103], v[48:63]
    ds_read_b128 v[104:107], v3 offset:24576
    ds_read_b128 v[108:111], v3 offset:25600
    ds_read_b128 v[116:119], v20 offset:3072
    v_exp_f32 v40, v40
    v_exp_f32 v41, v41
    v_exp_f32 v42, v42
    v_exp_f32 v43, v43
    s_waitcnt lgkmcnt(3)
    v_mfma_f32_32x32x16_bf16 v[64:79], v[112:115], v[120:123], v[64:79]
    s_barrier
    ds_read_b128 v[136:139], v12 offset:0
    ds_read_b128 v[140:143], v12 offset:1024
    v_exp_f32 v44, v44
    v_exp_f32 v45, v45
    v_smfmac_f32_16x16x64_bf16 v[4:7], v[8:11], v[120:127], v23
    ds_read_b128 v[112:115], v20 offset:14336
    ds_read_b128 v[144:147], v12 offset:8192
    ds_read_b128 v[148:151], v12 offset:9216
    v_exp_f32 v46, v46
    v_exp_f32 v47, v47
    v_cvt_pk_bf16_f32 v124, v40, v41
    v_cvt_pk_bf16_f32 v125, v42, v43
    v_cvt_pk_bf16_f32 v126, v44, v45
    v_cvt_pk_bf16_f32 v127, v46, v47
    s_waitcnt lgkmcnt(5)
    v_mfma_f32_32x32x16_bf16 v[32:47], v[104:107], v[96:99], v[80:95]
    v_exp_f32 v48, v48
    v_exp_f32 v49, v49
    ds_read_b128 v[152:155], v12 offset:16384
    ds_read_b128 v[156:159], v12 offset:17408
    v_exp_f32 v50, v50
    v_exp_f32 v51, v51
    v_cvt_pk_bf16_f32 v120, v48, v49
    v_cvt_pk_bf16_f32 v121, v50, v51
    v_mfma_f32_32x32x16_bf16 v[64:79], v[116:119], v[124:127], v[64:79]
    v_exp_f32 v52, v52
    v_exp_f32 v53, v53
    v_exp_f32 v54, v54
    v_exp_f32 v55, v55
    v_cvt_pk_bf16_f32 v122, v52, v53
    v_cvt_pk_bf16_f32 v123, v54, v55
    v_mfma_f32_32x32x16_bf16 v[32:47], v[108:111], v[100:103], v[32:47]
    ds_read_b128 v[104:107], v3 offset:36864
    ds_read_b128 v[108:111], v3 offset:37888
    ds_read_b128 v[116:119], v20 offset:15360
    v_exp_f32 v56, v56
    v_exp_f32 v57, v57
    v_exp_f32 v58, v58
    v_exp_f32 v59, v59
    s_waitcnt lgkmcnt(7)
    v_mfma_f32_32x32x16_bf16 v[64:79], v[112:115], v[120:123], v[64:79]
    ds_read_b128 v[160:163], v12 offset:24576
    ds_read_b128 v[164:167], v12 offset:25600
    v_exp_f32 v60, v60
    v_exp_f32 v61, v61
    v_smfmac_f32_16x16x64_bf16 v[4:7], v[8:11], v[120:127], v23
    ds_read_b128 v[112:115], v20 offset:26624
    v_exp_f32 v62, v62
    v_exp_f32 v63, v63
    v_cvt_pk_bf16_f32 v124, v56, v57
    v_cvt_pk_bf16_f32 v125, v58, v59
    v_cvt_pk_bf16_f32 v126, v60, v61
    v_cvt_pk_bf16_f32 v127, v62, v63
    s_waitcnt lgkmcnt(3)
    v_mfma_f32_32x32x16_bf16 v[48:63], v[104:107], v[96:99], v[80:95]
    v_exp_f32 v32, v32
    v_exp_f32 v33, v33
    v_add_f32 v136, v136, v144
    v_add_f32 v137, v137, v145
    v_add_f32 v138, v138, v146
    v_add_f32 v139, v139, v147
    v_add_f32 v140, v140, v148
    v_add_f32 v141, v141, v149
    v_add_f32 v142, v142, v150
    v_add_f32 v143, v143, v151
    v_exp_f32 v34, v34
    v_exp_f32 v35, v35
    v_cvt_pk_bf16_f32 v120, v32, v33
    v_cvt_pk_bf16_f32 v121, v34, v35
    v_mfma_f32_32x32x16_bf16 v[64:79], v[116:119], v[124:127], v[64:79]
    v_exp_f32 v36, v36
    v_exp_f32 v37, v37
    v_exp_f32 v38, v38
    v_exp_f32 v39, v39
    v_cvt_pk_bf16_f32 v122, v36, v37
    v_cvt_pk_bf16_f32 v123, v38, v39
    v_mfma_f32_32x32x16_bf16 v[48:63], v[108:111], v[100:103], v[48:63]
    v_add_u32 v3, 49152, v3
    ds_read_b128 v[104:107], v3 offset:0
    ds_read_b128 v[108:111], v3 offset:1024
    ds_read_b128 v[116:119], v20 offset:27648
    v_exp_f32 v40, v40
    v_exp_f32 v41, v41
    v_exp_f32 v42, v42
    v_exp_f32 v43, v43
    s_waitcnt lgkmcnt(3)
    v_mfma_f32_32x32x16_bf16 v[64:79], v[112:115], v[120:123], v[64:79]
    v_add_f32 v136, v136, v152
    v_add_f32 v137, v137, v153
    v_add_f32 v138, v138, v154
    v_add_f32 v139, v139, v155
    v_add_f32 v140, v140, v156
    v_add_f32 v141, v141, v157
    v_add_f32 v142, v142, v158
    v_add_f32 v143, v143, v159
    v_exp_f32 v44, v44
    v_exp_f32 v45, v45
    v_smfmac_f32_16x16x64_bf16 v[4:7], v[8:11], v[120:127], v23
    ds_read_b128 v[112:115], v20 offset:38912
    v_exp_f32 v46, v46
    v_exp_f32 v47, v47
    v_cvt_pk_bf16_f32 v124, v40, v41
    v_cvt_pk_bf16_f32 v125, v42, v43
    v_cvt_pk_bf16_f32 v126, v44, v45
    v_cvt_pk_bf16_f32 v127, v46, v47
    s_waitcnt lgkmcnt(1)
    v_mfma_f32_32x32x16_bf16 v[32:47], v[104:107], v[96:99], v[80:95]
    v_exp_f32 v48, v48
    v_exp_f32 v49, v49
    v_add_f32 v136, v136, v160
    v_add_f32 v137, v137, v161
    v_add_f32 v138, v138, v162
    v_add_f32 v139, v139, v163
    v_add_f32 v140, v140, v164
    v_add_f32 v141, v141, v165
    v_add_f32 v142, v142, v166
    v_add_f32 v143, v143, v167
    v_exp_f32 v50, v50
    v_exp_f32 v51, v51
    v_cvt_pk_bf16_f32 v120, v48, v49
    v_cvt_pk_bf16_f32 v121, v50, v51
    v_mfma_f32_32x32x16_bf16 v[64:79], v[116:119], v[124:127], v[64:79]
    v_exp_f32 v52, v52
    v_exp_f32 v53, v53
    v_exp_f32 v54, v54
    v_exp_f32 v55, v55
    v_cvt_pk_bf16_f32 v122, v52, v53
    v_cvt_pk_bf16_f32 v123, v54, v55
    v_mfma_f32_32x32x16_bf16 v[32:47], v[108:111], v[100:103], v[32:47]
    ds_read_b128 v[104:107], v3 offset:12288
    ds_read_b128 v[108:111], v3 offset:13312
    ds_read_b128 v[116:119], v20 offset:39936
    v_exp_f32 v56, v56
    v_exp_f32 v57, v57
    v_exp_f32 v58, v58
    v_exp_f32 v59, v59
    s_waitcnt lgkmcnt(3)
    v_mfma_f32_32x32x16_bf16 v[64:79], v[112:115], v[120:123], v[64:79]
    v_cvt_pk_bf16_f32 v144, v136, v137
    v_cvt_pk_bf16_f32 v145, v138, v139
    v_cvt_pk_bf16_f32 v146, v140, v141
    v_cvt_pk_bf16_f32 v147, v142, v143
    buffer_store_dwordx4 v[144:147], v13, s[16:19], s77 offen sc1
    v_exp_f32 v60, v60
    v_exp_f32 v61, v61
    v_smfmac_f32_16x16x64_bf16 v[4:7], v[8:11], v[120:127], v23
    v_mov_b32 v20, v3
    ds_read_b128 v[112:115], v20 offset:2048
    v_exp_f32 v62, v62
    v_exp_f32 v63, v63
    v_cvt_pk_bf16_f32 v124, v56, v57
    v_cvt_pk_bf16_f32 v125, v58, v59
    v_cvt_pk_bf16_f32 v126, v60, v61
    v_cvt_pk_bf16_f32 v127, v62, v63
    s_waitcnt lgkmcnt(1)
    v_mfma_f32_32x32x16_bf16 v[48:63], v[104:107], v[96:99], v[80:95]
    v_exp_f32 v32, v32
    v_exp_f32 v33, v33
    v_exp_f32 v34, v34
    v_exp_f32 v35, v35
    v_cvt_pk_bf16_f32 v120, v32, v33
    v_cvt_pk_bf16_f32 v121, v34, v35
    v_mfma_f32_32x32x16_bf16 v[64:79], v[116:119], v[124:127], v[64:79]
    v_exp_f32 v36, v36
    v_exp_f32 v37, v37
    v_exp_f32 v38, v38
    v_exp_f32 v39, v39
    v_cvt_pk_bf16_f32 v122, v36, v37
    v_cvt_pk_bf16_f32 v123, v38, v39
    v_mfma_f32_32x32x16_bf16 v[48:63], v[108:111], v[100:103], v[48:63]
    ds_read_b128 v[104:107], v3 offset:24576
    ds_read_b128 v[108:111], v3 offset:25600
    ds_read_b128 v[116:119], v20 offset:3072
    v_exp_f32 v40, v40
    v_exp_f32 v41, v41
    v_exp_f32 v42, v42
    v_exp_f32 v43, v43
    s_waitcnt lgkmcnt(3)
    v_mfma_f32_32x32x16_bf16 v[64:79], v[112:115], v[120:123], v[64:79]
    v_exp_f32 v44, v44
    v_exp_f32 v45, v45
    v_smfmac_f32_16x16x64_bf16 v[4:7], v[8:11], v[120:127], v23
    ds_read_b128 v[112:115], v20 offset:14336
    v_exp_f32 v46, v46
    v_exp_f32 v47, v47
    v_cvt_pk_bf16_f32 v124, v40, v41
    v_cvt_pk_bf16_f32 v125, v42, v43
    v_cvt_pk_bf16_f32 v126, v44, v45
    v_cvt_pk_bf16_f32 v127, v46, v47
    s_waitcnt lgkmcnt(1)
    v_mfma_f32_32x32x16_bf16 v[32:47], v[104:107], v[96:99], v[80:95]
    v_exp_f32 v48, v48
    v_exp_f32 v49, v49
    v_exp_f32 v50, v50
    v_exp_f32 v51, v51
    v_cvt_pk_bf16_f32 v120, v48, v49
    v_cvt_pk_bf16_f32 v121, v50, v51
    v_mfma_f32_32x32x16_bf16 v[64:79], v[116:119], v[124:127], v[64:79]
    v_exp_f32 v52, v52
    v_exp_f32 v53, v53
    v_exp_f32 v54, v54
    v_exp_f32 v55, v55
    v_cvt_pk_bf16_f32 v122, v52, v53
    v_cvt_pk_bf16_f32 v123, v54, v55
    v_mfma_f32_32x32x16_bf16 v[32:47], v[108:111], v[100:103], v[32:47]
    ds_read_b128 v[104:107], v3 offset:36864
    ds_read_b128 v[108:111], v3 offset:37888
    ds_read_b128 v[116:119], v20 offset:15360
    v_exp_f32 v56, v56
    v_exp_f32 v57, v57
    v_exp_f32 v58, v58
    v_exp_f32 v59, v59
    s_waitcnt lgkmcnt(3)
    v_mfma_f32_32x32x16_bf16 v[64:79], v[112:115], v[120:123], v[64:79]
    v_exp_f32 v60, v60
    v_exp_f32 v61, v61
    v_smfmac_f32_16x16x64_bf16 v[4:7], v[8:11], v[120:127], v23
    ds_read_b128 v[112:115], v20 offset:26624
    v_exp_f32 v62, v62
    v_exp_f32 v63, v63
    v_cvt_pk_bf16_f32 v124, v56, v57
    v_cvt_pk_bf16_f32 v125, v58, v59
    v_cvt_pk_bf16_f32 v126, v60, v61
    v_cvt_pk_bf16_f32 v127, v62, v63
    s_waitcnt lgkmcnt(1)
    v_mfma_f32_32x32x16_bf16 v[48:63], v[104:107], v[96:99], v[80:95]
    v_exp_f32 v32, v32
    v_exp_f32 v33, v33
    v_exp_f32 v34, v34
    v_exp_f32 v35, v35
    v_cvt_pk_bf16_f32 v120, v32, v33
    v_cvt_pk_bf16_f32 v121, v34, v35
    v_mfma_f32_32x32x16_bf16 v[64:79], v[116:119], v[124:127], v[64:79]
    v_exp_f32 v36, v36
    v_exp_f32 v37, v37
    v_exp_f32 v38, v38
    v_exp_f32 v39, v39
    v_cvt_pk_bf16_f32 v122, v36, v37
    v_cvt_pk_bf16_f32 v123, v38, v39
    v_mfma_f32_32x32x16_bf16 v[48:63], v[108:111], v[100:103], v[48:63]
    s_waitcnt vmcnt(0)
    s_barrier
    s_add_u32 s37, s37, 4096
    s_cmp_eq_u32 s37, 77824
    s_cselect_b32 s37, 65536, s37
    v_add_u32 v3, s37, v2
    ds_read_b128 v[104:107], v3 offset:0
    ds_read_b128 v[108:111], v3 offset:1024
    ds_read_b128 v[116:119], v20 offset:27648
    v_exp_f32 v40, v40
    v_exp_f32 v41, v41
    v_exp_f32 v42, v42
    v_exp_f32 v43, v43
    s_waitcnt lgkmcnt(3)
    v_mfma_f32_32x32x16_bf16 v[64:79], v[112:115], v[120:123], v[64:79]
    s_add_u32 s24, s40, 32768
    s_and_b32 s24, s24, 0x3ffff
    s_andn2_b32 s40, s40, 0x3ffff
    s_or_b32 s40, s40, s24
    s_add_u32 s41, s41, 4096
    s_cmp_eq_u32 s41, 12288
    s_cselect_b32 s41, 0, s41
    s_add_u32 m0, s32, s41
    s_nop 0
    buffer_load_dwordx4 v2, s[16:19], s40 offen offset:0 sc1 lds
    s_cmp_lg_u32 s3, 0
    s_cbranch_scc1 L_fa
    s_and_b32 s24, s2, 7
    s_lshl_b32 s24, s24, 7
    s_lshr_b32 s25, s2, 3
    s_lshl2_add_u32 s24, s25, s24
    s_add_u32 s24, s24, 0x150c000
    v_mov_b32 v18, s6
    buffer_store_dword v18, v21, s[16:19], s24 offen sc1
L_fa:
    v_exp_f32 v44, v44
    v_exp_f32 v45, v45
    v_smfmac_f32_16x16x64_bf16 v[4:7], v[8:11], v[120:127], v23
    ds_read_b128 v[112:115], v20 offset:38912
    buffer_load_dwordx4 v2, s[16:19], s40 offen offset:1024 sc1 lds
    v_exp_f32 v46, v46
    v_exp_f32 v47, v47
    v_cvt_pk_bf16_f32 v124, v40, v41
    v_cvt_pk_bf16_f32 v125, v42, v43
    v_cvt_pk_bf16_f32 v126, v44, v45
    v_cvt_pk_bf16_f32 v127, v46, v47
    s_waitcnt lgkmcnt(1)
    v_mfma_f32_32x32x16_bf16 v[32:47], v[104:107], v[96:99], v[80:95]
    v_exp_f32 v48, v48
    v_exp_f32 v49, v49
    buffer_load_dwordx4 v2, s[16:19], s40 offen offset:2048 sc1 lds
    v_exp_f32 v50, v50
    v_exp_f32 v51, v51
    v_cvt_pk_bf16_f32 v120, v48, v49
    v_cvt_pk_bf16_f32 v121, v50, v51
    v_mfma_f32_32x32x16_bf16 v[64:79], v[116:119], v[124:127], v[64:79]
    v_exp_f32 v52, v52
    v_exp_f32 v53, v53
    v_exp_f32 v54, v54
    v_exp_f32 v55, v55
    v_cvt_pk_bf16_f32 v122, v52, v53
    v_cvt_pk_bf16_f32 v123, v54, v55
    v_mfma_f32_32x32x16_bf16 v[32:47], v[108:111], v[100:103], v[32:47]
    ds_read_b128 v[104:107], v3 offset:12288
    ds_read_b128 v[108:111], v3 offset:13312
    ds_read_b128 v[116:119], v20 offset:39936
    v_exp_f32 v56, v56
    v_exp_f32 v57, v57
    v_exp_f32 v58, v58
    v_exp_f32 v59, v59
    s_waitcnt lgkmcnt(3)
    v_mfma_f32_32x32x16_bf16 v[64:79], v[112:115], v[120:123], v[64:79]
    buffer_load_dwordx4 v2, s[16:19], s40 offen offset:3072 sc1 lds
    v_exp_f32 v60, v60
    v_exp_f32 v61, v61
    v_smfmac_f32_16x16x64_bf16 v[4:7], v[8:11], v[120:127], v23
    v_mov_b32 v20, v3
    ds_read_b128 v[112:115], v20 offset:2048
    v_exp_f32 v62, v62
    v_exp_f32 v63, v63
    v_cvt_pk_bf16_f32 v124, v56, v57
    v_cvt_pk_bf16_f32 v125, v58, v59
    v_cvt_pk_bf16_f32 v126, v60, v61
    v_cvt_pk_bf16_f32 v127, v62, v63
    s_waitcnt lgkmcnt(1)
    v_mfma_f32_32x32x16_bf16 v[48:63], v[104:107], v[96:99], v[80:95]
    v_exp_f32 v32, v32
    v_exp_f32 v33, v33
    buffer_load_dwordx4 v[136:139], v2, s[16:19], s70 offen offset:0 sc1
    v_exp_f32 v34, v34
    v_exp_f32 v35, v35
    v_cvt_pk_bf16_f32 v120, v32, v33
    v_cvt_pk_bf16_f32 v121, v34, v35
    v_mfma_f32_32x32x16_bf16 v[64:79], v[116:119], v[124:127], v[64:79]
    v_exp_f32 v36, v36
    v_exp_f32 v37, v37
    v_exp_f32 v38, v38
    v_exp_f32 v39, v39
    v_cvt_pk_bf16_f32 v122, v36, v37
    v_cvt_pk_bf16_f32 v123, v38, v39
    v_mfma_f32_32x32x16_bf16 v[48:63], v[108:111], v[100:103], v[48:63]
    ds_read_b128 v[104:107], v3 offset:24576
    ds_read_b128 v[108:111], v3 offset:25600
    ds_read_b128 v[116:119], v20 offset:3072
    v_exp_f32 v40, v40
    v_exp_f32 v41, v41
    v_exp_f32 v42, v42
    v_exp_f32 v43, v43
    s_waitcnt lgkmcnt(3)
    v_mfma_f32_32x32x16_bf16 v[64:79], v[112:115], v[120:123], v[64:79]
    v_exp_f32 v44, v44
    v_exp_f32 v45, v45
    v_smfmac_f32_16x16x64_bf16 v[4:7], v[8:11], v[120:127], v23
    ds_read_b128 v[112:115], v20 offset:14336
    v_exp_f32 v46, v46
    v_exp_f32 v47, v47
    v_cvt_pk_bf16_f32 v124, v40, v41
    v_cvt_pk_bf16_f32 v125, v42, v43
    v_cvt_pk_bf16_f32 v126, v44, v45
    v_cvt_pk_bf16_f32 v127, v46, v47
    s_waitcnt lgkmcnt(1)
    v_mfma_f32_32x32x16_bf16 v[32:47], v[104:107], v[96:99], v[80:95]
    v_exp_f32 v48, v48
    v_exp_f32 v49, v49
    buffer_load_dwordx4 v[140:143], v2, s[16:19], s70 offen offset:1024 sc1
    v_exp_f32 v50, v50
    v_exp_f32 v51, v51
    v_cvt_pk_bf16_f32 v120, v48, v49
    v_cvt_pk_bf16_f32 v121, v50, v51
    v_mfma_f32_32x32x16_bf16 v[64:79], v[116:119], v[124:127], v[64:79]
    v_exp_f32 v52, v52
    v_exp_f32 v53, v53
    v_exp_f32 v54, v54
    v_exp_f32 v55, v55
    v_cvt_pk_bf16_f32 v122, v52, v53
    v_cvt_pk_bf16_f32 v123, v54, v55
    v_mfma_f32_32x32x16_bf16 v[32:47], v[108:111], v[100:103], v[32:47]
    ds_read_b128 v[104:107], v3 offset:36864
    ds_read_b128 v[108:111], v3 offset:37888
    ds_read_b128 v[116:119], v20 offset:15360
    v_exp_f32 v56, v56
    v_exp_f32 v57, v57
    v_exp_f32 v58, v58
    v_exp_f32 v59, v59
    s_waitcnt lgkmcnt(3)
    v_mfma_f32_32x32x16_bf16 v[64:79], v[112:115], v[120:123], v[64:79]
    v_exp_f32 v60, v60
    v_exp_f32 v61, v61
    v_smfmac_f32_16x16x64_bf16 v[4:7], v[8:11], v[120:127], v23
    ds_read_b128 v[112:115], v20 offset:26624
    v_exp_f32 v62, v62
    v_exp_f32 v63, v63
    v_cvt_pk_bf16_f32 v124, v56, v57
    v_cvt_pk_bf16_f32 v125, v58, v59
    v_cvt_pk_bf16_f32 v126, v60, v61
    v_cvt_pk_bf16_f32 v127, v62, v63
    s_waitcnt lgkmcnt(1)
    v_mfma_f32_32x32x16_bf16 v[48:63], v[104:107], v[96:99], v[80:95]
    v_exp_f32 v32, v32
    v_exp_f32 v33, v33
    buffer_load_dwordx4 v[144:147], v2, s[16:19], s70 offen offset:2048 sc1
    v_exp_f32 v34, v34
    v_exp_f32 v35, v35
    v_cvt_pk_bf16_f32 v120, v32, v33
    v_cvt_pk_bf16_f32 v121, v34, v35
    v_mfma_f32_32x32x16_bf16 v[64:79], v[116:119], v[124:127], v[64:79]
    v_exp_f32 v36, v36
    v_exp_f32 v37, v37
    v_exp_f32 v38, v38
    v_exp_f32 v39, v39
    v_cvt_pk_bf16_f32 v122, v36, v37
    v_cvt_pk_bf16_f32 v123, v38, v39
    v_mfma_f32_32x32x16_bf16 v[48:63], v[108:111], v[100:103], v[48:63]
    v_add_u32 v3, 49152, v3
    ds_read_b128 v[104:107], v3 offset:0
    ds_read_b128 v[108:111], v3 offset:1024
    ds_read_b128 v[116:119], v20 offset:27648
    v_exp_f32 v40, v40
    v_exp_f32 v41, v41
    v_exp_f32 v42, v42
    v_exp_f32 v43, v43
    s_waitcnt lgkmcnt(3)
    v_mfma_f32_32x32x16_bf16 v[64:79], v[112:115], v[120:123], v[64:79]
    v_exp_f32 v44, v44
    v_exp_f32 v45, v45
    v_smfmac_f32_16x16x64_bf16 v[4:7], v[8:11], v[120:127], v23
    ds_read_b128 v[112:115], v20 offset:38912
    v_exp_f32 v46, v46
    v_exp_f32 v47, v47
    v_cvt_pk_bf16_f32 v124, v40, v41
    v_cvt_pk_bf16_f32 v125, v42, v43
    v_cvt_pk_bf16_f32 v126, v44, v45
    v_cvt_pk_bf16_f32 v127, v46, v47
    s_waitcnt lgkmcnt(1)
    v_mfma_f32_32x32x16_bf16 v[32:47], v[104:107], v[96:99], v[80:95]
    v_exp_f32 v48, v48
    v_exp_f32 v49, v49
    buffer_load_dwordx4 v[148:151], v2, s[16:19], s70 offen offset:3072 sc1
    v_exp_f32 v50, v50
    v_exp_f32 v51, v51
    v_cvt_pk_bf16_f32 v120, v48, v49
    v_cvt_pk_bf16_f32 v121, v50, v51
    v_mfma_f32_32x32x16_bf16 v[64:79], v[116:119], v[124:127], v[64:79]
    v_exp_f32 v52, v52
    v_exp_f32 v53, v53
    v_exp_f32 v54, v54
    v_exp_f32 v55, v55
    v_cvt_pk_bf16_f32 v122, v52, v53
    v_cvt_pk_bf16_f32 v123, v54, v55
    v_mfma_f32_32x32x16_bf16 v[32:47], v[108:111], v[100:103], v[32:47]
    ds_read_b128 v[104:107], v3 offset:12288
    ds_read_b128 v[108:111], v3 offset:13312
    ds_read_b128 v[116:119], v20 offset:39936
    v_exp_f32 v56, v56
    v_exp_f32 v57, v57
    v_exp_f32 v58, v58
    v_exp_f32 v59, v59
    s_waitcnt lgkmcnt(3)
    v_mfma_f32_32x32x16_bf16 v[64:79], v[112:115], v[120:123], v[64:79]
    v_exp_f32 v60, v60
    v_exp_f32 v61, v61
    v_smfmac_f32_16x16x64_bf16 v[4:7], v[8:11], v[120:127], v23
    v_mov_b32 v20, v3
    ds_read_b128 v[112:115], v20 offset:2048
    v_exp_f32 v62, v62
    v_exp_f32 v63, v63
    v_cvt_pk_bf16_f32 v124, v56, v57
    v_cvt_pk_bf16_f32 v125, v58, v59
    v_cvt_pk_bf16_f32 v126, v60, v61
    v_cvt_pk_bf16_f32 v127, v62, v63
    s_waitcnt lgkmcnt(1)
    v_mfma_f32_32x32x16_bf16 v[48:63], v[104:107], v[96:99], v[80:95]
    v_exp_f32 v32, v32
    v_exp_f32 v33, v33
    buffer_load_dwordx4 v[152:155], v2, s[16:19], s71 offen offset:0 sc1
    v_exp_f32 v34, v34
    v_exp_f32 v35, v35
    v_cvt_pk_bf16_f32 v120, v32, v33
    v_cvt_pk_bf16_f32 v121, v34, v35
    v_mfma_f32_32x32x16_bf16 v[64:79], v[116:119], v[124:127], v[64:79]
    v_exp_f32 v36, v36
    v_exp_f32 v37, v37
    v_exp_f32 v38, v38
    v_exp_f32 v39, v39
    v_cvt_pk_bf16_f32 v122, v36, v37
    v_cvt_pk_bf16_f32 v123, v38, v39
    v_mfma_f32_32x32x16_bf16 v[48:63], v[108:111], v[100:103], v[48:63]
    ds_read_b128 v[104:107], v3 offset:24576
    ds_read_b128 v[108:111], v3 offset:25600
    ds_read_b128 v[116:119], v20 offset:3072
    v_exp_f32 v40, v40
    v_exp_f32 v41, v41
    v_exp_f32 v42, v42
    v_exp_f32 v43, v43
    s_waitcnt lgkmcnt(3)
    v_mfma_f32_32x32x16_bf16 v[64:79], v[112:115], v[120:123], v[64:79]
    v_exp_f32 v44, v44
    v_exp_f32 v45, v45
    v_smfmac_f32_16x16x64_bf16 v[4:7], v[8:11], v[120:127], v23
    ds_read_b128 v[112:115], v20 offset:14336
    v_exp_f32 v46, v46
    v_exp_f32 v47, v47
    v_cvt_pk_bf16_f32 v124, v40, v41
    v_cvt_pk_bf16_f32 v125, v42, v43
    v_cvt_pk_bf16_f32 v126, v44, v45
    v_cvt_pk_bf16_f32 v127, v46, v47
    s_waitcnt lgkmcnt(1)
    v_mfma_f32_32x32x16_bf16 v[32:47], v[104:107], v[96:99], v[80:95]
    v_exp_f32 v48, v48
    v_exp_f32 v49, v49
    buffer_load_dwordx4 v[156:159], v2, s[16:19], s71 offen offset:1024 sc1
    v_exp_f32 v50, v50
    v_exp_f32 v51, v51
    v_cvt_pk_bf16_f32 v120, v48, v49
    v_cvt_pk_bf16_f32 v121, v50, v51
    v_mfma_f32_32x32x16_bf16 v[64:79], v[116:119], v[124:127], v[64:79]
    v_exp_f32 v52, v52
    v_exp_f32 v53, v53
    v_exp_f32 v54, v54
    v_exp_f32 v55, v55
    v_cvt_pk_bf16_f32 v122, v52, v53
    v_cvt_pk_bf16_f32 v123, v54, v55
    v_mfma_f32_32x32x16_bf16 v[32:47], v[108:111], v[100:103], v[32:47]
    ds_read_b128 v[104:107], v3 offset:36864
    ds_read_b128 v[108:111], v3 offset:37888
    ds_read_b128 v[116:119], v20 offset:15360
    v_exp_f32 v56, v56
    v_exp_f32 v57, v57
    v_exp_f32 v58, v58
    v_exp_f32 v59, v59
    s_waitcnt lgkmcnt(3)
    v_mfma_f32_32x32x16_bf16 v[64:79], v[112:115], v[120:123], v[64:79]
    v_exp_f32 v60, v60
    v_exp_f32 v61, v61
    v_smfmac_f32_16x16x64_bf16 v[4:7], v[8:11], v[120:127], v23
    ds_read_b128 v[112:115], v20 offset:26624
    v_exp_f32 v62, v62
    v_exp_f32 v63, v63
    v_cvt_pk_bf16_f32 v124, v56, v57
    v_cvt_pk_bf16_f32 v125, v58, v59
    v_cvt_pk_bf16_f32 v126, v60, v61
    v_cvt_pk_bf16_f32 v127, v62, v63
    s_waitcnt lgkmcnt(1)
    v_mfma_f32_32x32x16_bf16 v[48:63], v[104:107], v[96:99], v[80:95]
    v_exp_f32 v32, v32
    v_exp_f32 v33, v33
    buffer_load_dwordx4 v[160:163], v2, s[16:19], s71 offen offset:2048 sc1
    v_exp_f32 v34, v34
    v_exp_f32 v35, v35
    v_cvt_pk_bf16_f32 v120, v32, v33
    v_cvt_pk_bf16_f32 v121, v34, v35
    v_mfma_f32_32x32x16_bf16 v[64:79], v[116:119], v[124:127], v[64:79]
    v_exp_f32 v36, v36
    v_exp_f32 v37, v37
    v_exp_f32 v38, v38
    v_exp_f32 v39, v39
    v_cvt_pk_bf16_f32 v122, v36, v37
    v_cvt_pk_bf16_f32 v123, v38, v39
    v_mfma_f32_32x32x16_bf16 v[48:63], v[108:111], v[100:103], v[48:63]
    s_waitcnt vmcnt(7)
    s_barrier
    s_add_u32 s37, s37, 4096
    s_cmp_eq_u32 s37, 77824
    s_cselect_b32 s37, 65536, s37
    v_add_u32 v3, s37, v2
    ds_read_b128 v[104:107], v3 offset:0
    ds_read_b128 v[108:111], v3 offset:1024
    ds_read_b128 v[116:119], v20 offset:27648
    v_exp_f32 v40, v40
    v_exp_f32 v41, v41
    v_exp_f32 v42, v42
    v_exp_f32 v43, v43
    s_waitcnt lgkmcnt(3)
    v_mfma_f32_32x32x16_bf16 v[64:79], v[112:115], v[120:123], v[64:79]
    s_add_u32 s24, s40, 32768
    s_and_b32 s24, s24, 0x3ffff
    s_andn2_b32 s40, s40, 0x3ffff
    s_or_b32 s40, s40, s24
    s_add_u32 s41, s41, 4096
    s_cmp_eq_u32 s41, 12288
    s_cselect_b32 s41, 0, s41
    s_add_u32 m0, s32, s41
    s_nop 0
    buffer_load_dwordx4 v2, s[16:19], s40 offen offset:0 sc1 lds
    v_exp_f32 v44, v44
    v_exp_f32 v45, v45
    v_smfmac_f32_16x16x64_bf16 v[4:7], v[8:11], v[120:127], v23
    ds_read_b128 v[112:115], v20 offset:38912
    buffer_load_dwordx4 v2, s[16:19], s40 offen offset:1024 sc1 lds
    v_exp_f32 v46, v46
    v_exp_f32 v47, v47
    v_cvt_pk_bf16_f32 v124, v40, v41
    v_cvt_pk_bf16_f32 v125, v42, v43
    v_cvt_pk_bf16_f32 v126, v44, v45
    v_cvt_pk_bf16_f32 v127, v46, v47
    s_waitcnt lgkmcnt(1)
    v_mfma_f32_32x32x16_bf16 v[32:47], v[104:107], v[96:99], v[80:95]
    v_exp_f32 v48, v48
    v_exp_f32 v49, v49
    buffer_load_dwordx4 v2, s[16:19], s40 offen offset:2048 sc1 lds
    buffer_load_dwordx4 v[164:167], v2, s[16:19], s71 offen offset:3072 sc1
    v_exp_f32 v50, v50
    v_exp_f32 v51, v51
    v_cvt_pk_bf16_f32 v120, v48, v49
    v_cvt_pk_bf16_f32 v121, v50, v51
    v_mfma_f32_32x32x16_bf16 v[64:79], v[116:119], v[124:127], v[64:79]
    v_exp_f32 v52, v52
    v_exp_f32 v53, v53
    v_exp_f32 v54, v54
    v_exp_f32 v55, v55
    v_cvt_pk_bf16_f32 v122, v52, v53
    v_cvt_pk_bf16_f32 v123, v54, v55
    v_mfma_f32_32x32x16_bf16 v[32:47], v[108:111], v[100:103], v[32:47]
    ds_read_b128 v[104:107], v3 offset:12288
    ds_read_b128 v[108:111], v3 offset:13312
    ds_read_b128 v[116:119], v20 offset:39936
    v_exp_f32 v56, v56
    v_exp_f32 v57, v57
    v_exp_f32 v58, v58
    v_exp_f32 v59, v59
    s_waitcnt lgkmcnt(3)
    v_mfma_f32_32x32x16_bf16 v[64:79], v[112:115], v[120:123], v[64:79]
    buffer_load_dwordx4 v2, s[16:19], s40 offen offset:3072 sc1 lds
    v_exp_f32 v60, v60
    v_exp_f32 v61, v61
    v_smfmac_f32_16x16x64_bf16 v[4:7], v[8:11], v[120:127], v23
    v_mov_b32 v20, v3
    ds_read_b128 v[112:115], v20 offset:2048
    v_exp_f32 v62, v62
    v_exp_f32 v63, v63
    v_cvt_pk_bf16_f32 v124, v56, v57
    v_cvt_pk_bf16_f32 v125, v58, v59
    v_cvt_pk_bf16_f32 v126, v60, v61
    v_cvt_pk_bf16_f32 v127, v62, v63
    s_waitcnt lgkmcnt(1)
    v_mfma_f32_32x32x16_bf16 v[48:63], v[104:107], v[96:99], v[80:95]
    v_exp_f32 v32, v32
    v_exp_f32 v33, v33
    v_exp_f32 v34, v34
    v_exp_f32 v35, v35
    v_cvt_pk_bf16_f32 v120, v32, v33
    v_cvt_pk_bf16_f32 v121, v34, v35
    v_mfma_f32_32x32x16_bf16 v[64:79], v[116:119], v[124:127], v[64:79]
    v_exp_f32 v36, v36
    v_exp_f32 v37, v37
    v_exp_f32 v38, v38
    v_exp_f32 v39, v39
    v_cvt_pk_bf16_f32 v122, v36, v37
    v_cvt_pk_bf16_f32 v123, v38, v39
    v_mfma_f32_32x32x16_bf16 v[48:63], v[108:111], v[100:103], v[48:63]
    ds_read_b128 v[104:107], v3 offset:24576
    ds_read_b128 v[108:111], v3 offset:25600
    ds_read_b128 v[116:119], v20 offset:3072
    v_exp_f32 v40, v40
    v_exp_f32 v41, v41
    v_exp_f32 v42, v42
    v_exp_f32 v43, v43
    s_waitcnt lgkmcnt(3)
    v_mfma_f32_32x32x16_bf16 v[64:79], v[112:115], v[120:123], v[64:79]
    v_exp_f32 v44, v44
    v_exp_f32 v45, v45
    v_smfmac_f32_16x16x64_bf16 v[4:7], v[8:11], v[120:127], v23
    ds_read_b128 v[112:115], v20 offset:14336
    v_exp_f32 v46, v46
    v_exp_f32 v47, v47
    v_cvt_pk_bf16_f32 v124, v40, v41
    v_cvt_pk_bf16_f32 v125, v42, v43
    v_cvt_pk_bf16_f32 v126, v44, v45
    v_cvt_pk_bf16_f32 v127, v46, v47
    s_waitcnt lgkmcnt(1)
    v_mfma_f32_32x32x16_bf16 v[32:47], v[104:107], v[96:99], v[80:95]
    v_exp_f32 v48, v48
    v_exp_f32 v49, v49
    v_exp_f32 v50, v50
    v_exp_f32 v51, v51
    v_cvt_pk_bf16_f32 v120, v48, v49
    v_cvt_pk_bf16_f32 v121, v50, v51
    v_mfma_f32_32x32x16_bf16 v[64:79], v[116:119], v[124:127], v[64:79]
    v_exp_f32 v52, v52
    v_exp_f32 v53, v53
    v_exp_f32 v54, v54
    v_exp_f32 v55, v55
    v_cvt_pk_bf16_f32 v122, v52, v53
    v_cvt_pk_bf16_f32 v123, v54, v55
    v_mfma_f32_32x32x16_bf16 v[32:47], v[108:111], v[100:103], v[32:47]
    ds_read_b128 v[104:107], v3 offset:36864
    ds_read_b128 v[108:111], v3 offset:37888
    ds_read_b128 v[116:119], v20 offset:15360
    v_exp_f32 v56, v56
    v_exp_f32 v57, v57
    v_exp_f32 v58, v58
    v_exp_f32 v59, v59
    s_waitcnt lgkmcnt(3)
    v_mfma_f32_32x32x16_bf16 v[64:79], v[112:115], v[120:123], v[64:79]
    v_exp_f32 v60, v60
    v_exp_f32 v61, v61
    v_smfmac_f32_16x16x64_bf16 v[4:7], v[8:11], v[120:127], v23
    ds_read_b128 v[112:115], v20 offset:26624
    v_exp_f32 v62, v62
    v_exp_f32 v63, v63
    v_cvt_pk_bf16_f32 v124, v56, v57
    v_cvt_pk_bf16_f32 v125, v58, v59
    v_cvt_pk_bf16_f32 v126, v60, v61
    v_cvt_pk_bf16_f32 v127, v62, v63
    s_waitcnt lgkmcnt(1)
    v_mfma_f32_32x32x16_bf16 v[48:63], v[104:107], v[96:99], v[80:95]
    v_exp_f32 v32, v32
    v_exp_f32 v33, v33
    v_exp_f32 v34, v34
    v_exp_f32 v35, v35
    v_cvt_pk_bf16_f32 v120, v32, v33
    v_cvt_pk_bf16_f32 v121, v34, v35
    v_mfma_f32_32x32x16_bf16 v[64:79], v[116:119], v[124:127], v[64:79]
    v_exp_f32 v36, v36
    v_exp_f32 v37, v37
    v_exp_f32 v38, v38
    v_exp_f32 v39, v39
    v_cvt_pk_bf16_f32 v122, v36, v37
    v_cvt_pk_bf16_f32 v123, v38, v39
    v_mfma_f32_32x32x16_bf16 v[48:63], v[108:111], v[100:103], v[48:63]
    v_add_u32 v3, 49152, v3
    ds_read_b128 v[104:107], v3 offset:0
    ds_read_b128 v[108:111], v3 offset:1024
    ds_read_b128 v[116:119], v20 offset:27648
    v_exp_f32 v40, v40
    v_exp_f32 v41, v41
    v_exp_f32 v42, v42
    v_exp_f32 v43, v43
    s_waitcnt lgkmcnt(3)
    v_mfma_f32_32x32x16_bf16 v[64:79], v[112:115], v[120:123], v[64:79]
    v_exp_f32 v44, v44
    v_exp_f32 v45, v45
    v_smfmac_f32_16x16x64_bf16 v[4:7], v[8:11], v[120:127], v23
    ds_read_b128 v[112:115], v20 offset:38912
    v_exp_f32 v46, v46
    v_exp_f32 v47, v47
    v_cvt_pk_bf16_f32 v124, v40, v41
    v_cvt_pk_bf16_f32 v125, v42, v43
    v_cvt_pk_bf16_f32 v126, v44, v45
    v_cvt_pk_bf16_f32 v127, v46, v47
    s_waitcnt lgkmcnt(1)
    v_mfma_f32_32x32x16_bf16 v[32:47], v[104:107], v[96:99], v[80:95]
    v_exp_f32 v48, v48
    v_exp_f32 v49, v49
    v_exp_f32 v50, v50
    v_exp_f32 v51, v51
    v_cvt_pk_bf16_f32 v120, v48, v49
    v_cvt_pk_bf16_f32 v121, v50, v51
    v_mfma_f32_32x32x16_bf16 v[64:79], v[116:119], v[124:127], v[64:79]
    v_exp_f32 v52, v52
    v_exp_f32 v53, v53
    v_exp_f32 v54, v54
    v_exp_f32 v55, v55
    v_cvt_pk_bf16_f32 v122, v52, v53
    v_cvt_pk_bf16_f32 v123, v54, v55
    v_mfma_f32_32x32x16_bf16 v[32:47], v[108:111], v[100:103], v[32:47]
    ds_read_b128 v[104:107], v3 offset:12288
    ds_read_b128 v[108:111], v3 offset:13312
    ds_read_b128 v[116:119], v20 offset:39936
    v_exp_f32 v56, v56
    v_exp_f32 v57, v57
    v_exp_f32 v58, v58
    v_exp_f32 v59, v59
    s_waitcnt lgkmcnt(3)
    v_mfma_f32_32x32x16_bf16 v[64:79], v[112:115], v[120:123], v[64:79]
    v_exp_f32 v60, v60
    v_exp_f32 v61, v61
    v_smfmac_f32_16x16x64_bf16 v[4:7], v[8:11], v[120:127], v23
    v_mov_b32 v20, v3
    ds_read_b128 v[112:115], v20 offset:2048
    v_exp_f32 v62, v62
    v_exp_f32 v63, v63
    v_cvt_pk_bf16_f32 v124, v56, v57
    v_cvt_pk_bf16_f32 v125, v58, v59
    v_cvt_pk_bf16_f32 v126, v60, v61
    v_cvt_pk_bf16_f32 v127, v62, v63
    s_waitcnt lgkmcnt(1)
    v_mfma_f32_32x32x16_bf16 v[48:63], v[104:107], v[96:99], v[80:95]
    v_exp_f32 v32, v32
    v_exp_f32 v33, v33
    v_exp_f32 v34, v34
    v_exp_f32 v35, v35
    v_cvt_pk_bf16_f32 v120, v32, v33
    v_cvt_pk_bf16_f32 v121, v34, v35
    v_mfma_f32_32x32x16_bf16 v[64:79], v[116:119], v[124:127], v[64:79]
    v_exp_f32 v36, v36
    v_exp_f32 v37, v37
    v_exp_f32 v38, v38
    v_exp_f32 v39, v39
    v_cvt_pk_bf16_f32 v122, v36, v37
    v_cvt_pk_bf16_f32 v123, v38, v39
    v_mfma_f32_32x32x16_bf16 v[48:63], v[108:111], v[100:103], v[48:63]
    ds_read_b128 v[104:107], v3 offset:24576
    ds_read_b128 v[108:111], v3 offset:25600
    ds_read_b128 v[116:119], v20 offset:3072
    v_exp_f32 v40, v40
    v_exp_f32 v41, v41
    v_exp_f32 v42, v42
    v_exp_f32 v43, v43
    s_waitcnt lgkmcnt(3)
    v_mfma_f32_32x32x16_bf16 v[64:79], v[112:115], v[120:123], v[64:79]
    v_exp_f32 v44, v44
    v_exp_f32 v45, v45
    v_smfmac_f32_16x16x64_bf16 v[4:7], v[8:11], v[120:127], v23
    ds_read_b128 v[112:115], v20 offset:14336
    v_exp_f32 v46, v46
    v_exp_f32 v47, v47
    v_cvt_pk_bf16_f32 v124, v40, v41
    v_cvt_pk_bf16_f32 v125, v42, v43
    v_cvt_pk_bf16_f32 v126, v44, v45
    v_cvt_pk_bf16_f32 v127, v46, v47
    s_waitcnt lgkmcnt(1)
    v_mfma_f32_32x32x16_bf16 v[32:47], v[104:107], v[96:99], v[80:95]
    v_exp_f32 v48, v48
    v_exp_f32 v49, v49
    s_mov_b32 s24, 0x150c000
    buffer_load_dwordx4 v[240:243], v2, s[16:19], s24 offen sc1
    v_exp_f32 v50, v50
    v_exp_f32 v51, v51
    v_cvt_pk_bf16_f32 v120, v48, v49
    v_cvt_pk_bf16_f32 v121, v50, v51
    v_mfma_f32_32x32x16_bf16 v[64:79], v[116:119], v[124:127], v[64:79]
    v_exp_f32 v52, v52
    v_exp_f32 v53, v53
    v_exp_f32 v54, v54
    v_exp_f32 v55, v55
    v_cvt_pk_bf16_f32 v122, v52, v53
    v_cvt_pk_bf16_f32 v123, v54, v55
    v_mfma_f32_32x32x16_bf16 v[32:47], v[108:111], v[100:103], v[32:47]
    ds_read_b128 v[104:107], v3 offset:36864
    ds_read_b128 v[108:111], v3 offset:37888
    ds_read_b128 v[116:119], v20 offset:15360
    v_exp_f32 v56, v56
    v_exp_f32 v57, v57
    v_exp_f32 v58, v58
    v_exp_f32 v59, v59
    s_waitcnt lgkmcnt(3)
    v_mfma_f32_32x32x16_bf16 v[64:79], v[112:115], v[120:123], v[64:79]
    v_exp_f32 v60, v60
    v_exp_f32 v61, v61
    v_smfmac_f32_16x16x64_bf16 v[4:7], v[8:11], v[120:127], v23
    ds_read_b128 v[112:115], v20 offset:26624
    v_exp_f32 v62, v62
    v_exp_f32 v63, v63
    v_cvt_pk_bf16_f32 v124, v56, v57
    v_cvt_pk_bf16_f32 v125, v58, v59
    v_cvt_pk_bf16_f32 v126, v60, v61
    v_cvt_pk_bf16_f32 v127, v62, v63
    s_waitcnt lgkmcnt(1)
    v_mfma_f32_32x32x16_bf16 v[48:63], v[104:107], v[96:99], v[80:95]
    v_exp_f32 v32, v32
    v_exp_f32 v33, v33
    v_exp_f32 v34, v34
    v_exp_f32 v35, v35
    v_cvt_pk_bf16_f32 v120, v32, v33
    v_cvt_pk_bf16_f32 v121, v34, v35
    v_mfma_f32_32x32x16_bf16 v[64:79], v[116:119], v[124:127], v[64:79]
    v_exp_f32 v36, v36
    v_exp_f32 v37, v37
    v_exp_f32 v38, v38
    v_exp_f32 v39, v39
    v_cvt_pk_bf16_f32 v122, v36, v37
    v_cvt_pk_bf16_f32 v123, v38, v39
    v_mfma_f32_32x32x16_bf16 v[48:63], v[108:111], v[100:103], v[48:63]
    s_waitcnt vmcnt(1)
    s_barrier
    s_add_u32 s37, s37, 4096
    s_cmp_eq_u32 s37, 77824
    s_cselect_b32 s37, 65536, s37
    v_add_u32 v3, s37, v2
    ds_read_b128 v[104:107], v3 offset:0
    ds_read_b128 v[108:111], v3 offset:1024
    ds_read_b128 v[116:119], v20 offset:27648
    v_exp_f32 v40, v40
    v_exp_f32 v41, v41
    v_exp_f32 v42, v42
    v_exp_f32 v43, v43
    s_waitcnt lgkmcnt(3)
    v_mfma_f32_32x32x16_bf16 v[64:79], v[112:115], v[120:123], v[64:79]
    s_add_u32 s24, s40, 32768
    s_and_b32 s24, s24, 0x3ffff
    s_andn2_b32 s40, s40, 0x3ffff
    s_or_b32 s40, s40, s24
    s_add_u32 s41, s41, 4096
    s_cmp_eq_u32 s41, 12288
    s_cselect_b32 s41, 0, s41
    s_add_u32 m0, s32, s41
    s_nop 0
    buffer_load_dwordx4 v2, s[16:19], s40 offen offset:0 sc1 lds
    v_exp_f32 v44, v44
    v_exp_f32 v45, v45
    v_smfmac_f32_16x16x64_bf16 v[4:7], v[8:11], v[120:127], v23
    ds_read_b128 v[112:115], v20 offset:38912
    buffer_load_dwordx4 v2, s[16:19], s40 offen offset:1024 sc1 lds
    v_exp_f32 v46, v46
    v_exp_f32 v47, v47
    v_cvt_pk_bf16_f32 v124, v40, v41
    v_cvt_pk_bf16_f32 v125, v42, v43
    v_cvt_pk_bf16_f32 v126, v44, v45
    v_cvt_pk_bf16_f32 v127, v46, v47
    s_waitcnt lgkmcnt(1)
    v_mfma_f32_32x32x16_bf16 v[32:47], v[104:107], v[96:99], v[80:95]
    v_exp_f32 v48, v48
    v_exp_f32 v49, v49
    buffer_load_dwordx4 v2, s[16:19], s40 offen offset:2048 sc1 lds
    v_exp_f32 v50, v50
    v_exp_f32 v51, v51
    v_cvt_pk_bf16_f32 v120, v48, v49
    v_cvt_pk_bf16_f32 v121, v50, v51
    v_mfma_f32_32x32x16_bf16 v[64:79], v[116:119], v[124:127], v[64:79]
    v_exp_f32 v52, v52
    v_exp_f32 v53, v53
    v_exp_f32 v54, v54
    v_exp_f32 v55, v55
    v_cvt_pk_bf16_f32 v122, v52, v53
    v_cvt_pk_bf16_f32 v123, v54, v55
    v_mfma_f32_32x32x16_bf16 v[32:47], v[108:111], v[100:103], v[32:47]
    ds_read_b128 v[104:107], v3 offset:12288
    ds_read_b128 v[108:111], v3 offset:13312
    ds_read_b128 v[116:119], v20 offset:39936
    v_exp_f32 v56, v56
    v_exp_f32 v57, v57
    v_exp_f32 v58, v58
    v_exp_f32 v59, v59
    s_waitcnt lgkmcnt(3)
    v_mfma_f32_32x32x16_bf16 v[64:79], v[112:115], v[120:123], v[64:79]
    buffer_load_dwordx4 v2, s[16:19], s40 offen offset:3072 sc1 lds
    v_exp_f32 v60, v60
    v_exp_f32 v61, v61
    v_smfmac_f32_16x16x64_bf16 v[4:7], v[8:11], v[120:127], v23
    v_mov_b32 v20, v3
    ds_read_b128 v[112:115], v20 offset:2048
    v_exp_f32 v62, v62
    v_exp_f32 v63, v63
    v_cvt_pk_bf16_f32 v124, v56, v57
    v_cvt_pk_bf16_f32 v125, v58, v59
    v_cvt_pk_bf16_f32 v126, v60, v61
    v_cvt_pk_bf16_f32 v127, v62, v63
    s_waitcnt lgkmcnt(1)
    v_mfma_f32_32x32x16_bf16 v[48:63], v[104:107], v[96:99], v[80:95]
    v_exp_f32 v32, v32
    v_exp_f32 v33, v33
    s_waitcnt vmcnt(4)
    s_mov_b32 s39, 0
L_pa_spin:
    v_xor_b32 v240, s6, v240
    v_xor_b32 v241, s6, v241
    v_xor_b32 v242, s6, v242
    v_xor_b32 v243, s6, v243
    v_or3_b32 v240, v240, v241, v242
    v_or_b32 v240, v240, v243
    v_cmp_ne_u32 vcc, 0, v240
    s_cmp_eq_u64 vcc, 0
    s_cbranch_scc1 L_pa_ok
    s_sleep 8
    s_mov_b32 s24, 0x150c000
    buffer_load_dwordx4 v[240:243], v2, s[16:19], s24 offen sc1
    s_waitcnt vmcnt(0)
    s_add_u32 s39, s39, 1
    s_cmp_lt_u32 s39, 0x40000
    s_cbranch_scc1 L_pa_spin
L_pa_ok:
    v_lshrrev_b32 v14, 5, v1
    v_lshlrev_b32 v14, 9, v14
    v_and_b32 v15, 1, v1
    v_lshl_add_u32 v14, v15, 8, v14
    v_bfe_u32 v15, v1, 1, 4
    v_lshl_add_u32 v22, v15, 4, v14
    buffer_load_dwordx4 v[168:171], v22, s[16:19], s72 offen offset:0 sc1
    v_exp_f32 v34, v34
    v_exp_f32 v35, v35
    v_cvt_pk_bf16_f32 v120, v32, v33
    v_cvt_pk_bf16_f32 v121, v34, v35
    v_mfma_f32_32x32x16_bf16 v[64:79], v[116:119], v[124:127], v[64:79]
    v_exp_f32 v36, v36
    v_exp_f32 v37, v37
    v_exp_f32 v38, v38
    v_exp_f32 v39, v39
    v_cvt_pk_bf16_f32 v122, v36, v37
    v_cvt_pk_bf16_f32 v123, v38, v39
    v_mfma_f32_32x32x16_bf16 v[48:63], v[108:111], v[100:103], v[48:63]
    ds_read_b128 v[104:107], v3 offset:24576
    ds_read_b128 v[108:111], v3 offset:25600
    ds_read_b128 v[116:119], v20 offset:3072
    v_exp_f32 v40, v40
    v_exp_f32 v41, v41
    v_exp_f32 v42, v42
    v_exp_f32 v43, v43
    s_waitcnt lgkmcnt(3)
    v_mfma_f32_32x32x16_bf16 v[64:79], v[112:115], v[120:123], v[64:79]
    buffer_load_dwordx4 v[172:175], v22, s[16:19], s72 offen offset:1024 sc1
    v_exp_f32 v44, v44
    v_exp_f32 v45, v45
    v_smfmac_f32_16x16x64_bf16 v[4:7], v[8:11], v[120:127], v23
    ds_read_b128 v[112:115], v20 offset:14336
    v_exp_f32 v46, v46
    v_exp_f32 v47, v47
    v_cvt_pk_bf16_f32 v124, v40, v41
    v_cvt_pk_bf16_f32 v125, v42, v43
    v_cvt_pk_bf16_f32 v126, v44, v45
    v_cvt_pk_bf16_f32 v127, v46, v47
    s_waitcnt lgkmcnt(1)
    v_mfma_f32_32x32x16_bf16 v[32:47], v[104:107], v[96:99], v[80:95]
    v_exp_f32 v48, v48
    v_exp_f32 v49, v49
    buffer_load_dwordx4 v[176:179], v22, s[16:19], s72 offen offset:2048 sc1
    v_exp_f32 v50, v50
    v_exp_f32 v51, v51
    v_cvt_pk_bf16_f32 v120, v48, v49
    v_cvt_pk_bf16_f32 v121, v50, v51
    v_mfma_f32_32x32x16_bf16 v[64:79], v[116:119], v[124:127], v[64:79]
    v_exp_f32 v52, v52
    v_exp_f32 v53, v53
    v_exp_f32 v54, v54
    v_exp_f32 v55, v55
    v_cvt_pk_bf16_f32 v122, v52, v53
    v_cvt_pk_bf16_f32 v123, v54, v55
    v_mfma_f32_32x32x16_bf16 v[32:47], v[108:111], v[100:103], v[32:47]
    ds_read_b128 v[104:107], v3 offset:36864
    ds_read_b128 v[108:111], v3 offset:37888
    ds_read_b128 v[116:119], v20 offset:15360
    v_exp_f32 v56, v56
    v_exp_f32 v57, v57
    v_exp_f32 v58, v58
    v_exp_f32 v59, v59
    s_waitcnt lgkmcnt(3)
    v_mfma_f32_32x32x16_bf16 v[64:79], v[112:115], v[120:123], v[64:79]
    buffer_load_dwordx4 v[180:183], v22, s[16:19], s72 offen offset:3072 sc1
    v_exp_f32 v60, v60
    v_exp_f32 v61, v61
    v_smfmac_f32_16x16x64_bf16 v[4:7], v[8:11], v[120:127], v23
    ds_read_b128 v[112:115], v20 offset:26624
    v_exp_f32 v62, v62
    v_exp_f32 v63, v63
    v_cvt_pk_bf16_f32 v124, v56, v57
    v_cvt_pk_bf16_f32 v125, v58, v59
    v_cvt_pk_bf16_f32 v126, v60, v61
    v_cvt_pk_bf16_f32 v127, v62, v63
    s_waitcnt lgkmcnt(1)
    v_mfma_f32_32x32x16_bf16 v[48:63], v[104:107], v[96:99], v[80:95]
    v_exp_f32 v32, v32
    v_exp_f32 v33, v33
    buffer_load_dwordx4 v[184:187], v22, s[16:19], s73 offen offset:0 sc1
    v_exp_f32 v34, v34
    v_exp_f32 v35, v35
    v_cvt_pk_bf16_f32 v120, v32, v33
    v_cvt_pk_bf16_f32 v121, v34, v35
    v_mfma_f32_32x32x16_bf16 v[64:79], v[116:119], v[124:127], v[64:79]
    v_exp_f32 v36, v36
    v_exp_f32 v37, v37
    v_exp_f32 v38, v38
    v_exp_f32 v39, v39
    v_cvt_pk_bf16_f32 v122, v36, v37
    v_cvt_pk_bf16_f32 v123, v38, v39
    v_mfma_f32_32x32x16_bf16 v[48:63], v[108:111], v[100:103], v[48:63]
    v_add_u32 v3, 49152, v3
    ds_read_b128 v[104:107], v3 offset:0
    ds_read_b128 v[108:111], v3 offset:1024
    ds_read_b128 v[116:119], v20 offset:27648
    v_exp_f32 v40, v40
    v_exp_f32 v41, v41
    v_exp_f32 v42, v42
    v_exp_f32 v43, v43
    s_waitcnt lgkmcnt(3)
    v_mfma_f32_32x32x16_bf16 v[64:79], v[112:115], v[120:123], v[64:79]
    buffer_load_dwordx4 v[188:191], v22, s[16:19], s73 offen offset:1024 sc1
    v_exp_f32 v44, v44
    v_exp_f32 v45, v45
    v_smfmac_f32_16x16x64_bf16 v[4:7], v[8:11], v[120:127], v23
    ds_read_b128 v[112:115], v20 offset:38912
    v_exp_f32 v46, v46
    v_exp_f32 v47, v47
    v_cvt_pk_bf16_f32 v124, v40, v41
    v_cvt_pk_bf16_f32 v125, v42, v43
    v_cvt_pk_bf16_f32 v126, v44, v45
    v_cvt_pk_bf16_f32 v127, v46, v47
    s_waitcnt lgkmcnt(1)
    v_mfma_f32_32x32x16_bf16 v[32:47], v[104:107], v[96:99], v[80:95]
    v_exp_f32 v48, v48
    v_exp_f32 v49, v49
    buffer_load_dwordx4 v[192:195], v22, s[16:19], s73 offen offset:2048 sc1
    v_exp_f32 v50, v50
    v_exp_f32 v51, v51
    v_cvt_pk_bf16_f32 v120, v48, v49
    v_cvt_pk_bf16_f32 v121, v50, v51
    v_mfma_f32_32x32x16_bf16 v[64:79], v[116:119], v[124:127], v[64:79]
    v_exp_f32 v52, v52
    v_exp_f32 v53, v53
    v_exp_f32 v54, v54
    v_exp_f32 v55, v55
    v_cvt_pk_bf16_f32 v122, v52, v53
    v_cvt_pk_bf16_f32 v123, v54, v55
    v_mfma_f32_32x32x16_bf16 v[32:47], v[108:111], v[100:103], v[32:47]
    ds_read_b128 v[104:107], v3 offset:12288
    ds_read_b128 v[108:111], v3 offset:13312
    ds_read_b128 v[116:119], v20 offset:39936
    v_exp_f32 v56, v56
    v_exp_f32 v57, v57
    v_exp_f32 v58, v58
    v_exp_f32 v59, v59
    s_waitcnt lgkmcnt(3)
    v_mfma_f32_32x32x16_bf16 v[64:79], v[112:115], v[120:123], v[64:79]
    buffer_load_dwordx4 v[196:199], v22, s[16:19], s73 offen offset:3072 sc1
    v_exp_f32 v60, v60
    v_exp_f32 v61, v61
    v_smfmac_f32_16x16x64_bf16 v[4:7], v[8:11], v[120:127], v23
    v_mov_b32 v20, v3
    ds_read_b128 v[112:115], v20 offset:2048
    v_exp_f32 v62, v62
    v_exp_f32 v63, v63
    v_cvt_pk_bf16_f32 v124, v56, v57
    v_cvt_pk_bf16_f32 v125, v58, v59
    v_cvt_pk_bf16_f32 v126, v60, v61
    v_cvt_pk_bf16_f32 v127, v62, v63
    s_waitcnt lgkmcnt(1)
    v_mfma_f32_32x32x16_bf16 v[48:63], v[104:107], v[96:99], v[80:95]
    v_exp_f32 v32, v32
    v_exp_f32 v33, v33
    s_add_u32 s74, s76, 28672
    buffer_load_dwordx4 v[248:251], v2, s[16:19], s74 offen offset:0 sc1
    s_or_b32 s26, s75, s67
    s_cbranch_scc1 L_j5e
    s_add_u32 s24, s72, 524288
    s_add_u32 s25, s73, 524288
    buffer_load_dwordx4 v[216:219], v22, s[16:19], s24 offen offset:0 sc1
    buffer_load_dwordx4 v[220:223], v22, s[16:19], s24 offen offset:1024 sc1
    buffer_load_dwordx4 v[224:227], v22, s[16:19], s24 offen offset:2048 sc1
    buffer_load_dwordx4 v[228:231], v22, s[16:19], s24 offen offset:3072 sc1
    buffer_load_dwordx4 v[232:235], v22, s[16:19], s25 offen offset:0 sc1
    buffer_load_dwordx4 v[236:239], v22, s[16:19], s25 offen offset:1024 sc1
    buffer_load_dwordx4 v[240:243], v22, s[16:19], s25 offen offset:2048 sc1
    buffer_load_dwordx4 v[244:247], v22, s[16:19], s25 offen offset:3072 sc1
L_j5e:
    v_exp_f32 v34, v34
    v_exp_f32 v35, v35
    v_cvt_pk_bf16_f32 v120, v32, v33
    v_cvt_pk_bf16_f32 v121, v34, v35
    v_mfma_f32_32x32x16_bf16 v[64:79], v[116:119], v[124:127], v[64:79]
    v_exp_f32 v36, v36
    v_exp_f32 v37, v37
    v_exp_f32 v38, v38
    v_exp_f32 v39, v39
    v_cvt_pk_bf16_f32 v122, v36, v37
    v_cvt_pk_bf16_f32 v123, v38, v39
    v_mfma_f32_32x32x16_bf16 v[48:63], v[108:111], v[100:103], v[48:63]
    ds_read_b128 v[104:107], v3 offset:24576
    ds_read_b128 v[108:111], v3 offset:25600
    ds_read_b128 v[116:119], v20 offset:3072
    v_exp_f32 v40, v40
    v_exp_f32 v41, v41
    v_exp_f32 v42, v42
    v_exp_f32 v43, v43
    s_waitcnt lgkmcnt(3)
    v_mfma_f32_32x32x16_bf16 v[64:79], v[112:115], v[120:123], v[64:79]
    buffer_load_dwordx4 v[252:255], v2, s[16:19], s74 offen offset:1024 sc1
    v_exp_f32 v44, v44
    v_exp_f32 v45, v45
    v_smfmac_f32_16x16x64_bf16 v[4:7], v[8:11], v[120:127], v23
    ds_read_b128 v[112:115], v20 offset:14336
    v_exp_f32 v46, v46
    v_exp_f32 v47, v47
    v_cvt_pk_bf16_f32 v124, v40, v41
    v_cvt_pk_bf16_f32 v125, v42, v43
    v_cvt_pk_bf16_f32 v126, v44, v45
    v_cvt_pk_bf16_f32 v127, v46, v47
    s_waitcnt lgkmcnt(1)
    v_mfma_f32_32x32x16_bf16 v[32:47], v[104:107], v[96:99], v[80:95]
    v_exp_f32 v48, v48
    v_exp_f32 v49, v49
    buffer_load_dwordx4 v[24:27], v2, s[16:19], s74 offen offset:2048 sc1
    v_exp_f32 v50, v50
    v_exp_f32 v51, v51
    v_cvt_pk_bf16_f32 v120, v48, v49
    v_cvt_pk_bf16_f32 v121, v50, v51
    v_mfma_f32_32x32x16_bf16 v[64:79], v[116:119], v[124:127], v[64:79]
    v_exp_f32 v52, v52
    v_exp_f32 v53, v53
    v_exp_f32 v54, v54
    v_exp_f32 v55, v55
    v_cvt_pk_bf16_f32 v122, v52, v53
    v_cvt_pk_bf16_f32 v123, v54, v55
    v_mfma_f32_32x32x16_bf16 v[32:47], v[108:111], v[100:103], v[32:47]
    ds_read_b128 v[104:107], v3 offset:36864
    ds_read_b128 v[108:111], v3 offset:37888
    ds_read_b128 v[116:119], v20 offset:15360
    v_exp_f32 v56, v56
    v_exp_f32 v57, v57
    v_exp_f32 v58, v58
    v_exp_f32 v59, v59
    s_waitcnt lgkmcnt(3)
    v_mfma_f32_32x32x16_bf16 v[64:79], v[112:115], v[120:123], v[64:79]
    buffer_load_dwordx4 v[28:31], v2, s[16:19], s74 offen offset:3072 sc1
    v_exp_f32 v60, v60
    v_exp_f32 v61, v61
    v_smfmac_f32_16x16x64_bf16 v[4:7], v[8:11], v[120:127], v23
    ds_read_b128 v[112:115], v20 offset:26624
    v_exp_f32 v62, v62
    v_exp_f32 v63, v63
    v_cvt_pk_bf16_f32 v124, v56, v57
    v_cvt_pk_bf16_f32 v125, v58, v59
    v_cvt_pk_bf16_f32 v126, v60, v61
    v_cvt_pk_bf16_f32 v127, v62, v63
    s_waitcnt lgkmcnt(1)
    v_mfma_f32_32x32x16_bf16 v[48:63], v[104:107], v[96:99], v[80:95]
    v_exp_f32 v32, v32
    v_exp_f32 v33, v33
    v_exp_f32 v34, v34
    v_exp_f32 v35, v35
    v_cvt_pk_bf16_f32 v120, v32, v33
    v_cvt_pk_bf16_f32 v121, v34, v35
    v_mfma_f32_32x32x16_bf16 v[64:79], v[116:119], v[124:127], v[64:79]
    v_exp_f32 v36, v36
    v_exp_f32 v37, v37
    v_exp_f32 v38, v38
    v_exp_f32 v39, v39
    v_cvt_pk_bf16_f32 v122, v36, v37
    v_cvt_pk_bf16_f32 v123, v38, v39
    v_mfma_f32_32x32x16_bf16 v[48:63], v[108:111], v[100:103], v[48:63]
    s_waitcnt vmcnt(12)
    s_barrier
    s_add_u32 s37, s37, 4096
    s_cmp_eq_u32 s37, 77824
    s_cselect_b32 s37, 65536, s37
    v_add_u32 v3, s37, v2
    ds_read_b128 v[104:107], v3 offset:0
    ds_read_b128 v[108:111], v3 offset:1024
    ds_read_b128 v[116:119], v20 offset:27648
    v_exp_f32 v40, v40
    v_exp_f32 v41, v41
    v_exp_f32 v42, v42
    v_exp_f32 v43, v43
    s_waitcnt lgkmcnt(3)
    v_mfma_f32_32x32x16_bf16 v[64:79], v[112:115], v[120:123], v[64:79]
    s_add_u32 s24, s40, 32768
    s_and_b32 s24, s24, 0x3ffff
    s_andn2_b32 s40, s40, 0x3ffff
    s_or_b32 s40, s40, s24
    s_add_u32 s41, s41, 4096
    s_cmp_eq_u32 s41, 12288
    s_cselect_b32 s41, 0, s41
    s_add_u32 m0, s32, s41
    s_nop 0
    buffer_load_dwordx4 v2, s[16:19], s40 offen offset:0 sc1 lds
    v_exp_f32 v44, v44
    v_exp_f32 v45, v45
    v_smfmac_f32_16x16x64_bf16 v[4:7], v[8:11], v[120:127], v23
    ds_read_b128 v[112:115], v20 offset:38912
    buffer_load_dwordx4 v2, s[16:19], s40 offen offset:1024 sc1 lds
    v_exp_f32 v46, v46
    v_exp_f32 v47, v47
    v_cvt_pk_bf16_f32 v124, v40, v41
    v_cvt_pk_bf16_f32 v125, v42, v43
    v_cvt_pk_bf16_f32 v126, v44, v45
    v_cvt_pk_bf16_f32 v127, v46, v47
    s_waitcnt lgkmcnt(1)
    v_mfma_f32_32x32x16_bf16 v[32:47], v[104:107], v[96:99], v[80:95]
    v_exp_f32 v48, v48
    v_exp_f32 v49, v49
    buffer_load_dwordx4 v2, s[16:19], s40 offen offset:2048 sc1 lds
    v_exp_f32 v50, v50
    v_exp_f32 v51, v51
    v_cvt_pk_bf16_f32 v120, v48, v49
    v_cvt_pk_bf16_f32 v121, v50, v51
    v_mfma_f32_32x32x16_bf16 v[64:79], v[116:119], v[124:127], v[64:79]
    v_exp_f32 v52, v52
    v_exp_f32 v53, v53
    v_exp_f32 v54, v54
    v_exp_f32 v55, v55
    v_cvt_pk_bf16_f32 v122, v52, v53
    v_cvt_pk_bf16_f32 v123, v54, v55
    v_mfma_f32_32x32x16_bf16 v[32:47], v[108:111], v[100:103], v[32:47]
    ds_read_b128 v[104:107], v3 offset:12288
    ds_read_b128 v[108:111], v3 offset:13312
    ds_read_b128 v[116:119], v20 offset:39936
    v_exp_f32 v56, v56
    v_exp_f32 v57, v57
    v_exp_f32 v58, v58
    v_exp_f32 v59, v59
    s_waitcnt lgkmcnt(3)
    v_mfma_f32_32x32x16_bf16 v[64:79], v[112:115], v[120:123], v[64:79]
    buffer_load_dwordx4 v2, s[16:19], s40 offen offset:3072 sc1 lds
    v_exp_f32 v60, v60
    v_exp_f32 v61, v61
    v_smfmac_f32_16x16x64_bf16 v[4:7], v[8:11], v[120:127], v23
    v_mov_b32 v20, v3
    ds_read_b128 v[112:115], v20 offset:2048
    v_exp_f32 v62, v62
    v_exp_f32 v63, v63
    v_cvt_pk_bf16_f32 v124, v56, v57
    v_cvt_pk_bf16_f32 v125, v58, v59
    v_cvt_pk_bf16_f32 v126, v60, v61
    v_cvt_pk_bf16_f32 v127, v62, v63
    s_waitcnt lgkmcnt(1)
    v_mfma_f32_32x32x16_bf16 v[48:63], v[104:107], v[96:99], v[80:95]
    v_exp_f32 v32, v32
    v_exp_f32 v33, v33
    s_waitcnt vmcnt(15)
    v_mfma_f32_32x32x16_bf16 v[200:215], v[136:139], v[168:171], 0
    v_exp_f32 v34, v34
    v_exp_f32 v35, v35
    v_cvt_pk_bf16_f32 v120, v32, v33
    v_cvt_pk_bf16_f32 v121, v34, v35
    v_mfma_f32_32x32x16_bf16 v[64:79], v[116:119], v[124:127], v[64:79]
    v_exp_f32 v36, v36
    v_exp_f32 v37, v37
    v_exp_f32 v38, v38
    v_exp_f32 v39, v39
    v_cvt_pk_bf16_f32 v122, v36, v37
    v_cvt_pk_bf16_f32 v123, v38, v39
    v_mfma_f32_32x32x16_bf16 v[48:63], v[108:111], v[100:103], v[48:63]
    ds_read_b128 v[104:107], v3 offset:24576
    ds_read_b128 v[108:111], v3 offset:25600
    ds_read_b128 v[116:119], v20 offset:3072
    v_exp_f32 v40, v40
    v_exp_f32 v41, v41
    v_exp_f32 v42, v42
    v_exp_f32 v43, v43
    s_waitcnt lgkmcnt(3)
    v_mfma_f32_32x32x16_bf16 v[64:79], v[112:115], v[120:123], v[64:79]
    s_waitcnt vmcnt(14)
    v_mfma_f32_32x32x16_bf16 v[200:215], v[140:143], v[172:175], v[200:215]
    v_exp_f32 v44, v44
    v_exp_f32 v45, v45
    v_smfmac_f32_16x16x64_bf16 v[4:7], v[8:11], v[120:127], v23
    ds_read_b128 v[112:115], v20 offset:14336
    v_exp_f32 v46, v46
    v_exp_f32 v47, v47
    v_cvt_pk_bf16_f32 v124, v40, v41
    v_cvt_pk_bf16_f32 v125, v42, v43
    v_cvt_pk_bf16_f32 v126, v44, v45
    v_cvt_pk_bf16_f32 v127, v46, v47
    s_waitcnt lgkmcnt(1)
    v_mfma_f32_32x32x16_bf16 v[32:47], v[104:107], v[96:99], v[80:95]
    v_exp_f32 v48, v48
    v_exp_f32 v49, v49
    s_waitcnt vmcnt(13)
    v_mfma_f32_32x32x16_bf16 v[200:215], v[144:147], v[176:179], v[200:215]
    v_exp_f32 v50, v50
    v_exp_f32 v51, v51
    v_cvt_pk_bf16_f32 v120, v48, v49
    v_cvt_pk_bf16_f32 v121, v50, v51
    v_mfma_f32_32x32x16_bf16 v[64:79], v[116:119], v[124:127], v[64:79]
    v_exp_f32 v52, v52
    v_exp_f32 v53, v53
    v_exp_f32 v54, v54
    v_exp_f32 v55, v55
    v_cvt_pk_bf16_f32 v122, v52, v53
    v_cvt_pk_bf16_f32 v123, v54, v55
    v_mfma_f32_32x32x16_bf16 v[32:47], v[108:111], v[100:103], v[32:47]
    ds_read_b128 v[104:107], v3 offset:36864
    ds_read_b128 v[108:111], v3 offset:37888
    ds_read_b128 v[116:119], v20 offset:15360
    v_exp_f32 v56, v56
    v_exp_f32 v57, v57
    v_exp_f32 v58, v58
    v_exp_f32 v59, v59
    s_waitcnt lgkmcnt(3)
    v_mfma_f32_32x32x16_bf16 v[64:79], v[112:115], v[120:123], v[64:79]
    s_waitcnt vmcnt(12)
    v_mfma_f32_32x32x16_bf16 v[200:215], v[148:151], v[180:183], v[200:215]
    v_exp_f32 v60, v60
    v_exp_f32 v61, v61
    v_smfmac_f32_16x16x64_bf16 v[4:7], v[8:11], v[120:127], v23
    ds_read_b128 v[112:115], v20 offset:26624
    v_exp_f32 v62, v62
    v_exp_f32 v63, v63
    v_cvt_pk_bf16_f32 v124, v56, v57
    v_cvt_pk_bf16_f32 v125, v58, v59
    v_cvt_pk_bf16_f32 v126, v60, v61
    v_cvt_pk_bf16_f32 v127, v62, v63
    s_waitcnt lgkmcnt(1)
    v_mfma_f32_32x32x16_bf16 v[48:63], v[104:107], v[96:99], v[80:95]
    v_exp_f32 v32, v32
    v_exp_f32 v33, v33
    s_waitcnt vmcnt(11)
    v_mfma_f32_32x32x16_bf16 v[200:215], v[152:155], v[184:187], v[200:215]
    v_exp_f32 v34, v34
    v_exp_f32 v35, v35
    v_cvt_pk_bf16_f32 v120, v32, v33
    v_cvt_pk_bf16_f32 v121, v34, v35
    v_mfma_f32_32x32x16_bf16 v[64:79], v[116:119], v[124:127], v[64:79]
    v_exp_f32 v36, v36
    v_exp_f32 v37, v37
    v_exp_f32 v38, v38
    v_exp_f32 v39, v39
    v_cvt_pk_bf16_f32 v122, v36, v37
    v_cvt_pk_bf16_f32 v123, v38, v39
    v_mfma_f32_32x32x16_bf16 v[48:63], v[108:111], v[100:103], v[48:63]
    v_add_u32 v3, 49152, v3
    ds_read_b128 v[104:107], v3 offset:0
    ds_read_b128 v[108:111], v3 offset:1024
    ds_read_b128 v[116:119], v20 offset:27648
    v_exp_f32 v40, v40
    v_exp_f32 v41, v41
    v_exp_f32 v42, v42
    v_exp_f32 v43, v43
    s_waitcnt lgkmcnt(3)
    v_mfma_f32_32x32x16_bf16 v[64:79], v[112:115], v[120:123], v[64:79]
    s_waitcnt vmcnt(10)
    v_mfma_f32_32x32x16_bf16 v[200:215], v[156:159], v[188:191], v[200:215]
    v_exp_f32 v44, v44
    v_exp_f32 v45, v45
    v_smfmac_f32_16x16x64_bf16 v[4:7], v[8:11], v[120:127], v23
    ds_read_b128 v[112:115], v20 offset:38912
    v_exp_f32 v46, v46
    v_exp_f32 v47, v47
    v_cvt_pk_bf16_f32 v124, v40, v41
    v_cvt_pk_bf16_f32 v125, v42, v43
    v_cvt_pk_bf16_f32 v126, v44, v45
    v_cvt_pk_bf16_f32 v127, v46, v47
    s_waitcnt lgkmcnt(1)
    v_mfma_f32_32x32x16_bf16 v[32:47], v[104:107], v[96:99], v[80:95]
    v_exp_f32 v48, v48
    v_exp_f32 v49, v49
    s_waitcnt vmcnt(9)
    v_mfma_f32_32x32x16_bf16 v[200:215], v[160:163], v[192:195], v[200:215]
    v_exp_f32 v50, v50
    v_exp_f32 v51, v51
    v_cvt_pk_bf16_f32 v120, v48, v49
    v_cvt_pk_bf16_f32 v121, v50, v51
    v_mfma_f32_32x32x16_bf16 v[64:79], v[116:119], v[124:127], v[64:79]
    v_exp_f32 v52, v52
    v_exp_f32 v53, v53
    v_exp_f32 v54, v54
    v_exp_f32 v55, v55
    v_cvt_pk_bf16_f32 v122, v52, v53
    v_cvt_pk_bf16_f32 v123, v54, v55
    v_mfma_f32_32x32x16_bf16 v[32:47], v[108:111], v[100:103], v[32:47]
    ds_read_b128 v[104:107], v3 offset:12288
    ds_read_b128 v[108:111], v3 offset:13312
    ds_read_b128 v[116:119], v20 offset:39936
    v_exp_f32 v56, v56
    v_exp_f32 v57, v57
    v_exp_f32 v58, v58
    v_exp_f32 v59, v59
    s_waitcnt lgkmcnt(3)
    v_mfma_f32_32x32x16_bf16 v[64:79], v[112:115], v[120:123], v[64:79]
    s_waitcnt vmcnt(8)
    v_mfma_f32_32x32x16_bf16 v[200:215], v[164:167], v[196:199], v[200:215]
    v_exp_f32 v60, v60
    v_exp_f32 v61, v61
    v_smfmac_f32_16x16x64_bf16 v[4:7], v[8:11], v[120:127], v23
    v_mov_b32 v20, v3
    ds_read_b128 v[112:115], v20 offset:2048
    v_exp_f32 v62, v62
    v_exp_f32 v63, v63
    v_cvt_pk_bf16_f32 v124, v56, v57
    v_cvt_pk_bf16_f32 v125, v58, v59
    v_cvt_pk_bf16_f32 v126, v60, v61
    v_cvt_pk_bf16_f32 v127, v62, v63
    s_waitcnt lgkmcnt(1)
    v_mfma_f32_32x32x16_bf16 v[48:63], v[104:107], v[96:99], v[80:95]
    v_exp_f32 v32, v32
    v_exp_f32 v33, v33
    v_lshrrev_b32 v15, 5, v1
    v_lshl_add_u32 v22, v15, 5, v2
    s_mul_i32 s24, s3, 4352
    v_add_u32 v22, s24, v22
    s_or_b32 s26, s75, s67
    s_cbranch_scc1 L_j6b
    s_waitcnt vmcnt(0)
    v_mfma_f32_32x32x16_bf16 v[168:183], v[136:139], v[216:219], 0
    v_mfma_f32_32x32x16_bf16 v[168:183], v[140:143], v[220:223], v[168:183]
    v_mfma_f32_32x32x16_bf16 v[168:183], v[144:147], v[224:227], v[168:183]
    v_mfma_f32_32x32x16_bf16 v[168:183], v[148:151], v[228:231], v[168:183]
    v_mfma_f32_32x32x16_bf16 v[168:183], v[152:155], v[232:235], v[168:183]
    v_mfma_f32_32x32x16_bf16 v[168:183], v[156:159], v[236:239], v[168:183]
    v_mfma_f32_32x32x16_bf16 v[168:183], v[160:163], v[240:243], v[168:183]
    v_mfma_f32_32x32x16_bf16 v[168:183], v[164:167], v[244:247], v[168:183]
    s_nop 11
    ds_write_b128 v22, v[168:171] offset:34816
    ds_write_b128 v22, v[172:175] offset:35904
    ds_write_b128 v22, v[176:179] offset:36992
    ds_write_b128 v22, v[180:183] offset:38080
    s_waitcnt lgkmcnt(0)
L_j6b:
    s_add_u32 s74, s76, 0
    buffer_load_dwordx4 v[136:139], v2, s[16:19], s74 offen offset:0 sc1
    v_exp_f32 v34, v34
    v_exp_f32 v35, v35
    v_cvt_pk_bf16_f32 v120, v32, v33
    v_cvt_pk_bf16_f32 v121, v34, v35
    v_mfma_f32_32x32x16_bf16 v[64:79], v[116:119], v[124:127], v[64:79]
    v_exp_f32 v36, v36
    v_exp_f32 v37, v37
    v_exp_f32 v38, v38
    v_exp_f32 v39, v39
    v_cvt_pk_bf16_f32 v122, v36, v37
    v_cvt_pk_bf16_f32 v123, v38, v39
    v_mfma_f32_32x32x16_bf16 v[48:63], v[108:111], v[100:103], v[48:63]
    ds_read_b128 v[104:107], v3 offset:24576
    ds_read_b128 v[108:111], v3 offset:25600
    ds_read_b128 v[116:119], v20 offset:3072
    v_exp_f32 v40, v40
    v_exp_f32 v41, v41
    v_exp_f32 v42, v42
    v_exp_f32 v43, v43
    s_waitcnt lgkmcnt(3)
    v_mfma_f32_32x32x16_bf16 v[64:79], v[112:115], v[120:123], v[64:79]
    buffer_load_dwordx4 v[140:143], v2, s[16:19], s74 offen offset:1024 sc1
    v_exp_f32 v44, v44
    v_exp_f32 v45, v45
    v_smfmac_f32_16x16x64_bf16 v[4:7], v[8:11], v[120:127], v23
    ds_read_b128 v[112:115], v20 offset:14336
    v_exp_f32 v46, v46
    v_exp_f32 v47, v47
    v_cvt_pk_bf16_f32 v124, v40, v41
    v_cvt_pk_bf16_f32 v125, v42, v43
    v_cvt_pk_bf16_f32 v126, v44, v45
    v_cvt_pk_bf16_f32 v127, v46, v47
    s_waitcnt lgkmcnt(1)
    v_mfma_f32_32x32x16_bf16 v[32:47], v[104:107], v[96:99], v[80:95]
    v_exp_f32 v48, v48
    v_exp_f32 v49, v49
    ds_write_b128 v22, v[200:203] offset:0
    ds_write_b128 v22, v[204:207] offset:1088
    ds_write_b128 v22, v[208:211] offset:2176
    ds_write_b128 v22, v[212:215] offset:3264
    buffer_load_dwordx4 v[144:147], v2, s[16:19], s74 offen offset:2048 sc1
    v_exp_f32 v50, v50
    v_exp_f32 v51, v51
    v_cvt_pk_bf16_f32 v120, v48, v49
    v_cvt_pk_bf16_f32 v121, v50, v51
    v_mfma_f32_32x32x16_bf16 v[64:79], v[116:119], v[124:127], v[64:79]
    v_exp_f32 v52, v52
    v_exp_f32 v53, v53
    v_exp_f32 v54, v54
    v_exp_f32 v55, v55
    v_cvt_pk_bf16_f32 v122, v52, v53
    v_cvt_pk_bf16_f32 v123, v54, v55
    v_mfma_f32_32x32x16_bf16 v[32:47], v[108:111], v[100:103], v[32:47]
    ds_read_b128 v[104:107], v3 offset:36864
    ds_read_b128 v[108:111], v3 offset:37888
    ds_read_b128 v[116:119], v20 offset:15360
    v_exp_f32 v56, v56
    v_exp_f32 v57, v57
    v_exp_f32 v58, v58
    v_exp_f32 v59, v59
    s_waitcnt lgkmcnt(7)
    v_mfma_f32_32x32x16_bf16 v[64:79], v[112:115], v[120:123], v[64:79]
    buffer_load_dwordx4 v[148:151], v2, s[16:19], s74 offen offset:3072 sc1
    v_exp_f32 v60, v60
    v_exp_f32 v61, v61
    v_smfmac_f32_16x16x64_bf16 v[4:7], v[8:11], v[120:127], v23
    ds_read_b128 v[112:115], v20 offset:26624
    v_exp_f32 v62, v62
    v_exp_f32 v63, v63
    v_cvt_pk_bf16_f32 v124, v56, v57
    v_cvt_pk_bf16_f32 v125, v58, v59
    v_cvt_pk_bf16_f32 v126, v60, v61
    v_cvt_pk_bf16_f32 v127, v62, v63
    s_waitcnt lgkmcnt(1)
    v_mfma_f32_32x32x16_bf16 v[48:63], v[104:107], v[96:99], v[80:95]
    v_exp_f32 v32, v32
    v_exp_f32 v33, v33
    v_exp_f32 v34, v34
    v_exp_f32 v35, v35
    v_cvt_pk_bf16_f32 v120, v32, v33
    v_cvt_pk_bf16_f32 v121, v34, v35
    v_mfma_f32_32x32x16_bf16 v[64:79], v[116:119], v[124:127], v[64:79]
    v_exp_f32 v36, v36
    v_exp_f32 v37, v37
    v_exp_f32 v38, v38
    v_exp_f32 v39, v39
    v_cvt_pk_bf16_f32 v122, v36, v37
    v_cvt_pk_bf16_f32 v123, v38, v39
    v_mfma_f32_32x32x16_bf16 v[48:63], v[108:111], v[100:103], v[48:63]
    s_waitcnt vmcnt(4)
    s_barrier
    s_add_u32 s37, s37, 4096
    s_cmp_eq_u32 s37, 77824
    s_cselect_b32 s37, 65536, s37
    v_add_u32 v3, s37, v2
    ds_read_b128 v[104:107], v3 offset:0
    ds_read_b128 v[108:111], v3 offset:1024
    ds_read_b128 v[116:119], v20 offset:27648
    v_exp_f32 v40, v40
    v_exp_f32 v41, v41
    v_exp_f32 v42, v42
    v_exp_f32 v43, v43
    s_waitcnt lgkmcnt(3)
    v_mfma_f32_32x32x16_bf16 v[64:79], v[112:115], v[120:123], v[64:79]
    s_add_u32 s24, s40, 32768
    s_and_b32 s24, s24, 0x3ffff
    s_andn2_b32 s40, s40, 0x3ffff
    s_or_b32 s40, s40, s24
    s_add_u32 s41, s41, 4096
    s_cmp_eq_u32 s41, 12288
    s_cselect_b32 s41, 0, s41
    s_add_u32 m0, s32, s41
    s_nop 0
    buffer_load_dwordx4 v2, s[16:19], s40 offen offset:0 sc1 lds
    v_exp_f32 v44, v44
    v_exp_f32 v45, v45
    v_smfmac_f32_16x16x64_bf16 v[4:7], v[8:11], v[120:127], v23
    ds_read_b128 v[112:115], v20 offset:38912
    buffer_load_dwordx4 v2, s[16:19], s40 offen offset:1024 sc1 lds
    v_exp_f32 v46, v46
    v_exp_f32 v47, v47
    v_cvt_pk_bf16_f32 v124, v40, v41
    v_cvt_pk_bf16_f32 v125, v42, v43
    v_cvt_pk_bf16_f32 v126, v44, v45
    v_cvt_pk_bf16_f32 v127, v46, v47
    s_waitcnt lgkmcnt(1)
    v_mfma_f32_32x32x16_bf16 v[32:47], v[104:107], v[96:99], v[80:95]
    v_exp_f32 v48, v48
    v_exp_f32 v49, v49
    buffer_load_dwordx4 v2, s[16:19], s40 offen offset:2048 sc1 lds
    v_exp_f32 v50, v50
    v_exp_f32 v51, v51
    v_cvt_pk_bf16_f32 v120, v48, v49
    v_cvt_pk_bf16_f32 v121, v50, v51
    v_mfma_f32_32x32x16_bf16 v[64:79], v[116:119], v[124:127], v[64:79]
    v_exp_f32 v52, v52
    v_exp_f32 v53, v53
    v_exp_f32 v54, v54
    v_exp_f32 v55, v55
    v_cvt_pk_bf16_f32 v122, v52, v53
    v_cvt_pk_bf16_f32 v123, v54, v55
    v_mfma_f32_32x32x16_bf16 v[32:47], v[108:111], v[100:103], v[32:47]
    ds_read_b128 v[104:107], v3 offset:12288
    ds_read_b128 v[108:111], v3 offset:13312
    ds_read_b128 v[116:119], v20 offset:39936
    v_exp_f32 v56, v56
    v_exp_f32 v57, v57
    v_exp_f32 v58, v58
    v_exp_f32 v59, v59
    s_waitcnt lgkmcnt(3)
    v_mfma_f32_32x32x16_bf16 v[64:79], v[112:115], v[120:123], v[64:79]
    buffer_load_dwordx4 v2, s[16:19], s40 offen offset:3072 sc1 lds
    v_exp_f32 v60, v60
    v_exp_f32 v61, v61
    v_smfmac_f32_16x16x64_bf16 v[4:7], v[8:11], v[120:127], v23
    v_mov_b32 v20, v3
    ds_read_b128 v[112:115], v20 offset:2048
    v_exp_f32 v62, v62
    v_exp_f32 v63, v63
    v_cvt_pk_bf16_f32 v124, v56, v57
    v_cvt_pk_bf16_f32 v125, v58, v59
    v_cvt_pk_bf16_f32 v126, v60, v61
    v_cvt_pk_bf16_f32 v127, v62, v63
    s_waitcnt lgkmcnt(1)
    v_mfma_f32_32x32x16_bf16 v[48:63], v[104:107], v[96:99], v[80:95]
    v_exp_f32 v32, v32
    v_exp_f32 v33, v33
    s_add_u32 s74, s76, 4096
    buffer_load_dwordx4 v[152:155], v2, s[16:19], s74 offen offset:0 sc1
    v_exp_f32 v34, v34
    v_exp_f32 v35, v35
    v_cvt_pk_bf16_f32 v120, v32, v33
    v_cvt_pk_bf16_f32 v121, v34, v35
    v_mfma_f32_32x32x16_bf16 v[64:79], v[116:119], v[124:127], v[64:79]
    v_exp_f32 v36, v36
    v_exp_f32 v37, v37
    v_exp_f32 v38, v38
    v_exp_f32 v39, v39
    v_cvt_pk_bf16_f32 v122, v36, v37
    v_cvt_pk_bf16_f32 v123, v38, v39
    v_mfma_f32_32x32x16_bf16 v[48:63], v[108:111], v[100:103], v[48:63]
    ds_read_b128 v[104:107], v3 offset:24576
    ds_read_b128 v[108:111], v3 offset:25600
    ds_read_b128 v[116:119], v20 offset:3072
    v_exp_f32 v40, v40
    v_exp_f32 v41, v41
    v_exp_f32 v42, v42
    v_exp_f32 v43, v43
    s_waitcnt lgkmcnt(3)
    v_mfma_f32_32x32x16_bf16 v[64:79], v[112:115], v[120:123], v[64:79]
    buffer_load_dwordx4 v[156:159], v2, s[16:19], s74 offen offset:1024 sc1
    v_exp_f32 v44, v44
    v_exp_f32 v45, v45
    v_smfmac_f32_16x16x64_bf16 v[4:7], v[8:11], v[120:127], v23
    ds_read_b128 v[112:115], v20 offset:14336
    v_exp_f32 v46, v46
    v_exp_f32 v47, v47
    v_cvt_pk_bf16_f32 v124, v40, v41
    v_cvt_pk_bf16_f32 v125, v42, v43
    v_cvt_pk_bf16_f32 v126, v44, v45
    v_cvt_pk_bf16_f32 v127, v46, v47
    s_waitcnt lgkmcnt(1)
    v_mfma_f32_32x32x16_bf16 v[32:47], v[104:107], v[96:99], v[80:95]
    v_exp_f32 v48, v48
    v_exp_f32 v49, v49
    buffer_load_dwordx4 v[160:163], v2, s[16:19], s74 offen offset:2048 sc1
    v_exp_f32 v50, v50
    v_exp_f32 v51, v51
    v_cvt_pk_bf16_f32 v120, v48, v49
    v_cvt_pk_bf16_f32 v121, v50, v51
    v_mfma_f32_32x32x16_bf16 v[64:79], v[116:119], v[124:127], v[64:79]
    v_exp_f32 v52, v52
    v_exp_f32 v53, v53
    v_exp_f32 v54, v54
    v_exp_f32 v55, v55
    v_cvt_pk_bf16_f32 v122, v52, v53
    v_cvt_pk_bf16_f32 v123, v54, v55
    v_mfma_f32_32x32x16_bf16 v[32:47], v[108:111], v[100:103], v[32:47]
    ds_read_b128 v[104:107], v3 offset:36864
    ds_read_b128 v[108:111], v3 offset:37888
    ds_read_b128 v[116:119], v20 offset:15360
    v_exp_f32 v56, v56
    v_exp_f32 v57, v57
    v_exp_f32 v58, v58
    v_exp_f32 v59, v59
    s_waitcnt lgkmcnt(3)
    v_mfma_f32_32x32x16_bf16 v[64:79], v[112:115], v[120:123], v[64:79]
    buffer_load_dwordx4 v[164:167], v2, s[16:19], s74 offen offset:3072 sc1
    v_exp_f32 v60, v60
    v_exp_f32 v61, v61
    v_smfmac_f32_16x16x64_bf16 v[4:7], v[8:11], v[120:127], v23
    ds_read_b128 v[112:115], v20 offset:26624
    v_exp_f32 v62, v62
    v_exp_f32 v63, v63
    v_cvt_pk_bf16_f32 v124, v56, v57
    v_cvt_pk_bf16_f32 v125, v58, v59
    v_cvt_pk_bf16_f32 v126, v60, v61
    v_cvt_pk_bf16_f32 v127, v62, v63
    s_waitcnt lgkmcnt(1)
    v_mfma_f32_32x32x16_bf16 v[48:63], v[104:107], v[96:99], v[80:95]
    v_exp_f32 v32, v32
    v_exp_f32 v33, v33
    s_add_u32 s74, s76, 8192
    buffer_load_dwordx4 v[168:171], v2, s[16:19], s74 offen offset:0 sc1
    v_exp_f32 v34, v34
    v_exp_f32 v35, v35
    v_cvt_pk_bf16_f32 v120, v32, v33
    v_cvt_pk_bf16_f32 v121, v34, v35
    v_mfma_f32_32x32x16_bf16 v[64:79], v[116:119], v[124:127], v[64:79]
    v_exp_f32 v36, v36
    v_exp_f32 v37, v37
    v_exp_f32 v38, v38
    v_exp_f32 v39, v39
    v_cvt_pk_bf16_f32 v122, v36, v37
    v_cvt_pk_bf16_f32 v123, v38, v39
    v_mfma_f32_32x32x16_bf16 v[48:63], v[108:111], v[100:103], v[48:63]
    v_add_u32 v3, 49152, v3
    ds_read_b128 v[104:107], v3 offset:0
    ds_read_b128 v[108:111], v3 offset:1024
    ds_read_b128 v[116:119], v20 offset:27648
    v_exp_f32 v40, v40
    v_exp_f32 v41, v41
    v_exp_f32 v42, v42
    v_exp_f32 v43, v43
    s_waitcnt lgkmcnt(3)
    v_mfma_f32_32x32x16_bf16 v[64:79], v[112:115], v[120:123], v[64:79]
    buffer_load_dwordx4 v[172:175], v2, s[16:19], s74 offen offset:1024 sc1
    v_exp_f32 v44, v44
    v_exp_f32 v45, v45
    v_smfmac_f32_16x16x64_bf16 v[4:7], v[8:11], v[120:127], v23
    ds_read_b128 v[112:115], v20 offset:38912
    v_exp_f32 v46, v46
    v_exp_f32 v47, v47
    v_cvt_pk_bf16_f32 v124, v40, v41
    v_cvt_pk_bf16_f32 v125, v42, v43
    v_cvt_pk_bf16_f32 v126, v44, v45
    v_cvt_pk_bf16_f32 v127, v46, v47
    s_waitcnt lgkmcnt(1)
    v_mfma_f32_32x32x16_bf16 v[32:47], v[104:107], v[96:99], v[80:95]
    v_exp_f32 v48, v48
    v_exp_f32 v49, v49
    buffer_load_dwordx4 v[176:179], v2, s[16:19], s74 offen offset:2048 sc1
    v_exp_f32 v50, v50
    v_exp_f32 v51, v51
    v_cvt_pk_bf16_f32 v120, v48, v49
    v_cvt_pk_bf16_f32 v121, v50, v51
    v_mfma_f32_32x32x16_bf16 v[64:79], v[116:119], v[124:127], v[64:79]
    v_exp_f32 v52, v52
    v_exp_f32 v53, v53
    v_exp_f32 v54, v54
    v_exp_f32 v55, v55
    v_cvt_pk_bf16_f32 v122, v52, v53
    v_cvt_pk_bf16_f32 v123, v54, v55
    v_mfma_f32_32x32x16_bf16 v[32:47], v[108:111], v[100:103], v[32:47]
    ds_read_b128 v[104:107], v3 offset:12288
    ds_read_b128 v[108:111], v3 offset:13312
    ds_read_b128 v[116:119], v20 offset:39936
    v_exp_f32 v56, v56
    v_exp_f32 v57, v57
    v_exp_f32 v58, v58
    v_exp_f32 v59, v59
    s_waitcnt lgkmcnt(3)
    v_mfma_f32_32x32x16_bf16 v[64:79], v[112:115], v[120:123], v[64:79]
    buffer_load_dwordx4 v[180:183], v2, s[16:19], s74 offen offset:3072 sc1
    v_exp_f32 v60, v60
    v_exp_f32 v61, v61
    v_smfmac_f32_16x16x64_bf16 v[4:7], v[8:11], v[120:127], v23
    v_mov_b32 v20, v3
    ds_read_b128 v[112:115], v20 offset:2048
    v_exp_f32 v62, v62
    v_exp_f32 v63, v63
    v_cvt_pk_bf16_f32 v124, v56, v57
    v_cvt_pk_bf16_f32 v125, v58, v59
    v_cvt_pk_bf16_f32 v126, v60, v61
    v_cvt_pk_bf16_f32 v127, v62, v63
    s_waitcnt lgkmcnt(1)
    v_mfma_f32_32x32x16_bf16 v[48:63], v[104:107], v[96:99], v[80:95]
    v_exp_f32 v32, v32
    v_exp_f32 v33, v33
    s_add_u32 s74, s76, 12288
    buffer_load_dwordx4 v[184:187], v2, s[16:19], s74 offen offset:0 sc1
    v_exp_f32 v34, v34
    v_exp_f32 v35, v35
    v_cvt_pk_bf16_f32 v120, v32, v33
    v_cvt_pk_bf16_f32 v121, v34, v35
    v_mfma_f32_32x32x16_bf16 v[64:79], v[116:119], v[124:127], v[64:79]
    v_exp_f32 v36, v36
    v_exp_f32 v37, v37
    v_exp_f32 v38, v38
    v_exp_f32 v39, v39
    v_cvt_pk_bf16_f32 v122, v36, v37
    v_cvt_pk_bf16_f32 v123, v38, v39
    v_mfma_f32_32x32x16_bf16 v[48:63], v[108:111], v[100:103], v[48:63]
    ds_read_b128 v[104:107], v3 offset:24576
    ds_read_b128 v[108:111], v3 offset:25600
    ds_read_b128 v[116:119], v20 offset:3072
    v_exp_f32 v40, v40
    v_exp_f32 v41, v41
    v_exp_f32 v42, v42
    v_exp_f32 v43, v43
    s_waitcnt lgkmcnt(3)
    v_mfma_f32_32x32x16_bf16 v[64:79], v[112:115], v[120:123], v[64:79]
    buffer_load_dwordx4 v[188:191], v2, s[16:19], s74 offen offset:1024 sc1
    v_exp_f32 v44, v44
    v_exp_f32 v45, v45
    v_smfmac_f32_16x16x64_bf16 v[4:7], v[8:11], v[120:127], v23
    ds_read_b128 v[112:115], v20 offset:14336
    v_exp_f32 v46, v46
    v_exp_f32 v47, v47
    v_cvt_pk_bf16_f32 v124, v40, v41
    v_cvt_pk_bf16_f32 v125, v42, v43
    v_cvt_pk_bf16_f32 v126, v44, v45
    v_cvt_pk_bf16_f32 v127, v46, v47
    s_waitcnt lgkmcnt(1)
    v_mfma_f32_32x32x16_bf16 v[32:47], v[104:107], v[96:99], v[80:95]
    v_exp_f32 v48, v48
    v_exp_f32 v49, v49
    buffer_load_dwordx4 v[192:195], v2, s[16:19], s74 offen offset:2048 sc1
    v_exp_f32 v50, v50
    v_exp_f32 v51, v51
    v_cvt_pk_bf16_f32 v120, v48, v49
    v_cvt_pk_bf16_f32 v121, v50, v51
    v_mfma_f32_32x32x16_bf16 v[64:79], v[116:119], v[124:127], v[64:79]
    v_exp_f32 v52, v52
    v_exp_f32 v53, v53
    v_exp_f32 v54, v54
    v_exp_f32 v55, v55
    v_cvt_pk_bf16_f32 v122, v52, v53
    v_cvt_pk_bf16_f32 v123, v54, v55
    v_mfma_f32_32x32x16_bf16 v[32:47], v[108:111], v[100:103], v[32:47]
    ds_read_b128 v[104:107], v3 offset:36864
    ds_read_b128 v[108:111], v3 offset:37888
    ds_read_b128 v[116:119], v20 offset:15360
    v_exp_f32 v56, v56
    v_exp_f32 v57, v57
    v_exp_f32 v58, v58
    v_exp_f32 v59, v59
    s_waitcnt lgkmcnt(3)
    v_mfma_f32_32x32x16_bf16 v[64:79], v[112:115], v[120:123], v[64:79]
    buffer_load_dwordx4 v[196:199], v2, s[16:19], s74 offen offset:3072 sc1
    v_exp_f32 v60, v60
    v_exp_f32 v61, v61
    v_smfmac_f32_16x16x64_bf16 v[4:7], v[8:11], v[120:127], v23
    ds_read_b128 v[112:115], v20 offset:26624
    v_exp_f32 v62, v62
    v_exp_f32 v63, v63
    v_cvt_pk_bf16_f32 v124, v56, v57
    v_cvt_pk_bf16_f32 v125, v58, v59
    v_cvt_pk_bf16_f32 v126, v60, v61
    v_cvt_pk_bf16_f32 v127, v62, v63
    s_waitcnt lgkmcnt(1)
    v_mfma_f32_32x32x16_bf16 v[48:63], v[104:107], v[96:99], v[80:95]
    v_exp_f32 v32, v32
    v_exp_f32 v33, v33
    s_add_u32 s74, s76, 16384
    buffer_load_dwordx4 v[200:203], v2, s[16:19], s74 offen offset:0 sc1
    v_exp_f32 v34, v34
    v_exp_f32 v35, v35
    v_cvt_pk_bf16_f32 v120, v32, v33
    v_cvt_pk_bf16_f32 v121, v34, v35
    v_mfma_f32_32x32x16_bf16 v[64:79], v[116:119], v[124:127], v[64:79]
    v_exp_f32 v36, v36
    v_exp_f32 v37, v37
    v_exp_f32 v38, v38
    v_exp_f32 v39, v39
    v_cvt_pk_bf16_f32 v122, v36, v37
    v_cvt_pk_bf16_f32 v123, v38, v39
    v_mfma_f32_32x32x16_bf16 v[48:63], v[108:111], v[100:103], v[48:63]
    s_waitcnt vmcnt(13)
    s_barrier
    s_add_u32 s37, s37, 4096
    s_cmp_eq_u32 s37, 77824
    s_cselect_b32 s37, 65536, s37
    v_add_u32 v3, s37, v2
    ds_read_b128 v[104:107], v3 offset:0
    ds_read_b128 v[108:111], v3 offset:1024
    ds_read_b128 v[116:119], v20 offset:27648
    v_exp_f32 v40, v40
    v_exp_f32 v41, v41
    v_exp_f32 v42, v42
    v_exp_f32 v43, v43
    s_waitcnt lgkmcnt(3)
    v_mfma_f32_32x32x16_bf16 v[64:79], v[112:115], v[120:123], v[64:79]
    buffer_load_dwordx4 v[204:207], v2, s[16:19], s74 offen offset:1024 sc1
    v_exp_f32 v44, v44
    v_exp_f32 v45, v45
    v_smfmac_f32_16x16x64_bf16 v[4:7], v[8:11], v[120:127], v23
    ds_read_b128 v[112:115], v20 offset:38912
    v_exp_f32 v46, v46
    v_exp_f32 v47, v47
    v_cvt_pk_bf16_f32 v124, v40, v41
    v_cvt_pk_bf16_f32 v125, v42, v43
    v_cvt_pk_bf16_f32 v126, v44, v45
    v_cvt_pk_bf16_f32 v127, v46, v47
    s_waitcnt lgkmcnt(1)
    v_mfma_f32_32x32x16_bf16 v[32:47], v[104:107], v[96:99], v[80:95]
    v_exp_f32 v48, v48
    v_exp_f32 v49, v49
    buffer_load_dwordx4 v[208:211], v2, s[16:19], s74 offen offset:2048 sc1
    v_exp_f32 v50, v50
    v_exp_f32 v51, v51
    v_cvt_pk_bf16_f32 v120, v48, v49
    v_cvt_pk_bf16_f32 v121, v50, v51
    v_mfma_f32_32x32x16_bf16 v[64:79], v[116:119], v[124:127], v[64:79]
    v_exp_f32 v52, v52
    v_exp_f32 v53, v53
    v_exp_f32 v54, v54
    v_exp_f32 v55, v55
    v_cvt_pk_bf16_f32 v122, v52, v53
    v_cvt_pk_bf16_f32 v123, v54, v55
    v_mfma_f32_32x32x16_bf16 v[32:47], v[108:111], v[100:103], v[32:47]
    ds_read_b128 v[104:107], v3 offset:12288
    ds_read_b128 v[108:111], v3 offset:13312
    ds_read_b128 v[116:119], v20 offset:39936
    v_exp_f32 v56, v56
    v_exp_f32 v57, v57
    v_exp_f32 v58, v58
    v_exp_f32 v59, v59
    s_waitcnt lgkmcnt(3)
    v_mfma_f32_32x32x16_bf16 v[64:79], v[112:115], v[120:123], v[64:79]
    buffer_load_dwordx4 v[212:215], v2, s[16:19], s74 offen offset:3072 sc1
    v_exp_f32 v60, v60
    v_exp_f32 v61, v61
    v_smfmac_f32_16x16x64_bf16 v[4:7], v[8:11], v[120:127], v23
    v_mov_b32 v20, v3
    ds_read_b128 v[112:115], v20 offset:2048
    v_exp_f32 v62, v62
    v_exp_f32 v63, v63
    v_cvt_pk_bf16_f32 v124, v56, v57
    v_cvt_pk_bf16_f32 v125, v58, v59
    v_cvt_pk_bf16_f32 v126, v60, v61
    v_cvt_pk_bf16_f32 v127, v62, v63
    s_waitcnt lgkmcnt(1)
    v_mfma_f32_32x32x16_bf16 v[48:63], v[104:107], v[96:99], v[80:95]
    v_exp_f32 v32, v32
    v_exp_f32 v33, v33
    s_add_u32 s74, s76, 20480
    buffer_load_dwordx4 v[216:219], v2, s[16:19], s74 offen offset:0 sc1
    v_exp_f32 v34, v34
    v_exp_f32 v35, v35
    v_cvt_pk_bf16_f32 v120, v32, v33
    v_cvt_pk_bf16_f32 v121, v34, v35
    v_mfma_f32_32x32x16_bf16 v[64:79], v[116:119], v[124:127], v[64:79]
    v_exp_f32 v36, v36
    v_exp_f32 v37, v37
    v_exp_f32 v38, v38
    v_exp_f32 v39, v39
    v_cvt_pk_bf16_f32 v122, v36, v37
    v_cvt_pk_bf16_f32 v123, v38, v39
    v_mfma_f32_32x32x16_bf16 v[48:63], v[108:111], v[100:103], v[48:63]
    ds_read_b128 v[104:107], v3 offset:24576
    ds_read_b128 v[108:111], v3 offset:25600
    ds_read_b128 v[116:119], v20 offset:3072
    v_exp_f32 v40, v40
    v_exp_f32 v41, v41
    v_exp_f32 v42, v42
    v_exp_f32 v43, v43
    s_waitcnt lgkmcnt(3)
    v_mfma_f32_32x32x16_bf16 v[64:79], v[112:115], v[120:123], v[64:79]
    buffer_load_dwordx4 v[220:223], v2, s[16:19], s74 offen offset:1024 sc1
    v_exp_f32 v44, v44
    v_exp_f32 v45, v45
    v_smfmac_f32_16x16x64_bf16 v[4:7], v[8:11], v[120:127], v23
    ds_read_b128 v[112:115], v20 offset:14336
    v_exp_f32 v46, v46
    v_exp_f32 v47, v47
    v_cvt_pk_bf16_f32 v124, v40, v41
    v_cvt_pk_bf16_f32 v125, v42, v43
    v_cvt_pk_bf16_f32 v126, v44, v45
    v_cvt_pk_bf16_f32 v127, v46, v47
    s_waitcnt lgkmcnt(1)
    v_mfma_f32_32x32x16_bf16 v[32:47], v[104:107], v[96:99], v[80:95]
    v_exp_f32 v48, v48
    v_exp_f32 v49, v49
    buffer_load_dwordx4 v[224:227], v2, s[16:19], s74 offen offset:2048 sc1
    v_exp_f32 v50, v50
    v_exp_f32 v51, v51
    v_cvt_pk_bf16_f32 v120, v48, v49
    v_cvt_pk_bf16_f32 v121, v50, v51
    v_mfma_f32_32x32x16_bf16 v[64:79], v[116:119], v[124:127], v[64:79]
    v_exp_f32 v52, v52
    v_exp_f32 v53, v53
    v_exp_f32 v54, v54
    v_exp_f32 v55, v55
    v_cvt_pk_bf16_f32 v122, v52, v53
    v_cvt_pk_bf16_f32 v123, v54, v55
    v_mfma_f32_32x32x16_bf16 v[32:47], v[108:111], v[100:103], v[32:47]
    ds_read_b128 v[104:107], v3 offset:36864
    ds_read_b128 v[108:111], v3 offset:37888
    ds_read_b128 v[116:119], v20 offset:15360
    v_exp_f32 v56, v56
    v_exp_f32 v57, v57
    v_exp_f32 v58, v58
    v_exp_f32 v59, v59
    s_waitcnt lgkmcnt(3)
    v_mfma_f32_32x32x16_bf16 v[64:79], v[112:115], v[120:123], v[64:79]
    buffer_load_dwordx4 v[228:231], v2, s[16:19], s74 offen offset:3072 sc1
    v_exp_f32 v60, v60
    v_exp_f32 v61, v61
    v_smfmac_f32_16x16x64_bf16 v[4:7], v[8:11], v[120:127], v23
    ds_read_b128 v[112:115], v20 offset:26624
    v_exp_f32 v62, v62
    v_exp_f32 v63, v63
    v_cvt_pk_bf16_f32 v124, v56, v57
    v_cvt_pk_bf16_f32 v125, v58, v59
    v_cvt_pk_bf16_f32 v126, v60, v61
    v_cvt_pk_bf16_f32 v127, v62, v63
    s_waitcnt lgkmcnt(1)
    v_mfma_f32_32x32x16_bf16 v[48:63], v[104:107], v[96:99], v[80:95]
    v_exp_f32 v32, v32
    v_exp_f32 v33, v33
    s_add_u32 s74, s76, 24576
    buffer_load_dwordx4 v[232:235], v2, s[16:19], s74 offen offset:0 sc1
    v_exp_f32 v34, v34
    v_exp_f32 v35, v35
    v_cvt_pk_bf16_f32 v120, v32, v33
    v_cvt_pk_bf16_f32 v121, v34, v35
    v_mfma_f32_32x32x16_bf16 v[64:79], v[116:119], v[124:127], v[64:79]
    v_exp_f32 v36, v36
    v_exp_f32 v37, v37
    v_exp_f32 v38, v38
    v_exp_f32 v39, v39
    v_cvt_pk_bf16_f32 v122, v36, v37
    v_cvt_pk_bf16_f32 v123, v38, v39
    v_mfma_f32_32x32x16_bf16 v[48:63], v[108:111], v[100:103], v[48:63]
    v_add_u32 v3, 49152, v3
    ds_read_b128 v[104:107], v3 offset:0
    ds_read_b128 v[108:111], v3 offset:1024
    ds_read_b128 v[116:119], v20 offset:27648
    v_exp_f32 v40, v40
    v_exp_f32 v41, v41
    v_exp_f32 v42, v42
    v_exp_f32 v43, v43
    s_waitcnt lgkmcnt(3)
    v_mfma_f32_32x32x16_bf16 v[64:79], v[112:115], v[120:123], v[64:79]
    buffer_load_dwordx4 v[236:239], v2, s[16:19], s74 offen offset:1024 sc1
    v_exp_f32 v44, v44
    v_exp_f32 v45, v45
    v_smfmac_f32_16x16x64_bf16 v[4:7], v[8:11], v[120:127], v23
    ds_read_b128 v[112:115], v20 offset:38912
    v_exp_f32 v46, v46
    v_exp_f32 v47, v47
    v_cvt_pk_bf16_f32 v124, v40, v41
    v_cvt_pk_bf16_f32 v125, v42, v43
    v_cvt_pk_bf16_f32 v126, v44, v45
    v_cvt_pk_bf16_f32 v127, v46, v47
    s_waitcnt lgkmcnt(1)
    v_mfma_f32_32x32x16_bf16 v[32:47], v[104:107], v[96:99], v[80:95]
    v_exp_f32 v48, v48
    v_exp_f32 v49, v49
    buffer_load_dwordx4 v[240:243], v2, s[16:19], s74 offen offset:2048 sc1
    v_exp_f32 v50, v50
    v_exp_f32 v51, v51
    v_cvt_pk_bf16_f32 v120, v48, v49
    v_cvt_pk_bf16_f32 v121, v50, v51
    v_mfma_f32_32x32x16_bf16 v[64:79], v[116:119], v[124:127], v[64:79]
    v_exp_f32 v52, v52
    v_exp_f32 v53, v53
    v_exp_f32 v54, v54
    v_exp_f32 v55, v55
    v_cvt_pk_bf16_f32 v122, v52, v53
    v_cvt_pk_bf16_f32 v123, v54, v55
    v_mfma_f32_32x32x16_bf16 v[32:47], v[108:111], v[100:103], v[32:47]
    ds_read_b128 v[104:107], v3 offset:12288
    ds_read_b128 v[108:111], v3 offset:13312
    ds_read_b128 v[116:119], v20 offset:39936
    v_exp_f32 v56, v56
    v_exp_f32 v57, v57
    v_exp_f32 v58, v58
    v_exp_f32 v59, v59
    s_waitcnt lgkmcnt(3)
    v_mfma_f32_32x32x16_bf16 v[64:79], v[112:115], v[120:123], v[64:79]
    buffer_load_dwordx4 v[244:247], v2, s[16:19], s74 offen offset:3072 sc1
    v_exp_f32 v60, v60
    v_exp_f32 v61, v61
    v_smfmac_f32_16x16x64_bf16 v[4:7], v[8:11], v[120:127], v23
    v_mov_b32 v20, v3
    ds_read_b128 v[112:115], v20 offset:2048
    v_exp_f32 v62, v62
    v_exp_f32 v63, v63
    v_cvt_pk_bf16_f32 v124, v56, v57
    v_cvt_pk_bf16_f32 v125, v58, v59
    v_cvt_pk_bf16_f32 v126, v60, v61
    v_cvt_pk_bf16_f32 v127, v62, v63
    s_waitcnt lgkmcnt(1)
    v_mfma_f32_32x32x16_bf16 v[48:63], v[104:107], v[96:99], v[80:95]
    v_exp_f32 v32, v32
    v_exp_f32 v33, v33
    v_exp_f32 v34, v34
    v_exp_f32 v35, v35
    v_cvt_pk_bf16_f32 v120, v32, v33
    v_cvt_pk_bf16_f32 v121, v34, v35
    v_mfma_f32_32x32x16_bf16 v[64:79], v[116:119], v[124:127], v[64:79]
    v_exp_f32 v36, v36
    v_exp_f32 v37, v37
    v_exp_f32 v38, v38
    v_exp_f32 v39, v39
    v_cvt_pk_bf16_f32 v122, v36, v37
    v_cvt_pk_bf16_f32 v123, v38, v39
    v_mfma_f32_32x32x16_bf16 v[48:63], v[108:111], v[100:103], v[48:63]
    ds_read_b128 v[104:107], v3 offset:24576
    ds_read_b128 v[108:111], v3 offset:25600
    ds_read_b128 v[116:119], v20 offset:3072
    v_exp_f32 v40, v40
    v_exp_f32 v41, v41
    v_exp_f32 v42, v42
    v_exp_f32 v43, v43
    s_waitcnt lgkmcnt(3)
    v_mfma_f32_32x32x16_bf16 v[64:79], v[112:115], v[120:123], v[64:79]
    v_exp_f32 v44, v44
    v_exp_f32 v45, v45
    v_smfmac_f32_16x16x64_bf16 v[4:7], v[8:11], v[120:127], v23
    ds_read_b128 v[112:115], v20 offset:14336
    v_exp_f32 v46, v46
    v_exp_f32 v47, v47
    v_cvt_pk_bf16_f32 v124, v40, v41
    v_cvt_pk_bf16_f32 v125, v42, v43
    v_cvt_pk_bf16_f32 v126, v44, v45
    v_cvt_pk_bf16_f32 v127, v46, v47
    s_waitcnt lgkmcnt(1)
    v_mfma_f32_32x32x16_bf16 v[32:47], v[104:107], v[96:99], v[80:95]
    v_exp_f32 v48, v48
    v_exp_f32 v49, v49
    v_exp_f32 v50, v50
    v_exp_f32 v51, v51
    v_cvt_pk_bf16_f32 v120, v48, v49
    v_cvt_pk_bf16_f32 v121, v50, v51
    v_mfma_f32_32x32x16_bf16 v[64:79], v[116:119], v[124:127], v[64:79]
    v_exp_f32 v52, v52
    v_exp_f32 v53, v53
    v_exp_f32 v54, v54
    v_exp_f32 v55, v55
    v_cvt_pk_bf16_f32 v122, v52, v53
    v_cvt_pk_bf16_f32 v123, v54, v55
    v_mfma_f32_32x32x16_bf16 v[32:47], v[108:111], v[100:103], v[32:47]
    ds_read_b128 v[104:107], v3 offset:36864
    ds_read_b128 v[108:111], v3 offset:37888
    ds_read_b128 v[116:119], v20 offset:15360
    v_exp_f32 v56, v56
    v_exp_f32 v57, v57
    v_exp_f32 v58, v58
    v_exp_f32 v59, v59
    s_waitcnt lgkmcnt(3)
    v_mfma_f32_32x32x16_bf16 v[64:79], v[112:115], v[120:123], v[64:79]
    v_exp_f32 v60, v60
    v_exp_f32 v61, v61
    v_smfmac_f32_16x16x64_bf16 v[4:7], v[8:11], v[120:127], v23
    ds_read_b128 v[112:115], v20 offset:26624
    v_exp_f32 v62, v62
    v_exp_f32 v63, v63
    v_cvt_pk_bf16_f32 v124, v56, v57
    v_cvt_pk_bf16_f32 v125, v58, v59
    v_cvt_pk_bf16_f32 v126, v60, v61
    v_cvt_pk_bf16_f32 v127, v62, v63
    s_waitcnt lgkmcnt(1)
    v_mfma_f32_32x32x16_bf16 v[48:63], v[104:107], v[96:99], v[80:95]
    v_exp_f32 v32, v32
    v_exp_f32 v33, v33
    v_exp_f32 v34, v34
    v_exp_f32 v35, v35
    v_cvt_pk_bf16_f32 v120, v32, v33
    v_cvt_pk_bf16_f32 v121, v34, v35
    v_mfma_f32_32x32x16_bf16 v[64:79], v[116:119], v[124:127], v[64:79]
    v_exp_f32 v36, v36
    v_exp_f32 v37, v37
    v_exp_f32 v38, v38
    v_exp_f32 v39, v39
    v_cvt_pk_bf16_f32 v122, v36, v37
    v_cvt_pk_bf16_f32 v123, v38, v39
    v_mfma_f32_32x32x16_bf16 v[48:63], v[108:111], v[100:103], v[48:63]
    ds_read_b128 v[116:119], v20 offset:27648
    v_exp_f32 v40, v40
    v_exp_f32 v41, v41
    v_exp_f32 v42, v42
    v_exp_f32 v43, v43
    s_waitcnt lgkmcnt(1)
    v_mfma_f32_32x32x16_bf16 v[64:79], v[112:115], v[120:123], v[64:79]
    v_exp_f32 v44, v44
    v_exp_f32 v45, v45
    v_smfmac_f32_16x16x64_bf16 v[4:7], v[8:11], v[120:127], v23
    ds_read_b128 v[112:115], v20 offset:38912
    v_exp_f32 v46, v46
    v_exp_f32 v47, v47
    v_cvt_pk_bf16_f32 v124, v40, v41
    v_cvt_pk_bf16_f32 v125, v42, v43
    v_cvt_pk_bf16_f32 v126, v44, v45
    v_cvt_pk_bf16_f32 v127, v46, v47
    s_waitcnt lgkmcnt(1)
    v_exp_f32 v48, v48
    v_exp_f32 v49, v49
    v_exp_f32 v50, v50
    v_exp_f32 v51, v51
    v_cvt_pk_bf16_f32 v120, v48, v49
    v_cvt_pk_bf16_f32 v121, v50, v51
    v_mfma_f32_32x32x16_bf16 v[64:79], v[116:119], v[124:127], v[64:79]
    v_exp_f32 v52, v52
    v_exp_f32 v53, v53
    v_exp_f32 v54, v54
    v_exp_f32 v55, v55
    v_cvt_pk_bf16_f32 v122, v52, v53
    v_cvt_pk_bf16_f32 v123, v54, v55
    ds_read_b128 v[116:119], v20 offset:39936
    v_exp_f32 v56, v56
    v_exp_f32 v57, v57
    v_exp_f32 v58, v58
    v_exp_f32 v59, v59
    s_waitcnt lgkmcnt(1)
    v_mfma_f32_32x32x16_bf16 v[64:79], v[112:115], v[120:123], v[64:79]
    v_exp_f32 v60, v60
    v_exp_f32 v61, v61
    v_smfmac_f32_16x16x64_bf16 v[4:7], v[8:11], v[120:127], v23
    v_exp_f32 v62, v62
    v_exp_f32 v63, v63
    v_cvt_pk_bf16_f32 v124, v56, v57
    v_cvt_pk_bf16_f32 v125, v58, v59
    v_cvt_pk_bf16_f32 v126, v60, v61
    v_cvt_pk_bf16_f32 v127, v62, v63
    s_waitcnt lgkmcnt(0)
    s_nop 0
    v_mfma_f32_32x32x16_bf16 v[64:79], v[116:119], v[124:127], v[64:79]
    v_mfma_f32_16x16x32_bf16 v[128:131], v[132:135], v[124:127], v[128:131]
    v_add_f32 v4, v4, v5
    s_nop 6
    v_add_f32 v128, v128, v4
    v_rcp_f32 v14, v128
    s_nop 0
    v_mul_f32 v64, v14, v64
    v_mul_f32 v65, v14, v65
    v_mul_f32 v66, v14, v66
    v_mul_f32 v67, v14, v67
    v_mul_f32 v68, v14, v68
    v_mul_f32 v69, v14, v69
    v_mul_f32 v70, v14, v70
    v_mul_f32 v71, v14, v71
    v_mul_f32 v72, v14, v72
    v_mul_f32 v73, v14, v73
    v_mul_f32 v74, v14, v74
    v_mul_f32 v75, v14, v75
    v_mul_f32 v76, v14, v76
    v_mul_f32 v77, v14, v77
    v_mul_f32 v78, v14, v78
    v_mul_f32 v79, v14, v79
    v_cvt_pk_bf16_f32 v120, v64, v65
    v_cvt_pk_bf16_f32 v121, v66, v67
    v_cvt_pk_bf16_f32 v122, v68, v69
    v_cvt_pk_bf16_f32 v123, v70, v71
    v_cvt_pk_bf16_f32 v124, v72, v73
    v_cvt_pk_bf16_f32 v125, v74, v75
    v_cvt_pk_bf16_f32 v126, v76, v77
    v_cvt_pk_bf16_f32 v127, v78, v79
    buffer_store_dwordx4 v[120:123], v2, s[16:19], s36 offen offset:0 sc1
    buffer_store_dwordx4 v[124:127], v2, s[16:19], s36 offen offset:1024 sc1
    v_mfma_f32_16x16x32_bf16 v[32:35], v[132:135], v[120:123], 0
    v_mfma_f32_16x16x32_bf16 v[32:35], v[132:135], v[124:127], v[32:35]
    s_mov_b32 s26, 0x71800000
    v_cmp_nge_f32_e64 s[24:25], s26, v128
    v_mov_b32 v14, 0x207
    s_nop 4
    v_cmp_class_f32 vcc, v32, v14
    s_or_b64 vcc, vcc, s[24:25]
    s_cbranch_scc1 L_fb
L_fbret:
    s_lshl_b32 s24, s75, 16
    v_add_u32 v81, s24, v2
    s_sub_u32 s24, 63, s75
    s_sub_u32 s25, 64, s75
    s_cmp_eq_u32 s75, 0
    s_cselect_b32 s25, 32, s25
    v_and_b32 v14, 31, v1
    v_cmp_eq_u32 vcc, 0, v14
    v_mov_b32 v16, s24
    v_mov_b32 v17, s25
    v_cndmask_b32 v16, v16, v17, vcc
    v_sub_u32 v14, 32, v14
    v_and_b32 v14, 31, v14
    v_and_b32 v17, 32, v1
    v_add_u32 v14, v14, v17
    v_lshlrev_b32 v14, 4, v14
    v_lshl_add_u32 v82, v16, 16, v14
    v_cmp_eq_u32 vcc, 0, v17
    v_mov_b32 v14, s75
    s_nop 0
    v_cndmask_b32 v16, v16, v14, vcc
    v_lshlrev_b32 v83, 10, v16
    s_lshl_b32 s70, s3, 7
    s_add_u32 s70, s70, 0x1510000
    s_mov_b32 s72, 1
    s_mov_b32 s73, 3
    s_mov_b64 exec, s[72:73]
    buffer_load_dwordx4 v[4:7], v83, s[16:19], s70 offen sc1
    s_mov_b64 exec, -1
    v_lshrrev_b32 v14, 3, v1
    s_lshl_b32 s24, s66, 3
    v_add_u32 v14, s24, v14
    v_and_b32 v15, 7, v1
    v_mul_u32_u24 v84, 544, v15
    v_mov_b32 v19, v84
    v_lshl_add_u32 v84, v14, 4, v84
    ds_read_b128 v[88:91], v84 offset:0
    ds_read_b128 v[92:95], v84 offset:4352
    ds_read_b128 v[96:99], v84 offset:8704
    ds_read_b128 v[100:103], v84 offset:13056
    ds_read_b128 v[104:107], v84 offset:17408
    ds_read_b128 v[108:111], v84 offset:21760
    ds_read_b128 v[112:115], v84 offset:26112
    ds_read_b128 v[116:119], v84 offset:30464
    s_lshl_b32 s24, s75, 5
    v_add_u32 v14, s24, v14
    v_sub_u32 v16, 2048, v14
    v_cmp_eq_u32 vcc, 0, v14
    v_mov_b32 v17, 1024
    s_nop 0
    v_cndmask_b32 v16, v16, v17, vcc
    v_cndmask_b32 v17, v14, v17, vcc
    s_cmp_lg_u32 s67, 0
    s_cselect_b64 vcc, -1, 0
    v_cndmask_b32 v85, v14, v16, vcc
    v_cndmask_b32 v17, v14, v17, vcc
    v_lshlrev_b32 v16, 2, v85
    v_lshlrev_b32 v17, 5, v17
    v_lshlrev_b32 v14, 5, v14
    s_mov_b32 s24, 0x1400000
    s_mov_b32 s25, 0x1420000
    s_mov_b32 s26, 0x1430000
    buffer_load_dword v32, v16, s[16:19], s24 offen sc1
    buffer_load_dwordx4 v[36:39], v17, s[16:19], s25 offen sc1
    buffer_load_dwordx4 v[40:43], v17, s[16:19], s25 offen offset:16 sc1
    buffer_load_dwordx4 v[44:47], v14, s[16:19], s26 offen sc1
    s_waitcnt lgkmcnt(6)
    v_add_f32 v88, v88, v92
    v_add_f32 v89, v89, v93
    v_add_f32 v90, v90, v94
    v_add_f32 v91, v91, v95
    s_waitcnt lgkmcnt(4)
    v_add_f32 v96, v96, v100
    v_add_f32 v97, v97, v101
    v_add_f32 v98, v98, v102
    v_add_f32 v99, v99, v103
    s_waitcnt lgkmcnt(2)
    v_add_f32 v104, v104, v108
    v_add_f32 v105, v105, v109
    v_add_f32 v106, v106, v110
    v_add_f32 v107, v107, v111
    s_waitcnt lgkmcnt(0)
    v_add_f32 v112, v112, v116
    v_add_f32 v113, v113, v117
    v_add_f32 v114, v114, v118
    v_add_f32 v115, v115, v119
    s_xor_b32 s24, s3, 4
    s_or_b32 s24, s24, s75
    s_cmp_lg_u32 s24, 0
    s_cbranch_scc1 L_norow
    s_mov_b64 exec, 0xff
    ds_read_b128 v[88:91], v19 offset:34816
    s_waitcnt lgkmcnt(0)
    ds_read_b128 v[48:51], v19 offset:34832
    s_waitcnt lgkmcnt(0)
    v_add_f32 v88, v88, v48
    v_add_f32 v89, v89, v49
    v_add_f32 v90, v90, v50
    v_add_f32 v91, v91, v51
    ds_read_b128 v[48:51], v19 offset:34848
    s_waitcnt lgkmcnt(0)
    v_add_f32 v88, v88, v48
    v_add_f32 v89, v89, v49
    v_add_f32 v90, v90, v50
    v_add_f32 v91, v91, v51
    ds_read_b128 v[48:51], v19 offset:34864
    s_waitcnt lgkmcnt(0)
    v_add_f32 v88, v88, v48
    v_add_f32 v89, v89, v49
    v_add_f32 v90, v90, v50
    v_add_f32 v91, v91, v51
    ds_read_b128 v[48:51], v19 offset:39168
    s_waitcnt lgkmcnt(0)
    v_add_f32 v88, v88, v48
    v_add_f32 v89, v89, v49
    v_add_f32 v90, v90, v50
    v_add_f32 v91, v91, v51
    ds_read_b128 v[48:51], v19 offset:39184
    s_waitcnt lgkmcnt(0)
    v_add_f32 v88, v88, v48
    v_add_f32 v89, v89, v49
    v_add_f32 v90, v90, v50
    v_add_f32 v91, v91, v51
    ds_read_b128 v[48:51], v19 offset:39200
    s_waitcnt lgkmcnt(0)
    v_add_f32 v88, v88, v48
    v_add_f32 v89, v89, v49
    v_add_f32 v90, v90, v50
    v_add_f32 v91, v91, v51
    ds_read_b128 v[48:51], v19 offset:39216
    s_waitcnt lgkmcnt(0)
    v_add_f32 v88, v88, v48
    v_add_f32 v89, v89, v49
    v_add_f32 v90, v90, v50
    v_add_f32 v91, v91, v51
    ds_read_b128 v[96:99], v19 offset:43520
    s_waitcnt lgkmcnt(0)
    ds_read_b128 v[48:51], v19 offset:43536
    s_waitcnt lgkmcnt(0)
    v_add_f32 v96, v96, v48
    v_add_f32 v97, v97, v49
    v_add_f32 v98, v98, v50
    v_add_f32 v99, v99, v51
    ds_read_b128 v[48:51], v19 offset:43552
    s_waitcnt lgkmcnt(0)
    v_add_f32 v96, v96, v48
    v_add_f32 v97, v97, v49
    v_add_f32 v98, v98, v50
    v_add_f32 v99, v99, v51
    ds_read_b128 v[48:51], v19 offset:43568
    s_waitcnt lgkmcnt(0)
    v_add_f32 v96, v96, v48
    v_add_f32 v97, v97, v49
    v_add_f32 v98, v98, v50
    v_add_f32 v99, v99, v51
    ds_read_b128 v[48:51], v19 offset:47872
    s_waitcnt lgkmcnt(0)
    v_add_f32 v96, v96, v48
    v_add_f32 v97, v97, v49
    v_add_f32 v98, v98, v50
    v_add_f32 v99, v99, v51
    ds_read_b128 v[48:51], v19 offset:47888
    s_waitcnt lgkmcnt(0)
    v_add_f32 v96, v96, v48
    v_add_f32 v97, v97, v49
    v_add_f32 v98, v98, v50
    v_add_f32 v99, v99, v51
    ds_read_b128 v[48:51], v19 offset:47904
    s_waitcnt lgkmcnt(0)
    v_add_f32 v96, v96, v48
    v_add_f32 v97, v97, v49
    v_add_f32 v98, v98, v50
    v_add_f32 v99, v99, v51
    ds_read_b128 v[48:51], v19 offset:47920
    s_waitcnt lgkmcnt(0)
    v_add_f32 v96, v96, v48
    v_add_f32 v97, v97, v49
    v_add_f32 v98, v98, v50
    v_add_f32 v99, v99, v51
    s_mov_b64 exec, -1
L_norow:
    s_waitcnt vmcnt(5)
    s_sub_u32 s24, s36, 0x800000
    s_lshr_b32 s24, s24, 13
    s_lshl_b32 s24, s24, 7
    s_and_b32 s25, s5, 3
    s_lshl2_add_u32 s24, s25, s24
    s_add_u32 s24, s24, 0x1510000
    v_mov_b32 v18, s6
    buffer_store_dword v18, v21, s[16:19], s24 offen sc1
    s_waitcnt vmcnt(1)
    v_add_f32 v36, v36, v37
    v_add_f32 v38, v38, v39
    v_add_f32 v36, v36, v38
    v_add_f32 v40, v40, v41
    v_add_f32 v42, v42, v43
    v_add_f32 v40, v40, v42
    v_add_f32 v44, v44, v45
    v_add_f32 v46, v46, v47
    v_add_f32 v44, v44, v46
    v_cvt_pk_bf16_f32 v32, v32, v32
    v_and_b32 v32, 0xffff0000, v32
    v_mul_f32 v32, 0xbfb8aa3b, v32
    v_exp_f32 v32, v32
    v_add_f32 v40, v40, v36
    v_add_f32 v32, 1.0, v32
    v_rcp_f32 v32, v32
    v_add_f32 v88, v88, v36
    v_sub_f32 v112, v112, v44
    v_sub_f32 v89, v89, v36
    v_add_f32 v113, v113, v44
    v_add_f32 v90, v90, v36
    v_sub_f32 v114, v114, v44
    v_sub_f32 v91, v91, v36
    v_add_f32 v115, v115, v44
    v_cvt_pk_bf16_f32 v32, v32, v32
    v_and_b32 v32, 0xffff0000, v32
    v_sub_f32 v80, 1.0, v32
    v_cvt_pk_bf16_f32 v80, v80, v80
    v_and_b32 v80, 0xffff0000, v80
    s_cmp_lg_u32 s67, 0
    s_cselect_b32 s24, 1.0, -1.0
    v_fma_f32 v64, v104, s24, v88
    v_fma_f32 v72, v104, -s24, v88
    v_fma_f32 v65, v105, s24, v89
    v_fma_f32 v73, v105, -s24, v89
    v_fma_f32 v66, v106, s24, v90
    v_fma_f32 v74, v106, -s24, v90
    v_fma_f32 v67, v107, s24, v91
    v_fma_f32 v75, v107, -s24, v91
    v_fma_f32 v68, v112, s24, v96
    v_fma_f32 v76, v112, -s24, v96
    v_fma_f32 v69, v113, s24, v97
    v_fma_f32 v77, v113, -s24, v97
    v_fma_f32 v70, v114, s24, v98
    v_fma_f32 v78, v114, -s24, v98
    v_fma_f32 v71, v115, s24, v99
    v_fma_f32 v79, v115, -s24, v99
    v_or_b32 v14, s65, v15
    v_cmp_eq_u32 vcc, 0, v14
    s_nop 1
    v_cndmask_b32 v72, v72, v40, vcc
    v_mul_f32 v64, v32, v64
    v_mul_f32 v65, v32, v65
    v_mul_f32 v66, v32, v66
    v_mul_f32 v67, v32, v67
    v_mul_f32 v68, v32, v68
    v_mul_f32 v69, v32, v69
    v_mul_f32 v70, v32, v70
    v_mul_f32 v71, v32, v71
    v_mul_f32 v72, v32, v72
    v_mul_f32 v73, v32, v73
    v_mul_f32 v74, v32, v74
    v_mul_f32 v75, v32, v75
    v_mul_f32 v76, v32, v76
    v_mul_f32 v77, v32, v77
    v_mul_f32 v78, v32, v78
    v_mul_f32 v79, v32, v79
    s_lshl_b32 s24, s65, 7
    v_lshl_add_u32 v14, v15, 4, s24
    v_lshlrev_b32 v85, 11, v85
    v_add_u32 v86, v85, v14
    v_sub_u32 v14, 2032, v14
    v_add_u32 v87, v85, v14
    v_add_u32 v85, 1008, v85
    v_cndmask_b32 v85, v87, v85, vcc
    s_lshl_b32 s24, s67, 14
    v_add_u32 v14, s24, v2
    v_add_u32 v15, 65536, v14
    s_waitcnt lgkmcnt(0)
    s_barrier
    s_lshl_b32 s24, s3, 12
    s_lshl_b32 s25, s3, 13
    s_add_u32 s25, s25, 0x800000
    s_mov_b32 s39, 0
L_po0:
    v_cmp_ne_u32 vcc, s6, v4
    s_and_b64 vcc, vcc, s[72:73]
    s_cbranch_scc0 L_pk0
    s_mov_b64 exec, s[72:73]
    buffer_load_dwordx4 v[4:7], v83, s[16:19], s70 offen sc1
    s_mov_b64 exec, -1
    s_waitcnt vmcnt(0)
    s_add_u32 s39, s39, 1
    s_cmp_lt_u32 s39, 0x40000
    s_cbranch_scc1 L_po0
L_pk0:
    s_add_u32 m0, s24, 65536
    s_nop 0
    buffer_load_dwordx4 v81, s[16:19], s25 offen offset:0 sc1 lds
    buffer_load_dwordx4 v81, s[16:19], s25 offen offset:1024 sc1 lds
    s_add_u32 m0, s24, 67584
    s_nop 0
    buffer_load_dwordx4 v82, s[16:19], s25 offen offset:0 sc1 lds
    buffer_load_dwordx4 v82, s[16:19], s25 offen offset:1024 sc1 lds
    s_add_u32 s25, s25, 2048
L_po1:
    v_cmp_ne_u32 vcc, s6, v5
    s_and_b64 vcc, vcc, s[72:73]
    s_cbranch_scc0 L_pk1
    s_mov_b64 exec, s[72:73]
    buffer_load_dwordx4 v[4:7], v83, s[16:19], s70 offen sc1
    s_mov_b64 exec, -1
    s_waitcnt vmcnt(0)
    s_add_u32 s39, s39, 1
    s_cmp_lt_u32 s39, 0x40000
    s_cbranch_scc1 L_po1
L_pk1:
    s_add_u32 m0, s24, 98304
    s_nop 0
    buffer_load_dwordx4 v81, s[16:19], s25 offen offset:0 sc1 lds
    buffer_load_dwordx4 v81, s[16:19], s25 offen offset:1024 sc1 lds
    s_add_u32 m0, s24, 100352
    s_nop 0
    buffer_load_dwordx4 v82, s[16:19], s25 offen offset:0 sc1 lds
    buffer_load_dwordx4 v82, s[16:19], s25 offen offset:1024 sc1 lds
    s_add_u32 s25, s25, 2048
L_po2:
    v_cmp_ne_u32 vcc, s6, v6
    s_and_b64 vcc, vcc, s[72:73]
    s_cbranch_scc0 L_pk2
    s_mov_b64 exec, s[72:73]
    buffer_load_dwordx4 v[4:7], v83, s[16:19], s70 offen sc1
    s_mov_b64 exec, -1
    s_waitcnt vmcnt(0)
    s_add_u32 s39, s39, 1
    s_cmp_lt_u32 s39, 0x40000
    s_cbranch_scc1 L_po2
L_pk2:
    s_add_u32 m0, s24, 0
    s_nop 0
    buffer_load_dwordx4 v81, s[16:19], s25 offen offset:0 sc1 lds
    buffer_load_dwordx4 v81, s[16:19], s25 offen offset:1024 sc1 lds
    s_add_u32 m0, s24, 2048
    s_nop 0
    buffer_load_dwordx4 v82, s[16:19], s25 offen offset:0 sc1 lds
    buffer_load_dwordx4 v82, s[16:19], s25 offen offset:1024 sc1 lds
    s_add_u32 s25, s25, 2048
L_po3:
    v_cmp_ne_u32 vcc, s6, v7
    s_and_b64 vcc, vcc, s[72:73]
    s_cbranch_scc0 L_pk3
    s_mov_b64 exec, s[72:73]
    buffer_load_dwordx4 v[4:7], v83, s[16:19], s70 offen sc1
    s_mov_b64 exec, -1
    s_waitcnt vmcnt(0)
    s_add_u32 s39, s39, 1
    s_cmp_lt_u32 s39, 0x40000
    s_cbranch_scc1 L_po3
L_pk3:
    s_add_u32 m0, s24, 32768
    s_nop 0
    buffer_load_dwordx4 v81, s[16:19], s25 offen offset:0 sc1 lds
    buffer_load_dwordx4 v81, s[16:19], s25 offen offset:1024 sc1 lds
    s_add_u32 m0, s24, 34816
    s_nop 0
    buffer_load_dwordx4 v82, s[16:19], s25 offen offset:0 sc1 lds
    buffer_load_dwordx4 v82, s[16:19], s25 offen offset:1024 sc1 lds
    s_waitcnt vmcnt(12)
    s_barrier
    ds_read_b128 v[88:91], v15 offset:0
    ds_read_b128 v[92:95], v15 offset:2048
    ds_read_b128 v[96:99], v15 offset:1024
    ds_read_b128 v[100:103], v15 offset:3072
    ds_read_b128 v[104:107], v15 offset:4096
    ds_read_b128 v[108:111], v15 offset:6144
    s_waitcnt lgkmcnt(4)
    v_mfma_f32_32x32x16_bf16 v[32:47], v[136:139], v[88:91], 0
    v_mfma_f32_32x32x16_bf16 v[48:63], v[136:139], v[92:95], 0
    ds_read_b128 v[112:115], v15 offset:5120
    ds_read_b128 v[116:119], v15 offset:7168
    s_waitcnt lgkmcnt(4)
    v_mfma_f32_32x32x16_bf16 v[32:47], v[140:143], v[96:99], v[32:47]
    v_mfma_f32_32x32x16_bf16 v[48:63], v[140:143], v[100:103], v[48:63]
    ds_read_b128 v[120:123], v15 offset:8192
    ds_read_b128 v[124:127], v15 offset:10240
    s_waitcnt lgkmcnt(4)
    v_mfma_f32_32x32x16_bf16 v[32:47], v[168:171], v[104:107], v[32:47]
    v_mfma_f32_32x32x16_bf16 v[48:63], v[168:171], v[108:111], v[48:63]
    ds_read_b128 v[128:131], v15 offset:9216
    ds_read_b128 v[132:135], v15 offset:11264
    s_waitcnt lgkmcnt(4)
    v_mfma_f32_32x32x16_bf16 v[32:47], v[172:175], v[112:115], v[32:47]
    v_mfma_f32_32x32x16_bf16 v[48:63], v[172:175], v[116:119], v[48:63]
    ds_read_b128 v[88:91], v15 offset:12288
    ds_read_b128 v[92:95], v15 offset:14336
    s_waitcnt lgkmcnt(4)
    v_mfma_f32_32x32x16_bf16 v[32:47], v[200:203], v[120:123], v[32:47]
    v_mfma_f32_32x32x16_bf16 v[48:63], v[200:203], v[124:127], v[48:63]
    v_lshrrev_b32 v17, 5, v1
    v_lshl_add_u32 v16, v17, 5, v2
    s_lshl1_add_u32 s24, s66, s67
    s_mul_i32 s24, s24, 4352
    s_add_u32 s24, s24, 65536
    v_add_u32 v16, s24, v16
    s_mul_i32 s24, s67, 34816
    s_add_u32 s24, s24, 65536
    v_add_u32 v84, s24, v84
    ds_read_b128 v[96:99], v15 offset:13312
    ds_read_b128 v[100:103], v15 offset:15360
    s_waitcnt lgkmcnt(4)
    v_mfma_f32_32x32x16_bf16 v[32:47], v[204:207], v[128:131], v[32:47]
    v_mfma_f32_32x32x16_bf16 v[48:63], v[204:207], v[132:135], v[48:63]
    s_waitcnt vmcnt(8)
    s_barrier
    ds_read_b128 v[104:107], v15 offset:32768
    ds_read_b128 v[108:111], v15 offset:34816
    s_waitcnt lgkmcnt(4)
    v_mfma_f32_32x32x16_bf16 v[32:47], v[232:235], v[88:91], v[32:47]
    v_mfma_f32_32x32x16_bf16 v[48:63], v[232:235], v[92:95], v[48:63]
    ds_read_b128 v[112:115], v15 offset:33792
    ds_read_b128 v[116:119], v15 offset:35840
    s_waitcnt lgkmcnt(4)
    v_mfma_f32_32x32x16_bf16 v[32:47], v[236:239], v[96:99], v[32:47]
    v_mfma_f32_32x32x16_bf16 v[48:63], v[236:239], v[100:103], v[48:63]
    ds_read_b128 v[120:123], v15 offset:36864
    ds_read_b128 v[124:127], v15 offset:38912
    s_waitcnt lgkmcnt(4)
    v_mfma_f32_32x32x16_bf16 v[32:47], v[144:147], v[104:107], v[32:47]
    v_mfma_f32_32x32x16_bf16 v[48:63], v[144:147], v[108:111], v[48:63]
    ds_read_b128 v[128:131], v15 offset:37888
    ds_read_b128 v[132:135], v15 offset:39936
    s_waitcnt lgkmcnt(4)
    v_mfma_f32_32x32x16_bf16 v[32:47], v[148:151], v[112:115], v[32:47]
    v_mfma_f32_32x32x16_bf16 v[48:63], v[148:151], v[116:119], v[48:63]
    ds_read_b128 v[88:91], v15 offset:40960
    ds_read_b128 v[92:95], v15 offset:43008
    s_waitcnt lgkmcnt(4)
    v_mfma_f32_32x32x16_bf16 v[32:47], v[176:179], v[120:123], v[32:47]
    v_mfma_f32_32x32x16_bf16 v[48:63], v[176:179], v[124:127], v[48:63]
    ds_read_b128 v[96:99], v15 offset:41984
    ds_read_b128 v[100:103], v15 offset:44032
    s_waitcnt lgkmcnt(4)
    v_mfma_f32_32x32x16_bf16 v[32:47], v[180:183], v[128:131], v[32:47]
    v_mfma_f32_32x32x16_bf16 v[48:63], v[180:183], v[132:135], v[48:63]
    ds_read_b128 v[104:107], v15 offset:45056
    ds_read_b128 v[108:111], v15 offset:47104
    s_waitcnt lgkmcnt(4)
    v_mfma_f32_32x32x16_bf16 v[32:47], v[208:211], v[88:91], v[32:47]
    v_mfma_f32_32x32x16_bf16 v[48:63], v[208:211], v[92:95], v[48:63]
    ds_read_b128 v[112:115], v15 offset:46080
    ds_read_b128 v[116:119], v15 offset:48128
    s_waitcnt lgkmcnt(4)
    v_mfma_f32_32x32x16_bf16 v[32:47], v[212:215], v[96:99], v[32:47]
    v_mfma_f32_32x32x16_bf16 v[48:63], v[212:215], v[100:103], v[48:63]
    s_waitcnt vmcnt(4)
    s_barrier
    ds_read_b128 v[120:123], v14 offset:0
    ds_read_b128 v[124:127], v14 offset:2048
    s_waitcnt lgkmcnt(4)
    v_mfma_f32_32x32x16_bf16 v[32:47], v[240:243], v[104:107], v[32:47]
    v_mfma_f32_32x32x16_bf16 v[48:63], v[240:243], v[108:111], v[48:63]
    ds_read_b128 v[128:131], v14 offset:1024
    ds_read_b128 v[132:135], v14 offset:3072
    s_waitcnt lgkmcnt(4)
    v_mfma_f32_32x32x16_bf16 v[32:47], v[244:247], v[112:115], v[32:47]
    v_mfma_f32_32x32x16_bf16 v[48:63], v[244:247], v[116:119], v[48:63]
    ds_read_b128 v[88:91], v14 offset:4096
    ds_read_b128 v[92:95], v14 offset:6144
    s_waitcnt lgkmcnt(4)
    v_mfma_f32_32x32x16_bf16 v[32:47], v[152:155], v[120:123], v[32:47]
    v_mfma_f32_32x32x16_bf16 v[48:63], v[152:155], v[124:127], v[48:63]
    ds_read_b128 v[96:99], v14 offset:5120
    ds_read_b128 v[100:103], v14 offset:7168
    s_waitcnt lgkmcnt(4)
    v_mfma_f32_32x32x16_bf16 v[32:47], v[156:159], v[128:131], v[32:47]
    v_mfma_f32_32x32x16_bf16 v[48:63], v[156:159], v[132:135], v[48:63]
    ds_read_b128 v[104:107], v14 offset:8192
    ds_read_b128 v[108:111], v14 offset:10240
    s_waitcnt lgkmcnt(4)
    v_mfma_f32_32x32x16_bf16 v[32:47], v[184:187], v[88:91], v[32:47]
    v_mfma_f32_32x32x16_bf16 v[48:63], v[184:187], v[92:95], v[48:63]
    ds_read_b128 v[112:115], v14 offset:9216
    ds_read_b128 v[116:119], v14 offset:11264
    s_waitcnt lgkmcnt(4)
    v_mfma_f32_32x32x16_bf16 v[32:47], v[188:191], v[96:99], v[32:47]
    v_mfma_f32_32x32x16_bf16 v[48:63], v[188:191], v[100:103], v[48:63]
    ds_read_b128 v[120:123], v14 offset:12288
    ds_read_b128 v[124:127], v14 offset:14336
    s_waitcnt lgkmcnt(4)
    v_mfma_f32_32x32x16_bf16 v[32:47], v[216:219], v[104:107], v[32:47]
    v_mfma_f32_32x32x16_bf16 v[48:63], v[216:219], v[108:111], v[48:63]
    ds_read_b128 v[128:131], v14 offset:13312
    ds_read_b128 v[132:135], v14 offset:15360
    s_waitcnt lgkmcnt(4)
    v_mfma_f32_32x32x16_bf16 v[32:47], v[220:223], v[112:115], v[32:47]
    v_mfma_f32_32x32x16_bf16 v[48:63], v[220:223], v[116:119], v[48:63]
    s_waitcnt vmcnt(0)
    s_barrier
    ds_read_b128 v[88:91], v14 offset:32768
    ds_read_b128 v[92:95], v14 offset:33792
    s_waitcnt lgkmcnt(4)
    v_mfma_f32_32x32x16_bf16 v[32:47], v[248:251], v[120:123], v[32:47]
    v_mfma_f32_32x32x16_bf16 v[48:63], v[248:251], v[124:127], v[48:63]
    ds_read_b128 v[96:99], v14 offset:36864
    ds_read_b128 v[100:103], v14 offset:37888
    s_waitcnt lgkmcnt(4)
    v_mfma_f32_32x32x16_bf16 v[32:47], v[252:255], v[128:131], v[32:47]
    v_mfma_f32_32x32x16_bf16 v[48:63], v[252:255], v[132:135], v[48:63]
    ds_read_b128 v[104:107], v14 offset:40960
    ds_read_b128 v[108:111], v14 offset:41984
    s_waitcnt lgkmcnt(4)
    v_mfma_f32_32x32x16_bf16 v[32:47], v[160:163], v[88:91], v[32:47]
    v_mfma_f32_32x32x16_bf16 v[32:47], v[164:167], v[92:95], v[32:47]
    ds_read_b128 v[112:115], v14 offset:45056
    ds_read_b128 v[116:119], v14 offset:46080
    s_waitcnt lgkmcnt(4)
    v_mfma_f32_32x32x16_bf16 v[32:47], v[192:195], v[96:99], v[32:47]
    v_mfma_f32_32x32x16_bf16 v[32:47], v[196:199], v[100:103], v[32:47]
    ds_read_b128 v[120:123], v14 offset:34816
    ds_read_b128 v[124:127], v14 offset:35840
    s_waitcnt lgkmcnt(4)
    v_mfma_f32_32x32x16_bf16 v[32:47], v[224:227], v[104:107], v[32:47]
    v_mfma_f32_32x32x16_bf16 v[32:47], v[228:231], v[108:111], v[32:47]
    ds_read_b128 v[128:131], v14 offset:38912
    ds_read_b128 v[132:135], v14 offset:39936
    s_waitcnt lgkmcnt(4)
    v_mfma_f32_32x32x16_bf16 v[32:47], v[24:27], v[112:115], v[32:47]
    v_mfma_f32_32x32x16_bf16 v[32:47], v[28:31], v[116:119], v[32:47]
    ds_read_b128 v[88:91], v14 offset:43008
    ds_read_b128 v[92:95], v14 offset:44032
    s_waitcnt lgkmcnt(4)
    v_mfma_f32_32x32x16_bf16 v[48:63], v[160:163], v[120:123], v[48:63]
    v_mfma_f32_32x32x16_bf16 v[48:63], v[164:167], v[124:127], v[48:63]
    ds_read_b128 v[96:99], v14 offset:47104
    ds_read_b128 v[100:103], v14 offset:48128
    s_waitcnt lgkmcnt(4)
    v_mfma_f32_32x32x16_bf16 v[48:63], v[192:195], v[128:131], v[48:63]
    v_mfma_f32_32x32x16_bf16 v[48:63], v[196:199], v[132:135], v[48:63]
    s_waitcnt lgkmcnt(2)
    v_mfma_f32_32x32x16_bf16 v[48:63], v[224:227], v[88:91], v[48:63]
    ds_write_b128 v16, v[32:35] offset:0
    v_mfma_f32_32x32x16_bf16 v[48:63], v[228:231], v[92:95], v[48:63]
    ds_write_b128 v16, v[36:39] offset:1088
    s_waitcnt lgkmcnt(2)
    v_mfma_f32_32x32x16_bf16 v[48:63], v[24:27], v[96:99], v[48:63]
    ds_write_b128 v16, v[40:43] offset:2176
    v_mfma_f32_32x32x16_bf16 v[48:63], v[28:31], v[100:103], v[48:63]
    ds_write_b128 v16, v[44:47] offset:3264
    s_nop 10
    ds_write_b128 v16, v[48:51] offset:34816
    ds_write_b128 v16, v[52:55] offset:35904
    ds_write_b128 v16, v[56:59] offset:36992
    ds_write_b128 v16, v[60:63] offset:38080
    s_waitcnt lgkmcnt(0)
    s_barrier
    ds_read_b128 v[88:91], v84 offset:0
    ds_read_b128 v[92:95], v84 offset:4352
    ds_read_b128 v[96:99], v84 offset:8704
    ds_read_b128 v[100:103], v84 offset:13056
    ds_read_b128 v[104:107], v84 offset:17408
    ds_read_b128 v[108:111], v84 offset:21760
    ds_read_b128 v[112:115], v84 offset:26112
    ds_read_b128 v[116:119], v84 offset:30464
    s_waitcnt lgkmcnt(6)
    v_add_f32 v88, v88, v92
    v_add_f32 v89, v89, v93
    v_add_f32 v90, v90, v94
    v_add_f32 v91, v91, v95
    v_fma_f32 v64, v88, v80, v64
    v_fma_f32 v65, v89, v80, v65
    v_fma_f32 v66, v90, v80, v66
    v_fma_f32 v67, v91, v80, v67
    s_waitcnt lgkmcnt(4)
    v_add_f32 v96, v96, v100
    v_add_f32 v97, v97, v101
    v_add_f32 v98, v98, v102
    v_add_f32 v99, v99, v103
    v_fma_f32 v68, v96, v80, v68
    v_fma_f32 v69, v97, v80, v69
    v_fma_f32 v70, v98, v80, v70
    v_fma_f32 v71, v99, v80, v71
    v_cvt_pk_bf16_f32 v32, v64, v68
    v_cvt_pk_bf16_f32 v33, v65, v69
    v_cvt_pk_bf16_f32 v34, v66, v70
    v_cvt_pk_bf16_f32 v35, v67, v71
    buffer_store_dwordx4 v[32:35], v86, s[60:63], 0 offen nt
    s_waitcnt lgkmcnt(2)
    v_add_f32 v104, v104, v108
    v_add_f32 v105, v105, v109
    v_add_f32 v106, v106, v110
    v_add_f32 v107, v107, v111
    v_fma_f32 v72, v104, v80, v72
    v_fma_f32 v73, v105, v80, v73
    v_fma_f32 v74, v106, v80, v74
    v_fma_f32 v75, v107, v80, v75
    s_waitcnt lgkmcnt(0)
    v_add_f32 v112, v112, v116
    v_add_f32 v113, v113, v117
    v_add_f32 v114, v114, v118
    v_add_f32 v115, v115, v119
    v_fma_f32 v76, v112, v80, v76
    v_fma_f32 v77, v113, v80, v77
    v_fma_f32 v78, v114, v80, v78
    v_fma_f32 v79, v115, v80, v79
    v_cvt_pk_bf16_f32 v36, v75, v78
    v_cvt_pk_bf16_f32 v37, v74, v77
    v_cvt_pk_bf16_f32 v38, v73, v76
    v_cvt_pk_bf16_f32 v40, v79, v72
    buffer_store_dwordx3 v[36:38], v87, s[60:63], 0 offen offset:4 nt
    buffer_store_short v40, v87, s[60:63], 0 offen offset:2 nt
    buffer_store_short_d16_hi v40, v85, s[60:63], 0 offen offset:16 nt
    s_waitcnt vmcnt(0) lgkmcnt(0)
    s_waitcnt vmcnt(0)
L_end:
    s_endpgm
L_load:
    s_add_u32 s55, s4, s5
    s_and_b32 s55, s55, 2
    s_and_b32 s24, s5, 1
    s_add_u32 s55, s55, s24
    s_lshl_b32 s55, s55, 2
    s_bfe_u32 s24, s2, 0x20001
    s_add_u32 s55, s55, s24
    s_and_b32 s26, s3, 1
    s_lshl1_add_u32 s24, s4, s26
    s_lshl_b32 s28, s24, 18
    s_mul_i32 s29, s26, 49152
    s_add_u32 s29, s29, 65536
    s_mul_i32 s30, s26, 196608
    s_lshl_b32 s24, s5, 6
    s_add_u32 s30, s30, s24
    s_mul_i32 s33, s26, 6144
    v_lshrrev_b32 v14, 3, v1
    v_lshlrev_b32 v14, 11, v14
    v_and_b32 v15, 7, v1
    v_lshrrev_b32 v16, 4, v1
    v_xor_b32 v15, v15, v16
    v_lshlrev_b32 v15, 4, v15
    v_add_u32 v4, v14, v15
    v_xor_b32 v15, 64, v15
    v_add_u32 v14, v14, v15
    v_add_u32 v5, 15360, v14
    v_add_u32 v6, 30720, v4
    v_add_u32 v7, 46080, v14
    v_lshrrev_b32 v14, 2, v1
    v_mul_u32_u24 v14, 6144, v14
    v_and_b32 v15, 3, v1
    v_lshl_add_u32 v8, v15, 4, v14
    v_add_u32 v9, 1024, v8
    v_add_u32 v10, 2048, v8
    s_waitcnt lgkmcnt(0)
    s_add_u32 s31, s55, 0
    s_and_b32 s31, s31, 15
    s_mul_i32 s31, s31, 393216
    s_add_u32 s31, s31, s30
    s_add_u32 m0, s33, 0
    s_nop 0
    buffer_load_dwordx4 v8, s[12:15], s31 offen offset:0 lds
    buffer_load_dwordx4 v9, s[12:15], s31 offen offset:1024 lds
    buffer_load_dwordx4 v10, s[12:15], s31 offen offset:2048 lds
    s_add_u32 m0, s33, 3072
    s_add_u32 s31, s31, 98304
    buffer_load_dwordx4 v8, s[12:15], s31 offen offset:0 lds
    buffer_load_dwordx4 v9, s[12:15], s31 offen offset:1024 lds
    buffer_load_dwordx4 v10, s[12:15], s31 offen offset:2048 lds
    s_add_u32 s31, s55, 0
    s_and_b32 s31, s31, 15
    s_lshl_b32 s31, s31, 7
    s_add_u32 s31, s31, s28
    s_add_u32 m0, s29, 0
    s_nop 0
    buffer_load_dwordx4 v4, s[8:11], s31 offen offset:0 lds
    buffer_load_dwordx4 v5, s[8:11], s31 offen offset:1024 lds
    buffer_load_dwordx4 v6, s[8:11], s31 offen offset:2048 lds
    buffer_load_dwordx4 v7, s[8:11], s31 offen offset:3072 lds
    s_add_u32 m0, s29, 12288
    s_add_u32 s31, s31, 65536
    buffer_load_dwordx4 v4, s[8:11], s31 offen offset:0 lds
    buffer_load_dwordx4 v5, s[8:11], s31 offen offset:1024 lds
    buffer_load_dwordx4 v6, s[8:11], s31 offen offset:2048 lds
    buffer_load_dwordx4 v7, s[8:11], s31 offen offset:3072 lds
    s_add_u32 m0, s29, 24576
    s_add_u32 s31, s31, 65536
    buffer_load_dwordx4 v4, s[8:11], s31 offen offset:0 lds
    buffer_load_dwordx4 v5, s[8:11], s31 offen offset:1024 lds
    buffer_load_dwordx4 v6, s[8:11], s31 offen offset:2048 lds
    buffer_load_dwordx4 v7, s[8:11], s31 offen offset:3072 lds
    s_add_u32 m0, s29, 36864
    s_add_u32 s31, s31, 65536
    buffer_load_dwordx4 v4, s[8:11], s31 offen offset:0 lds
    buffer_load_dwordx4 v5, s[8:11], s31 offen offset:1024 lds
    buffer_load_dwordx4 v6, s[8:11], s31 offen offset:2048 lds
    buffer_load_dwordx4 v7, s[8:11], s31 offen offset:3072 lds
    s_add_u32 s31, s55, 1
    s_and_b32 s31, s31, 15
    s_mul_i32 s31, s31, 393216
    s_add_u32 s31, s31, s30
    s_add_u32 m0, s33, 12288
    s_nop 0
    buffer_load_dwordx4 v8, s[12:15], s31 offen offset:0 lds
    buffer_load_dwordx4 v9, s[12:15], s31 offen offset:1024 lds
    buffer_load_dwordx4 v10, s[12:15], s31 offen offset:2048 lds
    s_add_u32 m0, s33, 15360
    s_add_u32 s31, s31, 98304
    buffer_load_dwordx4 v8, s[12:15], s31 offen offset:0 lds
    buffer_load_dwordx4 v9, s[12:15], s31 offen offset:1024 lds
    buffer_load_dwordx4 v10, s[12:15], s31 offen offset:2048 lds
    s_add_u32 s31, s55, 1
    s_and_b32 s31, s31, 15
    s_lshl_b32 s31, s31, 7
    s_add_u32 s31, s31, s28
    s_add_u32 m0, s29, 4096
    s_nop 0
    buffer_load_dwordx4 v4, s[8:11], s31 offen offset:0 lds
    buffer_load_dwordx4 v5, s[8:11], s31 offen offset:1024 lds
    buffer_load_dwordx4 v6, s[8:11], s31 offen offset:2048 lds
    buffer_load_dwordx4 v7, s[8:11], s31 offen offset:3072 lds
    s_add_u32 m0, s29, 16384
    s_add_u32 s31, s31, 65536
    buffer_load_dwordx4 v4, s[8:11], s31 offen offset:0 lds
    buffer_load_dwordx4 v5, s[8:11], s31 offen offset:1024 lds
    buffer_load_dwordx4 v6, s[8:11], s31 offen offset:2048 lds
    buffer_load_dwordx4 v7, s[8:11], s31 offen offset:3072 lds
    s_add_u32 m0, s29, 28672
    s_add_u32 s31, s31, 65536
    buffer_load_dwordx4 v4, s[8:11], s31 offen offset:0 lds
    buffer_load_dwordx4 v5, s[8:11], s31 offen offset:1024 lds
    buffer_load_dwordx4 v6, s[8:11], s31 offen offset:2048 lds
    buffer_load_dwordx4 v7, s[8:11], s31 offen offset:3072 lds
    s_add_u32 m0, s29, 40960
    s_add_u32 s31, s31, 65536
    buffer_load_dwordx4 v4, s[8:11], s31 offen offset:0 lds
    buffer_load_dwordx4 v5, s[8:11], s31 offen offset:1024 lds
    buffer_load_dwordx4 v6, s[8:11], s31 offen offset:2048 lds
    buffer_load_dwordx4 v7, s[8:11], s31 offen offset:3072 lds
    s_mul_i32 s32, s3, 12288
    s_add_u32 s32, s32, 65536
    s_lshr_b32 s64, s5, 3
    s_and_b32 s65, s5, 7
    s_and_b32 s66, s3, 3
    s_lshr_b32 s67, s3, 2
    s_lshl1_add_u32 s24, s4, s67
    s_lshl_b32 s24, s24, 6
    s_and_b32 s25, s64, 1
    s_add_u32 s69, s24, s25
    v_mov_b32 v14, 0x40000000
    v_cmp_eq_u32 vcc, 63, v1
    s_nop 1
    v_cndmask_b32_e64 v21, v14, 0, vcc
    s_waitcnt vmcnt(22)
    s_barrier
    s_add_u32 s31, s55, 2
    s_and_b32 s31, s31, 15
    s_lshl_b32 s31, s31, 7
    s_add_u32 s31, s31, s28
    s_add_u32 m0, s29, 8192
    s_nop 0
    buffer_load_dwordx4 v4, s[8:11], s31 offen offset:0 lds
    buffer_load_dwordx4 v5, s[8:11], s31 offen offset:1024 lds
    buffer_load_dwordx4 v6, s[8:11], s31 offen offset:2048 lds
    buffer_load_dwordx4 v7, s[8:11], s31 offen offset:3072 lds
    s_add_u32 m0, s29, 20480
    s_add_u32 s31, s31, 65536
    buffer_load_dwordx4 v4, s[8:11], s31 offen offset:0 lds
    buffer_load_dwordx4 v5, s[8:11], s31 offen offset:1024 lds
    buffer_load_dwordx4 v6, s[8:11], s31 offen offset:2048 lds
    buffer_load_dwordx4 v7, s[8:11], s31 offen offset:3072 lds
    s_add_u32 m0, s29, 32768
    s_add_u32 s31, s31, 65536
    buffer_load_dwordx4 v4, s[8:11], s31 offen offset:0 lds
    buffer_load_dwordx4 v5, s[8:11], s31 offen offset:1024 lds
    buffer_load_dwordx4 v6, s[8:11], s31 offen offset:2048 lds
    buffer_load_dwordx4 v7, s[8:11], s31 offen offset:3072 lds
    s_add_u32 m0, s29, 45056
    s_add_u32 s31, s31, 65536
    buffer_load_dwordx4 v4, s[8:11], s31 offen offset:0 lds
    buffer_load_dwordx4 v5, s[8:11], s31 offen offset:1024 lds
    buffer_load_dwordx4 v6, s[8:11], s31 offen offset:2048 lds
    buffer_load_dwordx4 v7, s[8:11], s31 offen offset:3072 lds
    s_add_u32 s31, s55, 2
    s_and_b32 s31, s31, 15
    s_mul_i32 s31, s31, 393216
    s_add_u32 s31, s31, s30
    s_add_u32 m0, s33, 24576
    s_nop 0
    buffer_load_dwordx4 v8, s[12:15], s31 offen offset:0 lds
    buffer_load_dwordx4 v9, s[12:15], s31 offen offset:1024 lds
    buffer_load_dwordx4 v10, s[12:15], s31 offen offset:2048 lds
    s_add_u32 m0, s33, 27648
    s_add_u32 s31, s31, 98304
    buffer_load_dwordx4 v8, s[12:15], s31 offen offset:0 lds
    buffer_load_dwordx4 v9, s[12:15], s31 offen offset:1024 lds
    buffer_load_dwordx4 v10, s[12:15], s31 offen offset:2048 lds
    s_add_u32 s31, s55, 3
    s_and_b32 s31, s31, 15
    s_mul_i32 s31, s31, 393216
    s_add_u32 s31, s31, s30
    s_add_u32 m0, s33, 36864
    s_nop 0
    buffer_load_dwordx4 v8, s[12:15], s31 offen offset:0 lds
    buffer_load_dwordx4 v9, s[12:15], s31 offen offset:1024 lds
    buffer_load_dwordx4 v10, s[12:15], s31 offen offset:2048 lds
    s_add_u32 m0, s33, 39936
    s_add_u32 s31, s31, 98304
    buffer_load_dwordx4 v8, s[12:15], s31 offen offset:0 lds
    buffer_load_dwordx4 v9, s[12:15], s31 offen offset:1024 lds
    buffer_load_dwordx4 v10, s[12:15], s31 offen offset:2048 lds
    s_waitcnt vmcnt(28)
    s_barrier
    s_add_u32 s31, s55, 3
    s_and_b32 s31, s31, 15
    s_lshl_b32 s31, s31, 7
    s_add_u32 s31, s31, s28
    s_add_u32 m0, s29, 0
    s_nop 0
    buffer_load_dwordx4 v4, s[8:11], s31 offen offset:0 lds
    buffer_load_dwordx4 v5, s[8:11], s31 offen offset:1024 lds
    buffer_load_dwordx4 v6, s[8:11], s31 offen offset:2048 lds
    buffer_load_dwordx4 v7, s[8:11], s31 offen offset:3072 lds
    s_add_u32 m0, s29, 12288
    s_add_u32 s31, s31, 65536
    buffer_load_dwordx4 v4, s[8:11], s31 offen offset:0 lds
    buffer_load_dwordx4 v5, s[8:11], s31 offen offset:1024 lds
    buffer_load_dwordx4 v6, s[8:11], s31 offen offset:2048 lds
    buffer_load_dwordx4 v7, s[8:11], s31 offen offset:3072 lds
    s_add_u32 m0, s29, 24576
    s_add_u32 s31, s31, 65536
    buffer_load_dwordx4 v4, s[8:11], s31 offen offset:0 lds
    buffer_load_dwordx4 v5, s[8:11], s31 offen offset:1024 lds
    buffer_load_dwordx4 v6, s[8:11], s31 offen offset:2048 lds
    buffer_load_dwordx4 v7, s[8:11], s31 offen offset:3072 lds
    s_add_u32 m0, s29, 36864
    s_add_u32 s31, s31, 65536
    buffer_load_dwordx4 v4, s[8:11], s31 offen offset:0 lds
    buffer_load_dwordx4 v5, s[8:11], s31 offen offset:1024 lds
    buffer_load_dwordx4 v6, s[8:11], s31 offen offset:2048 lds
    buffer_load_dwordx4 v7, s[8:11], s31 offen offset:3072 lds
    s_add_u32 s31, s55, 4
    s_and_b32 s31, s31, 15
    s_mul_i32 s31, s31, 393216
    s_add_u32 s31, s31, s30
    s_add_u32 m0, s33, 49152
    s_nop 0
    buffer_load_dwordx4 v8, s[12:15], s31 offen offset:0 lds
    buffer_load_dwordx4 v9, s[12:15], s31 offen offset:1024 lds
    buffer_load_dwordx4 v10, s[12:15], s31 offen offset:2048 lds
    s_add_u32 m0, s33, 52224
    s_add_u32 s31, s31, 98304
    buffer_load_dwordx4 v8, s[12:15], s31 offen offset:0 lds
    buffer_load_dwordx4 v9, s[12:15], s31 offen offset:1024 lds
    buffer_load_dwordx4 v10, s[12:15], s31 offen offset:2048 lds
    s_add_u32 s31, s55, 5
    s_and_b32 s31, s31, 15
    s_mul_i32 s31, s31, 393216
    s_add_u32 s31, s31, s30
    s_add_u32 m0, s33, 0
    s_nop 0
    buffer_load_dwordx4 v8, s[12:15], s31 offen offset:0 lds
    buffer_load_dwordx4 v9, s[12:15], s31 offen offset:1024 lds
    buffer_load_dwordx4 v10, s[12:15], s31 offen offset:2048 lds
    s_add_u32 m0, s33, 3072
    s_add_u32 s31, s31, 98304
    buffer_load_dwordx4 v8, s[12:15], s31 offen offset:0 lds
    buffer_load_dwordx4 v9, s[12:15], s31 offen offset:1024 lds
    buffer_load_dwordx4 v10, s[12:15], s31 offen offset:2048 lds
    s_waitcnt vmcnt(34)
    s_barrier
    s_add_u32 s31, s55, 4
    s_and_b32 s31, s31, 15
    s_lshl_b32 s31, s31, 7
    s_add_u32 s31, s31, s28
    s_add_u32 m0, s29, 4096
    s_nop 0
    buffer_load_dwordx4 v4, s[8:11], s31 offen offset:0 lds
    buffer_load_dwordx4 v5, s[8:11], s31 offen offset:1024 lds
    buffer_load_dwordx4 v6, s[8:11], s31 offen offset:2048 lds
    buffer_load_dwordx4 v7, s[8:11], s31 offen offset:3072 lds
    s_add_u32 m0, s29, 16384
    s_add_u32 s31, s31, 65536
    buffer_load_dwordx4 v4, s[8:11], s31 offen offset:0 lds
    buffer_load_dwordx4 v5, s[8:11], s31 offen offset:1024 lds
    buffer_load_dwordx4 v6, s[8:11], s31 offen offset:2048 lds
    buffer_load_dwordx4 v7, s[8:11], s31 offen offset:3072 lds
    s_add_u32 m0, s29, 28672
    s_add_u32 s31, s31, 65536
    buffer_load_dwordx4 v4, s[8:11], s31 offen offset:0 lds
    buffer_load_dwordx4 v5, s[8:11], s31 offen offset:1024 lds
    buffer_load_dwordx4 v6, s[8:11], s31 offen offset:2048 lds
    buffer_load_dwordx4 v7, s[8:11], s31 offen offset:3072 lds
    s_add_u32 m0, s29, 40960
    s_add_u32 s31, s31, 65536
    buffer_load_dwordx4 v4, s[8:11], s31 offen offset:0 lds
    buffer_load_dwordx4 v5, s[8:11], s31 offen offset:1024 lds
    buffer_load_dwordx4 v6, s[8:11], s31 offen offset:2048 lds
    buffer_load_dwordx4 v7, s[8:11], s31 offen offset:3072 lds
    s_add_u32 s31, s55, 6
    s_and_b32 s31, s31, 15
    s_mul_i32 s31, s31, 393216
    s_add_u32 s31, s31, s30
    s_add_u32 m0, s33, 12288
    s_nop 0
    buffer_load_dwordx4 v8, s[12:15], s31 offen offset:0 lds
    buffer_load_dwordx4 v9, s[12:15], s31 offen offset:1024 lds
    buffer_load_dwordx4 v10, s[12:15], s31 offen offset:2048 lds
    s_add_u32 m0, s33, 15360
    s_add_u32 s31, s31, 98304
    buffer_load_dwordx4 v8, s[12:15], s31 offen offset:0 lds
    buffer_load_dwordx4 v9, s[12:15], s31 offen offset:1024 lds
    buffer_load_dwordx4 v10, s[12:15], s31 offen offset:2048 lds
    s_waitcnt vmcnt(34)
    s_barrier
    s_add_u32 s31, s55, 5
    s_and_b32 s31, s31, 15
    s_lshl_b32 s31, s31, 7
    s_add_u32 s31, s31, s28
    s_add_u32 m0, s29, 8192
    s_nop 0
    buffer_load_dwordx4 v4, s[8:11], s31 offen offset:0 lds
    buffer_load_dwordx4 v5, s[8:11], s31 offen offset:1024 lds
    buffer_load_dwordx4 v6, s[8:11], s31 offen offset:2048 lds
    buffer_load_dwordx4 v7, s[8:11], s31 offen offset:3072 lds
    s_add_u32 m0, s29, 20480
    s_add_u32 s31, s31, 65536
    buffer_load_dwordx4 v4, s[8:11], s31 offen offset:0 lds
    buffer_load_dwordx4 v5, s[8:11], s31 offen offset:1024 lds
    buffer_load_dwordx4 v6, s[8:11], s31 offen offset:2048 lds
    buffer_load_dwordx4 v7, s[8:11], s31 offen offset:3072 lds
    s_add_u32 m0, s29, 32768
    s_add_u32 s31, s31, 65536
    buffer_load_dwordx4 v4, s[8:11], s31 offen offset:0 lds
    buffer_load_dwordx4 v5, s[8:11], s31 offen offset:1024 lds
    buffer_load_dwordx4 v6, s[8:11], s31 offen offset:2048 lds
    buffer_load_dwordx4 v7, s[8:11], s31 offen offset:3072 lds
    s_add_u32 m0, s29, 45056
    s_add_u32 s31, s31, 65536
    buffer_load_dwordx4 v4, s[8:11], s31 offen offset:0 lds
    buffer_load_dwordx4 v5, s[8:11], s31 offen offset:1024 lds
    buffer_load_dwordx4 v6, s[8:11], s31 offen offset:2048 lds
    buffer_load_dwordx4 v7, s[8:11], s31 offen offset:3072 lds
    s_add_u32 s31, s55, 7
    s_and_b32 s31, s31, 15
    s_mul_i32 s31, s31, 393216
    s_add_u32 s31, s31, s30
    s_add_u32 m0, s33, 24576
    s_nop 0
    buffer_load_dwordx4 v8, s[12:15], s31 offen offset:0 lds
    buffer_load_dwordx4 v9, s[12:15], s31 offen offset:1024 lds
    buffer_load_dwordx4 v10, s[12:15], s31 offen offset:2048 lds
    s_add_u32 m0, s33, 27648
    s_add_u32 s31, s31, 98304
    buffer_load_dwordx4 v8, s[12:15], s31 offen offset:0 lds
    buffer_load_dwordx4 v9, s[12:15], s31 offen offset:1024 lds
    buffer_load_dwordx4 v10, s[12:15], s31 offen offset:2048 lds
    s_waitcnt vmcnt(28)
    s_barrier
    s_add_u32 s31, s55, 6
    s_and_b32 s31, s31, 15
    s_lshl_b32 s31, s31, 7
    s_add_u32 s31, s31, s28
    s_add_u32 m0, s29, 0
    s_nop 0
    buffer_load_dwordx4 v4, s[8:11], s31 offen offset:0 lds
    buffer_load_dwordx4 v5, s[8:11], s31 offen offset:1024 lds
    buffer_load_dwordx4 v6, s[8:11], s31 offen offset:2048 lds
    buffer_load_dwordx4 v7, s[8:11], s31 offen offset:3072 lds
    s_add_u32 m0, s29, 12288
    s_add_u32 s31, s31, 65536
    buffer_load_dwordx4 v4, s[8:11], s31 offen offset:0 lds
    buffer_load_dwordx4 v5, s[8:11], s31 offen offset:1024 lds
    buffer_load_dwordx4 v6, s[8:11], s31 offen offset:2048 lds
    buffer_load_dwordx4 v7, s[8:11], s31 offen offset:3072 lds
    s_add_u32 m0, s29, 24576
    s_add_u32 s31, s31, 65536
    buffer_load_dwordx4 v4, s[8:11], s31 offen offset:0 lds
    buffer_load_dwordx4 v5, s[8:11], s31 offen offset:1024 lds
    buffer_load_dwordx4 v6, s[8:11], s31 offen offset:2048 lds
    buffer_load_dwordx4 v7, s[8:11], s31 offen offset:3072 lds
    s_add_u32 m0, s29, 36864
    s_add_u32 s31, s31, 65536
    buffer_load_dwordx4 v4, s[8:11], s31 offen offset:0 lds
    buffer_load_dwordx4 v5, s[8:11], s31 offen offset:1024 lds
    buffer_load_dwordx4 v6, s[8:11], s31 offen offset:2048 lds
    buffer_load_dwordx4 v7, s[8:11], s31 offen offset:3072 lds
    s_add_u32 s31, s55, 8
    s_and_b32 s31, s31, 15
    s_mul_i32 s31, s31, 393216
    s_add_u32 s31, s31, s30
    s_add_u32 m0, s33, 36864
    s_nop 0
    buffer_load_dwordx4 v8, s[12:15], s31 offen offset:0 lds
    buffer_load_dwordx4 v9, s[12:15], s31 offen offset:1024 lds
    buffer_load_dwordx4 v10, s[12:15], s31 offen offset:2048 lds
    s_add_u32 m0, s33, 39936
    s_add_u32 s31, s31, 98304
    buffer_load_dwordx4 v8, s[12:15], s31 offen offset:0 lds
    buffer_load_dwordx4 v9, s[12:15], s31 offen offset:1024 lds
    buffer_load_dwordx4 v10, s[12:15], s31 offen offset:2048 lds
    s_waitcnt vmcnt(28)
    s_barrier
    s_add_u32 s31, s55, 7
    s_and_b32 s31, s31, 15
    s_lshl_b32 s31, s31, 7
    s_add_u32 s31, s31, s28
    s_add_u32 m0, s29, 4096
    s_nop 0
    buffer_load_dwordx4 v4, s[8:11], s31 offen offset:0 lds
    buffer_load_dwordx4 v5, s[8:11], s31 offen offset:1024 lds
    buffer_load_dwordx4 v6, s[8:11], s31 offen offset:2048 lds
    buffer_load_dwordx4 v7, s[8:11], s31 offen offset:3072 lds
    s_add_u32 m0, s29, 16384
    s_add_u32 s31, s31, 65536
    buffer_load_dwordx4 v4, s[8:11], s31 offen offset:0 lds
    buffer_load_dwordx4 v5, s[8:11], s31 offen offset:1024 lds
    buffer_load_dwordx4 v6, s[8:11], s31 offen offset:2048 lds
    buffer_load_dwordx4 v7, s[8:11], s31 offen offset:3072 lds
    s_add_u32 m0, s29, 28672
    s_add_u32 s31, s31, 65536
    buffer_load_dwordx4 v4, s[8:11], s31 offen offset:0 lds
    buffer_load_dwordx4 v5, s[8:11], s31 offen offset:1024 lds
    buffer_load_dwordx4 v6, s[8:11], s31 offen offset:2048 lds
    buffer_load_dwordx4 v7, s[8:11], s31 offen offset:3072 lds
    s_add_u32 m0, s29, 40960
    s_add_u32 s31, s31, 65536
    buffer_load_dwordx4 v4, s[8:11], s31 offen offset:0 lds
    buffer_load_dwordx4 v5, s[8:11], s31 offen offset:1024 lds
    buffer_load_dwordx4 v6, s[8:11], s31 offen offset:2048 lds
    buffer_load_dwordx4 v7, s[8:11], s31 offen offset:3072 lds
    s_add_u32 s31, s55, 9
    s_and_b32 s31, s31, 15
    s_mul_i32 s31, s31, 393216
    s_add_u32 s31, s31, s30
    s_add_u32 m0, s33, 49152
    s_nop 0
    buffer_load_dwordx4 v8, s[12:15], s31 offen offset:0 lds
    buffer_load_dwordx4 v9, s[12:15], s31 offen offset:1024 lds
    buffer_load_dwordx4 v10, s[12:15], s31 offen offset:2048 lds
    s_add_u32 m0, s33, 52224
    s_add_u32 s31, s31, 98304
    buffer_load_dwordx4 v8, s[12:15], s31 offen offset:0 lds
    buffer_load_dwordx4 v9, s[12:15], s31 offen offset:1024 lds
    buffer_load_dwordx4 v10, s[12:15], s31 offen offset:2048 lds
    s_waitcnt vmcnt(28)
    s_barrier
    s_add_u32 s31, s55, 8
    s_and_b32 s31, s31, 15
    s_lshl_b32 s31, s31, 7
    s_add_u32 s31, s31, s28
    s_add_u32 m0, s29, 8192
    s_nop 0
    buffer_load_dwordx4 v4, s[8:11], s31 offen offset:0 lds
    buffer_load_dwordx4 v5, s[8:11], s31 offen offset:1024 lds
    buffer_load_dwordx4 v6, s[8:11], s31 offen offset:2048 lds
    buffer_load_dwordx4 v7, s[8:11], s31 offen offset:3072 lds
    s_add_u32 m0, s29, 20480
    s_add_u32 s31, s31, 65536
    buffer_load_dwordx4 v4, s[8:11], s31 offen offset:0 lds
    buffer_load_dwordx4 v5, s[8:11], s31 offen offset:1024 lds
    buffer_load_dwordx4 v6, s[8:11], s31 offen offset:2048 lds
    buffer_load_dwordx4 v7, s[8:11], s31 offen offset:3072 lds
    s_add_u32 m0, s29, 32768
    s_add_u32 s31, s31, 65536
    buffer_load_dwordx4 v4, s[8:11], s31 offen offset:0 lds
    buffer_load_dwordx4 v5, s[8:11], s31 offen offset:1024 lds
    buffer_load_dwordx4 v6, s[8:11], s31 offen offset:2048 lds
    buffer_load_dwordx4 v7, s[8:11], s31 offen offset:3072 lds
    s_add_u32 m0, s29, 45056
    s_add_u32 s31, s31, 65536
    buffer_load_dwordx4 v4, s[8:11], s31 offen offset:0 lds
    buffer_load_dwordx4 v5, s[8:11], s31 offen offset:1024 lds
    buffer_load_dwordx4 v6, s[8:11], s31 offen offset:2048 lds
    buffer_load_dwordx4 v7, s[8:11], s31 offen offset:3072 lds
    s_add_u32 s31, s55, 10
    s_and_b32 s31, s31, 15
    s_mul_i32 s31, s31, 393216
    s_add_u32 s31, s31, s30
    s_add_u32 m0, s33, 0
    s_nop 0
    buffer_load_dwordx4 v8, s[12:15], s31 offen offset:0 lds
    buffer_load_dwordx4 v9, s[12:15], s31 offen offset:1024 lds
    buffer_load_dwordx4 v10, s[12:15], s31 offen offset:2048 lds
    s_add_u32 m0, s33, 3072
    s_add_u32 s31, s31, 98304
    buffer_load_dwordx4 v8, s[12:15], s31 offen offset:0 lds
    buffer_load_dwordx4 v9, s[12:15], s31 offen offset:1024 lds
    buffer_load_dwordx4 v10, s[12:15], s31 offen offset:2048 lds
    s_waitcnt vmcnt(28)
    s_barrier
    s_add_u32 s31, s55, 9
    s_and_b32 s31, s31, 15
    s_lshl_b32 s31, s31, 7
    s_add_u32 s31, s31, s28
    s_add_u32 m0, s29, 0
    s_nop 0
    buffer_load_dwordx4 v4, s[8:11], s31 offen offset:0 lds
    buffer_load_dwordx4 v5, s[8:11], s31 offen offset:1024 lds
    buffer_load_dwordx4 v6, s[8:11], s31 offen offset:2048 lds
    buffer_load_dwordx4 v7, s[8:11], s31 offen offset:3072 lds
    s_add_u32 m0, s29, 12288
    s_add_u32 s31, s31, 65536
    buffer_load_dwordx4 v4, s[8:11], s31 offen offset:0 lds
    buffer_load_dwordx4 v5, s[8:11], s31 offen offset:1024 lds
    buffer_load_dwordx4 v6, s[8:11], s31 offen offset:2048 lds
    buffer_load_dwordx4 v7, s[8:11], s31 offen offset:3072 lds
    s_add_u32 m0, s29, 24576
    s_add_u32 s31, s31, 65536
    buffer_load_dwordx4 v4, s[8:11], s31 offen offset:0 lds
    buffer_load_dwordx4 v5, s[8:11], s31 offen offset:1024 lds
    buffer_load_dwordx4 v6, s[8:11], s31 offen offset:2048 lds
    buffer_load_dwordx4 v7, s[8:11], s31 offen offset:3072 lds
    s_add_u32 m0, s29, 36864
    s_add_u32 s31, s31, 65536
    buffer_load_dwordx4 v4, s[8:11], s31 offen offset:0 lds
    buffer_load_dwordx4 v5, s[8:11], s31 offen offset:1024 lds
    buffer_load_dwordx4 v6, s[8:11], s31 offen offset:2048 lds
    buffer_load_dwordx4 v7, s[8:11], s31 offen offset:3072 lds
    s_add_u32 s31, s55, 11
    s_and_b32 s31, s31, 15
    s_mul_i32 s31, s31, 393216
    s_add_u32 s31, s31, s30
    s_add_u32 m0, s33, 12288
    s_nop 0
    buffer_load_dwordx4 v8, s[12:15], s31 offen offset:0 lds
    buffer_load_dwordx4 v9, s[12:15], s31 offen offset:1024 lds
    buffer_load_dwordx4 v10, s[12:15], s31 offen offset:2048 lds
    s_add_u32 m0, s33, 15360
    s_add_u32 s31, s31, 98304
    buffer_load_dwordx4 v8, s[12:15], s31 offen offset:0 lds
    buffer_load_dwordx4 v9, s[12:15], s31 offen offset:1024 lds
    buffer_load_dwordx4 v10, s[12:15], s31 offen offset:2048 lds
    s_waitcnt vmcnt(28)
    s_barrier
    s_add_u32 s31, s55, 10
    s_and_b32 s31, s31, 15
    s_lshl_b32 s31, s31, 7
    s_add_u32 s31, s31, s28
    s_add_u32 m0, s29, 4096
    s_nop 0
    buffer_load_dwordx4 v4, s[8:11], s31 offen offset:0 lds
    buffer_load_dwordx4 v5, s[8:11], s31 offen offset:1024 lds
    buffer_load_dwordx4 v6, s[8:11], s31 offen offset:2048 lds
    buffer_load_dwordx4 v7, s[8:11], s31 offen offset:3072 lds
    s_add_u32 m0, s29, 16384
    s_add_u32 s31, s31, 65536
    buffer_load_dwordx4 v4, s[8:11], s31 offen offset:0 lds
    buffer_load_dwordx4 v5, s[8:11], s31 offen offset:1024 lds
    buffer_load_dwordx4 v6, s[8:11], s31 offen offset:2048 lds
    buffer_load_dwordx4 v7, s[8:11], s31 offen offset:3072 lds
    s_add_u32 m0, s29, 28672
    s_add_u32 s31, s31, 65536
    buffer_load_dwordx4 v4, s[8:11], s31 offen offset:0 lds
    buffer_load_dwordx4 v5, s[8:11], s31 offen offset:1024 lds
    buffer_load_dwordx4 v6, s[8:11], s31 offen offset:2048 lds
    buffer_load_dwordx4 v7, s[8:11], s31 offen offset:3072 lds
    s_add_u32 m0, s29, 40960
    s_add_u32 s31, s31, 65536
    buffer_load_dwordx4 v4, s[8:11], s31 offen offset:0 lds
    buffer_load_dwordx4 v5, s[8:11], s31 offen offset:1024 lds
    buffer_load_dwordx4 v6, s[8:11], s31 offen offset:2048 lds
    buffer_load_dwordx4 v7, s[8:11], s31 offen offset:3072 lds
    s_add_u32 s31, s55, 12
    s_and_b32 s31, s31, 15
    s_mul_i32 s31, s31, 393216
    s_add_u32 s31, s31, s30
    s_add_u32 m0, s33, 24576
    s_nop 0
    buffer_load_dwordx4 v8, s[12:15], s31 offen offset:0 lds
    buffer_load_dwordx4 v9, s[12:15], s31 offen offset:1024 lds
    buffer_load_dwordx4 v10, s[12:15], s31 offen offset:2048 lds
    s_add_u32 m0, s33, 27648
    s_add_u32 s31, s31, 98304
    buffer_load_dwordx4 v8, s[12:15], s31 offen offset:0 lds
    buffer_load_dwordx4 v9, s[12:15], s31 offen offset:1024 lds
    buffer_load_dwordx4 v10, s[12:15], s31 offen offset:2048 lds
    s_waitcnt vmcnt(28)
    s_barrier
    s_add_u32 s31, s55, 11
    s_and_b32 s31, s31, 15
    s_lshl_b32 s31, s31, 7
    s_add_u32 s31, s31, s28
    s_add_u32 m0, s29, 8192
    s_nop 0
    buffer_load_dwordx4 v4, s[8:11], s31 offen offset:0 lds
    buffer_load_dwordx4 v5, s[8:11], s31 offen offset:1024 lds
    buffer_load_dwordx4 v6, s[8:11], s31 offen offset:2048 lds
    buffer_load_dwordx4 v7, s[8:11], s31 offen offset:3072 lds
    s_add_u32 m0, s29, 20480
    s_add_u32 s31, s31, 65536
    buffer_load_dwordx4 v4, s[8:11], s31 offen offset:0 lds
    buffer_load_dwordx4 v5, s[8:11], s31 offen offset:1024 lds
    buffer_load_dwordx4 v6, s[8:11], s31 offen offset:2048 lds
    buffer_load_dwordx4 v7, s[8:11], s31 offen offset:3072 lds
    s_add_u32 m0, s29, 32768
    s_add_u32 s31, s31, 65536
    buffer_load_dwordx4 v4, s[8:11], s31 offen offset:0 lds
    buffer_load_dwordx4 v5, s[8:11], s31 offen offset:1024 lds
    buffer_load_dwordx4 v6, s[8:11], s31 offen offset:2048 lds
    buffer_load_dwordx4 v7, s[8:11], s31 offen offset:3072 lds
    s_add_u32 m0, s29, 45056
    s_add_u32 s31, s31, 65536
    buffer_load_dwordx4 v4, s[8:11], s31 offen offset:0 lds
    buffer_load_dwordx4 v5, s[8:11], s31 offen offset:1024 lds
    buffer_load_dwordx4 v6, s[8:11], s31 offen offset:2048 lds
    buffer_load_dwordx4 v7, s[8:11], s31 offen offset:3072 lds
    s_add_u32 s31, s55, 13
    s_and_b32 s31, s31, 15
    s_mul_i32 s31, s31, 393216
    s_add_u32 s31, s31, s30
    s_add_u32 m0, s33, 36864
    s_nop 0
    buffer_load_dwordx4 v8, s[12:15], s31 offen offset:0 lds
    buffer_load_dwordx4 v9, s[12:15], s31 offen offset:1024 lds
    buffer_load_dwordx4 v10, s[12:15], s31 offen offset:2048 lds
    s_add_u32 m0, s33, 39936
    s_add_u32 s31, s31, 98304
    buffer_load_dwordx4 v8, s[12:15], s31 offen offset:0 lds
    buffer_load_dwordx4 v9, s[12:15], s31 offen offset:1024 lds
    buffer_load_dwordx4 v10, s[12:15], s31 offen offset:2048 lds
    s_waitcnt vmcnt(28)
    s_barrier
    s_add_u32 s31, s55, 12
    s_and_b32 s31, s31, 15
    s_lshl_b32 s31, s31, 7
    s_add_u32 s31, s31, s28
    s_add_u32 m0, s29, 0
    s_nop 0
    buffer_load_dwordx4 v4, s[8:11], s31 offen offset:0 lds
    buffer_load_dwordx4 v5, s[8:11], s31 offen offset:1024 lds
    buffer_load_dwordx4 v6, s[8:11], s31 offen offset:2048 lds
    buffer_load_dwordx4 v7, s[8:11], s31 offen offset:3072 lds
    s_add_u32 m0, s29, 12288
    s_add_u32 s31, s31, 65536
    buffer_load_dwordx4 v4, s[8:11], s31 offen offset:0 lds
    buffer_load_dwordx4 v5, s[8:11], s31 offen offset:1024 lds
    buffer_load_dwordx4 v6, s[8:11], s31 offen offset:2048 lds
    buffer_load_dwordx4 v7, s[8:11], s31 offen offset:3072 lds
    s_add_u32 m0, s29, 24576
    s_add_u32 s31, s31, 65536
    buffer_load_dwordx4 v4, s[8:11], s31 offen offset:0 lds
    buffer_load_dwordx4 v5, s[8:11], s31 offen offset:1024 lds
    buffer_load_dwordx4 v6, s[8:11], s31 offen offset:2048 lds
    buffer_load_dwordx4 v7, s[8:11], s31 offen offset:3072 lds
    s_add_u32 m0, s29, 36864
    s_add_u32 s31, s31, 65536
    buffer_load_dwordx4 v4, s[8:11], s31 offen offset:0 lds
    buffer_load_dwordx4 v5, s[8:11], s31 offen offset:1024 lds
    buffer_load_dwordx4 v6, s[8:11], s31 offen offset:2048 lds
    buffer_load_dwordx4 v7, s[8:11], s31 offen offset:3072 lds
    s_add_u32 s31, s55, 14
    s_and_b32 s31, s31, 15
    s_mul_i32 s31, s31, 393216
    s_add_u32 s31, s31, s30
    s_add_u32 m0, s33, 49152
    s_nop 0
    buffer_load_dwordx4 v8, s[12:15], s31 offen offset:0 lds
    buffer_load_dwordx4 v9, s[12:15], s31 offen offset:1024 lds
    buffer_load_dwordx4 v10, s[12:15], s31 offen offset:2048 lds
    s_add_u32 m0, s33, 52224
    s_add_u32 s31, s31, 98304
    buffer_load_dwordx4 v8, s[12:15], s31 offen offset:0 lds
    buffer_load_dwordx4 v9, s[12:15], s31 offen offset:1024 lds
    buffer_load_dwordx4 v10, s[12:15], s31 offen offset:2048 lds
    s_waitcnt vmcnt(28)
    s_barrier
    s_add_u32 s31, s55, 13
    s_and_b32 s31, s31, 15
    s_lshl_b32 s31, s31, 7
    s_add_u32 s31, s31, s28
    s_add_u32 m0, s29, 4096
    s_nop 0
    buffer_load_dwordx4 v4, s[8:11], s31 offen offset:0 lds
    buffer_load_dwordx4 v5, s[8:11], s31 offen offset:1024 lds
    buffer_load_dwordx4 v6, s[8:11], s31 offen offset:2048 lds
    buffer_load_dwordx4 v7, s[8:11], s31 offen offset:3072 lds
    s_add_u32 m0, s29, 16384
    s_add_u32 s31, s31, 65536
    buffer_load_dwordx4 v4, s[8:11], s31 offen offset:0 lds
    buffer_load_dwordx4 v5, s[8:11], s31 offen offset:1024 lds
    buffer_load_dwordx4 v6, s[8:11], s31 offen offset:2048 lds
    buffer_load_dwordx4 v7, s[8:11], s31 offen offset:3072 lds
    s_add_u32 m0, s29, 28672
    s_add_u32 s31, s31, 65536
    buffer_load_dwordx4 v4, s[8:11], s31 offen offset:0 lds
    buffer_load_dwordx4 v5, s[8:11], s31 offen offset:1024 lds
    buffer_load_dwordx4 v6, s[8:11], s31 offen offset:2048 lds
    buffer_load_dwordx4 v7, s[8:11], s31 offen offset:3072 lds
    s_add_u32 m0, s29, 40960
    s_add_u32 s31, s31, 65536
    buffer_load_dwordx4 v4, s[8:11], s31 offen offset:0 lds
    buffer_load_dwordx4 v5, s[8:11], s31 offen offset:1024 lds
    buffer_load_dwordx4 v6, s[8:11], s31 offen offset:2048 lds
    buffer_load_dwordx4 v7, s[8:11], s31 offen offset:3072 lds
    s_add_u32 s31, s55, 15
    s_and_b32 s31, s31, 15
    s_mul_i32 s31, s31, 393216
    s_add_u32 s31, s31, s30
    s_add_u32 m0, s33, 0
    s_nop 0
    buffer_load_dwordx4 v8, s[12:15], s31 offen offset:0 lds
    buffer_load_dwordx4 v9, s[12:15], s31 offen offset:1024 lds
    buffer_load_dwordx4 v10, s[12:15], s31 offen offset:2048 lds
    s_add_u32 m0, s33, 3072
    s_add_u32 s31, s31, 98304
    buffer_load_dwordx4 v8, s[12:15], s31 offen offset:0 lds
    buffer_load_dwordx4 v9, s[12:15], s31 offen offset:1024 lds
    buffer_load_dwordx4 v10, s[12:15], s31 offen offset:2048 lds
    s_waitcnt vmcnt(28)
    s_barrier
    s_add_u32 s31, s55, 14
    s_and_b32 s31, s31, 15
    s_lshl_b32 s31, s31, 7
    s_add_u32 s31, s31, s28
    s_add_u32 m0, s29, 8192
    s_nop 0
    buffer_load_dwordx4 v4, s[8:11], s31 offen offset:0 lds
    buffer_load_dwordx4 v5, s[8:11], s31 offen offset:1024 lds
    buffer_load_dwordx4 v6, s[8:11], s31 offen offset:2048 lds
    buffer_load_dwordx4 v7, s[8:11], s31 offen offset:3072 lds
    s_add_u32 m0, s29, 20480
    s_add_u32 s31, s31, 65536
    buffer_load_dwordx4 v4, s[8:11], s31 offen offset:0 lds
    buffer_load_dwordx4 v5, s[8:11], s31 offen offset:1024 lds
    buffer_load_dwordx4 v6, s[8:11], s31 offen offset:2048 lds
    buffer_load_dwordx4 v7, s[8:11], s31 offen offset:3072 lds
    s_add_u32 m0, s29, 32768
    s_add_u32 s31, s31, 65536
    buffer_load_dwordx4 v4, s[8:11], s31 offen offset:0 lds
    buffer_load_dwordx4 v5, s[8:11], s31 offen offset:1024 lds
    buffer_load_dwordx4 v6, s[8:11], s31 offen offset:2048 lds
    buffer_load_dwordx4 v7, s[8:11], s31 offen offset:3072 lds
    s_add_u32 m0, s29, 45056
    s_add_u32 s31, s31, 65536
    buffer_load_dwordx4 v4, s[8:11], s31 offen offset:0 lds
    buffer_load_dwordx4 v5, s[8:11], s31 offen offset:1024 lds
    buffer_load_dwordx4 v6, s[8:11], s31 offen offset:2048 lds
    buffer_load_dwordx4 v7, s[8:11], s31 offen offset:3072 lds
    s_waitcnt vmcnt(22)
    s_barrier
    s_add_u32 s31, s55, 15
    s_and_b32 s31, s31, 15
    s_lshl_b32 s31, s31, 7
    s_add_u32 s31, s31, s28
    s_add_u32 m0, s29, 0
    s_nop 0
    buffer_load_dwordx4 v4, s[8:11], s31 offen offset:0 lds
    buffer_load_dwordx4 v5, s[8:11], s31 offen offset:1024 lds
    buffer_load_dwordx4 v6, s[8:11], s31 offen offset:2048 lds
    buffer_load_dwordx4 v7, s[8:11], s31 offen offset:3072 lds
    s_add_u32 m0, s29, 12288
    s_add_u32 s31, s31, 65536
    buffer_load_dwordx4 v4, s[8:11], s31 offen offset:0 lds
    buffer_load_dwordx4 v5, s[8:11], s31 offen offset:1024 lds
    buffer_load_dwordx4 v6, s[8:11], s31 offen offset:2048 lds
    buffer_load_dwordx4 v7, s[8:11], s31 offen offset:3072 lds
    s_add_u32 m0, s29, 24576
    s_add_u32 s31, s31, 65536
    buffer_load_dwordx4 v4, s[8:11], s31 offen offset:0 lds
    buffer_load_dwordx4 v5, s[8:11], s31 offen offset:1024 lds
    buffer_load_dwordx4 v6, s[8:11], s31 offen offset:2048 lds
    buffer_load_dwordx4 v7, s[8:11], s31 offen offset:3072 lds
    s_add_u32 m0, s29, 36864
    s_add_u32 s31, s31, 65536
    buffer_load_dwordx4 v4, s[8:11], s31 offen offset:0 lds
    buffer_load_dwordx4 v5, s[8:11], s31 offen offset:1024 lds
    buffer_load_dwordx4 v6, s[8:11], s31 offen offset:2048 lds
    buffer_load_dwordx4 v7, s[8:11], s31 offen offset:3072 lds
    s_lshl_b32 s71, s66, 7
    s_lshr_b32 s72, s64, 1
    s_cmp_lg_u32 s72, 0
    s_cselect_b32 s54, 0x3e800000, 0
    v_and_b32 v25, 31, v1
    v_lshl_add_u32 v25, v25, 1, s69
    v_cvt_f32_u32 v25, v25
    v_mul_f32 v25, 0x3a000000, v25
    v_lshrrev_b32 v27, 5, v1
    v_lshl_add_u32 v27, v27, 3, s71
    v_cvt_f32_u32 v27, v27
    v_fma_f32 v24, v25, v27, s54
    v_fract_f32 v24, v24
    v_mul_f32 v26, 0x41100000, v25
    v_mul_f32 v27, 0x44000000, v25
    v_add_f32 v27, s54, v27
    v_fract_f32 v27, v27
    v_cos_f32 v27, v27
    v_mov_b32 v169, 0
    v_mov_b32 v170, 0
    v_mov_b32 v171, 0
    v_cvt_pk_bf16_f32 v168, v27, v27
    v_cos_f32 v27, v24
    v_add_f32 v24, v24, v25
    v_cos_f32 v28, v24
    v_add_f32 v24, v24, v25
    v_cvt_pk_bf16_f32 v136, v27, v28
    v_cos_f32 v29, v24
    v_add_f32 v24, v24, v25
    v_cos_f32 v30, v24
    v_add_f32 v24, v24, v25
    v_cvt_pk_bf16_f32 v137, v29, v30
    v_cos_f32 v27, v24
    v_add_f32 v24, v24, v25
    v_cos_f32 v28, v24
    v_add_f32 v24, v24, v25
    v_cvt_pk_bf16_f32 v138, v27, v28
    v_cos_f32 v29, v24
    v_add_f32 v24, v24, v25
    v_cos_f32 v30, v24
    v_add_f32 v24, v24, v26
    v_cvt_pk_bf16_f32 v139, v29, v30
    v_cos_f32 v27, v24
    v_add_f32 v24, v24, v25
    v_cos_f32 v28, v24
    v_add_f32 v24, v24, v25
    v_cvt_pk_bf16_f32 v140, v27, v28
    v_cos_f32 v29, v24
    v_add_f32 v24, v24, v25
    v_cos_f32 v30, v24
    v_add_f32 v24, v24, v25
    v_cvt_pk_bf16_f32 v141, v29, v30
    v_cos_f32 v27, v24
    v_add_f32 v24, v24, v25
    v_cos_f32 v28, v24
    v_add_f32 v24, v24, v25
    v_cvt_pk_bf16_f32 v142, v27, v28
    v_cos_f32 v29, v24
    v_add_f32 v24, v24, v25
    v_cos_f32 v30, v24
    v_add_f32 v24, v24, v26
    v_cvt_pk_bf16_f32 v143, v29, v30
    v_cos_f32 v27, v24
    v_add_f32 v24, v24, v25
    v_cos_f32 v28, v24
    v_add_f32 v24, v24, v25
    v_cvt_pk_bf16_f32 v144, v27, v28
    v_cos_f32 v29, v24
    v_add_f32 v24, v24, v25
    v_cos_f32 v30, v24
    s_waitcnt vmcnt(16)
    s_barrier
    v_add_f32 v24, v24, v25
    v_cvt_pk_bf16_f32 v145, v29, v30
    v_cos_f32 v27, v24
    v_add_f32 v24, v24, v25
    v_cos_f32 v28, v24
    v_add_f32 v24, v24, v25
    v_cvt_pk_bf16_f32 v146, v27, v28
    v_cos_f32 v29, v24
    v_add_f32 v24, v24, v25
    v_cos_f32 v30, v24
    v_add_f32 v24, v24, v26
    v_cvt_pk_bf16_f32 v147, v29, v30
    v_cos_f32 v27, v24
    v_add_f32 v24, v24, v25
    v_cos_f32 v28, v24
    v_add_f32 v24, v24, v25
    v_cvt_pk_bf16_f32 v148, v27, v28
    v_cos_f32 v29, v24
    v_add_f32 v24, v24, v25
    v_cos_f32 v30, v24
    v_add_f32 v24, v24, v25
    v_cvt_pk_bf16_f32 v149, v29, v30
    v_cos_f32 v27, v24
    v_add_f32 v24, v24, v25
    v_cos_f32 v28, v24
    v_add_f32 v24, v24, v25
    v_cvt_pk_bf16_f32 v150, v27, v28
    v_cos_f32 v29, v24
    v_add_f32 v24, v24, v25
    v_cos_f32 v30, v24
    v_add_f32 v24, v24, v26
    v_cvt_pk_bf16_f32 v151, v29, v30
    v_cos_f32 v27, v24
    v_add_f32 v24, v24, v25
    v_cos_f32 v28, v24
    v_add_f32 v24, v24, v25
    v_cvt_pk_bf16_f32 v152, v27, v28
    v_cos_f32 v29, v24
    v_add_f32 v24, v24, v25
    v_cos_f32 v30, v24
    v_add_f32 v24, v24, v25
    v_cvt_pk_bf16_f32 v153, v29, v30
    v_cos_f32 v27, v24
    v_add_f32 v24, v24, v25
    v_cos_f32 v28, v24
    v_add_f32 v24, v24, v25
    v_cvt_pk_bf16_f32 v154, v27, v28
    v_cos_f32 v29, v24
    v_add_f32 v24, v24, v25
    v_cos_f32 v30, v24
    v_add_f32 v24, v24, v26
    v_cvt_pk_bf16_f32 v155, v29, v30
    v_cos_f32 v27, v24
    v_add_f32 v24, v24, v25
    v_cos_f32 v28, v24
    v_add_f32 v24, v24, v25
    v_cvt_pk_bf16_f32 v156, v27, v28
    v_cos_f32 v29, v24
    v_add_f32 v24, v24, v25
    v_cos_f32 v30, v24
    v_add_f32 v24, v24, v25
    v_cvt_pk_bf16_f32 v157, v29, v30
    v_cos_f32 v27, v24
    v_add_f32 v24, v24, v25
    v_cos_f32 v28, v24
    v_add_f32 v24, v24, v25
    v_cvt_pk_bf16_f32 v158, v27, v28
    v_cos_f32 v29, v24
    v_add_f32 v24, v24, v25
    v_cos_f32 v30, v24
    s_waitcnt vmcnt(0)
    s_barrier
    v_add_f32 v24, v24, v26
    v_cvt_pk_bf16_f32 v159, v29, v30
    v_cos_f32 v27, v24
    v_add_f32 v24, v24, v25
    v_cos_f32 v28, v24
    v_add_f32 v24, v24, v25
    v_cvt_pk_bf16_f32 v160, v27, v28
    v_cos_f32 v29, v24
    v_add_f32 v24, v24, v25
    v_cos_f32 v30, v24
    v_add_f32 v24, v24, v25
    v_cvt_pk_bf16_f32 v161, v29, v30
    v_cos_f32 v27, v24
    v_add_f32 v24, v24, v25
    v_cos_f32 v28, v24
    v_add_f32 v24, v24, v25
    v_cvt_pk_bf16_f32 v162, v27, v28
    v_cos_f32 v29, v24
    v_add_f32 v24, v24, v25
    v_cos_f32 v30, v24
    v_add_f32 v24, v24, v26
    v_cvt_pk_bf16_f32 v163, v29, v30
    v_cos_f32 v27, v24
    v_add_f32 v24, v24, v25
    v_cos_f32 v28, v24
    v_add_f32 v24, v24, v25
    v_cvt_pk_bf16_f32 v164, v27, v28
    v_cos_f32 v29, v24
    v_add_f32 v24, v24, v25
    v_cos_f32 v30, v24
    v_add_f32 v24, v24, v25
    v_cvt_pk_bf16_f32 v165, v29, v30
    v_cos_f32 v27, v24
    v_add_f32 v24, v24, v25
    v_cos_f32 v28, v24
    v_add_f32 v24, v24, v25
    v_cvt_pk_bf16_f32 v166, v27, v28
    v_cos_f32 v29, v24
    v_add_f32 v24, v24, v25
    v_cos_f32 v30, v24
    v_add_f32 v24, v24, v26
    v_cvt_pk_bf16_f32 v167, v29, v30
    s_branch L_epi
L_p0:
    s_and_b32 s24, s2, 1
    s_lshl_b32 s24, s24, 8
    s_bfe_u32 s25, s2, 0x20001
    s_lshl_b32 s25, s25, 6
    s_add_u32 s24, s24, s25
    s_lshr_b32 s25, s2, 3
    s_lshl1_add_u32 s24, s25, s24
    s_and_b32 s27, s3, 1
    s_add_u32 s7, s24, s27
    s_lshl_b32 s98, s7, 11
    s_sub_u32 s99, 0x400000, s98
    s_sub_u32 s100, 0x200000, s98
    s_add_u32 s101, 0x200000, s98
    s_cmp_eq_u32 s7, 0
    s_cselect_b32 s99, 0x100000, s99
    s_cselect_b32 s100, 0x300000, s100
    s_cselect_b32 s42, 0, 1.0
    v_lshlrev_b32 v192, 3, v1
    v_sub_u32 v193, 1016, v192
    s_waitcnt lgkmcnt(0)
    buffer_load_dwordx2 v[96:97], v192, s[44:47], 0 offen offset:0
    buffer_load_dwordx2 v[100:101], v193, s[44:47], 0 offen offset:1024
    buffer_load_dwordx2 v[104:105], v193, s[44:47], 0 offen offset:0
    buffer_load_dwordx2 v[108:109], v192, s[44:47], 0 offen offset:1024
    buffer_load_dwordx2 v[32:33], v192, s[8:11], s98 offen offset:0
    buffer_load_dwordx2 v[36:37], v193, s[8:11], s98 offen offset:1024
    buffer_load_dwordx2 v[40:41], v193, s[8:11], s98 offen offset:0
    buffer_load_dwordx2 v[44:45], v192, s[8:11], s98 offen offset:1024
    buffer_load_dwordx2 v[48:49], v192, s[8:11], s99 offen offset:0
    buffer_load_dwordx2 v[52:53], v193, s[8:11], s99 offen offset:1024
    buffer_load_dwordx2 v[56:57], v193, s[8:11], s99 offen offset:0
    buffer_load_dwordx2 v[60:61], v192, s[8:11], s99 offen offset:1024
    buffer_load_dwordx2 v[64:65], v192, s[8:11], s100 offen offset:0
    buffer_load_dwordx2 v[68:69], v193, s[8:11], s100 offen offset:1024
    buffer_load_dwordx2 v[72:73], v193, s[8:11], s100 offen offset:0
    buffer_load_dwordx2 v[76:77], v192, s[8:11], s100 offen offset:1024
    buffer_load_dwordx2 v[80:81], v192, s[8:11], s101 offen offset:0
    buffer_load_dwordx2 v[84:85], v193, s[8:11], s101 offen offset:1024
    buffer_load_dwordx2 v[88:89], v193, s[8:11], s101 offen offset:0
    buffer_load_dwordx2 v[92:93], v192, s[8:11], s101 offen offset:1024
    v_cmp_eq_u32 vcc, 0, v1
    s_nop 1
    v_cndmask_b32_e64 v194, 1.0, 0, vcc
    v_mov_b32 v175, 0x40000000
    v_cndmask_b32_e64 v195, v175, 0, vcc
    s_mov_b32 s43, 0x3f803f80
    s_and_b32 s24, s2, 7
    s_lshr_b32 s25, s2, 7
    s_bfe_u32 s26, s2, 0x40003
    s_lshl_b32 s71, s24, 6
    s_add_u32 s71, s71, s25
    s_lshl_b32 s72, s26, 4
    s_lshl1_add_u32 s25, s27, s25
    s_lshl3_add_u32 s25, s25, s24
    s_lshl4_add_u32 s25, s25, s26
    s_lshl_b32 s25, s25, 10
    s_add_u32 s73, s25, 0x1a00000
    s_mov_b32 s74, s27
    s_lshl_b32 s25, s24, 6
    v_and_b32 v174, 31, v1
    v_lshl_add_u32 v174, v174, 1, s25
    v_sub_u32 v175, 1024, v174
    v_cmp_eq_u32 vcc, 0, v174
    v_mov_b32 v176, 512
    s_nop 0
    v_cndmask_b32 v176, v175, v176, vcc
    v_lshrrev_b32 v177, 5, v1
    v_lshlrev_b32 v177, 13, v177
    v_lshl_add_u32 v202, v174, 1, v177
    v_lshl_add_u32 v204, v176, 1, v177
    v_lshl_add_u32 v205, v175, 1, v177
    v_add_u32 v205, -2, v205
    s_lshr_b32 s25, s2, 3
    s_lshl1_add_u32 s25, s25, s27
    s_lshl_b32 s24, s24, 8
    s_add_u32 s24, s24, s25
    s_lshl_b32 s24, s24, 10
    s_add_u32 s68, s24, 0x1200000
    s_lshl_b32 s70, s25, 15
    s_cmp_lg_u32 s7, 0
    s_cbranch_scc1 L_notag
    s_memrealtime s[24:25]
    s_waitcnt lgkmcnt(0)
    s_or_b32 s24, s24, 1
    v_mov_b32 v14, s24
    v_mov_b32 v15, 0
    buffer_store_dword v14, v15, s[20:23], 0 offen sc1
L_notag:
    s_cmp_lg_u32 s74, 0
    s_cselect_b32 s54, 0x3e800000, 0
    v_and_b32 v25, 31, v1
    v_lshl_add_u32 v25, v25, 1, s71
    v_cvt_f32_u32 v25, v25
    v_mul_f32 v25, 0x3a800000, v25
    v_lshrrev_b32 v27, 5, v1
    v_lshl_add_u32 v27, v27, 3, s72
    v_cvt_f32_u32 v27, v27
    v_fma_f32 v24, v25, v27, s54
    v_fract_f32 v24, v24
    v_mul_f32 v26, 0x41100000, v25
    v_cos_f32 v27, v24
    v_add_f32 v24, v24, v25
    v_cos_f32 v28, v24
    v_add_f32 v24, v24, v25
    v_cvt_pk_bf16_f32 v112, v27, v28
    v_cos_f32 v29, v24
    v_add_f32 v24, v24, v25
    v_cos_f32 v30, v24
    v_add_f32 v24, v24, v25
    v_cvt_pk_bf16_f32 v113, v29, v30
    v_cos_f32 v27, v24
    v_add_f32 v24, v24, v25
    v_cos_f32 v28, v24
    v_add_f32 v24, v24, v25
    v_cvt_pk_bf16_f32 v114, v27, v28
    v_cos_f32 v29, v24
    v_add_f32 v24, v24, v25
    v_cos_f32 v30, v24
    v_add_f32 v24, v24, v26
    v_cvt_pk_bf16_f32 v115, v29, v30
    buffer_store_dwordx4 v[112:115], v2, s[16:19], s73 offen sc1
    s_lshl_b32 s71, s66, 7
    s_lshr_b32 s72, s64, 1
    s_cmp_lg_u32 s72, 0
    s_cselect_b32 s54, 0x3e800000, 0
    v_and_b32 v25, 31, v1
    v_lshl_add_u32 v25, v25, 1, s69
    v_cvt_f32_u32 v25, v25
    v_mul_f32 v25, 0x3a000000, v25
    v_lshrrev_b32 v27, 5, v1
    v_lshl_add_u32 v27, v27, 3, s71
    v_cvt_f32_u32 v27, v27
    v_fma_f32 v24, v25, v27, s54
    v_fract_f32 v24, v24
    v_mul_f32 v26, 0x41100000, v25
    v_mul_f32 v27, 0x44000000, v25
    v_add_f32 v27, s54, v27
    v_fract_f32 v27, v27
    v_cos_f32 v27, v27
    v_mov_b32 v169, 0
    v_mov_b32 v170, 0
    v_mov_b32 v171, 0
    v_cvt_pk_bf16_f32 v168, v27, v27
    v_cos_f32 v27, v24
    v_add_f32 v24, v24, v25
    v_cos_f32 v28, v24
    v_add_f32 v24, v24, v25
    v_cvt_pk_bf16_f32 v136, v27, v28
    v_cos_f32 v29, v24
    v_add_f32 v24, v24, v25
    v_cos_f32 v30, v24
    v_add_f32 v24, v24, v25
    v_cvt_pk_bf16_f32 v137, v29, v30
    v_cos_f32 v27, v24
    v_add_f32 v24, v24, v25
    v_cos_f32 v28, v24
    v_add_f32 v24, v24, v25
    v_cvt_pk_bf16_f32 v138, v27, v28
    v_cos_f32 v29, v24
    v_add_f32 v24, v24, v25
    v_cos_f32 v30, v24
    v_add_f32 v24, v24, v26
    v_cvt_pk_bf16_f32 v139, v29, v30
    v_cos_f32 v27, v24
    v_add_f32 v24, v24, v25
    v_cos_f32 v28, v24
    v_add_f32 v24, v24, v25
    v_cvt_pk_bf16_f32 v140, v27, v28
    v_cos_f32 v29, v24
    v_add_f32 v24, v24, v25
    v_cos_f32 v30, v24
    v_add_f32 v24, v24, v25
    v_cvt_pk_bf16_f32 v141, v29, v30
    v_cos_f32 v27, v24
    v_add_f32 v24, v24, v25
    v_cos_f32 v28, v24
    v_add_f32 v24, v24, v25
    v_cvt_pk_bf16_f32 v142, v27, v28
    v_cos_f32 v29, v24
    v_add_f32 v24, v24, v25
    v_cos_f32 v30, v24
    v_add_f32 v24, v24, v26
    v_cvt_pk_bf16_f32 v143, v29, v30
    v_cos_f32 v27, v24
    v_add_f32 v24, v24, v25
    v_cos_f32 v28, v24
    v_add_f32 v24, v24, v25
    v_cvt_pk_bf16_f32 v144, v27, v28
    v_cos_f32 v29, v24
    v_add_f32 v24, v24, v25
    v_cos_f32 v30, v24
    v_add_f32 v24, v24, v25
    v_cvt_pk_bf16_f32 v145, v29, v30
    v_cos_f32 v27, v24
    v_add_f32 v24, v24, v25
    v_cos_f32 v28, v24
    v_add_f32 v24, v24, v25
    v_cvt_pk_bf16_f32 v146, v27, v28
    v_cos_f32 v29, v24
    v_add_f32 v24, v24, v25
    v_cos_f32 v30, v24
    v_add_f32 v24, v24, v26
    v_cvt_pk_bf16_f32 v147, v29, v30
    v_cos_f32 v27, v24
    v_add_f32 v24, v24, v25
    v_cos_f32 v28, v24
    v_add_f32 v24, v24, v25
    v_cvt_pk_bf16_f32 v148, v27, v28
    v_cos_f32 v29, v24
    v_add_f32 v24, v24, v25
    v_cos_f32 v30, v24
    v_add_f32 v24, v24, v25
    v_cvt_pk_bf16_f32 v149, v29, v30
    v_cos_f32 v27, v24
    v_add_f32 v24, v24, v25
    v_cos_f32 v28, v24
    v_add_f32 v24, v24, v25
    v_cvt_pk_bf16_f32 v150, v27, v28
    v_cos_f32 v29, v24
    v_add_f32 v24, v24, v25
    v_cos_f32 v30, v24
    v_add_f32 v24, v24, v26
    v_cvt_pk_bf16_f32 v151, v29, v30
    v_cos_f32 v27, v24
    v_add_f32 v24, v24, v25
    v_cos_f32 v28, v24
    v_add_f32 v24, v24, v25
    v_cvt_pk_bf16_f32 v152, v27, v28
    v_cos_f32 v29, v24
    v_add_f32 v24, v24, v25
    v_cos_f32 v30, v24
    v_add_f32 v24, v24, v25
    v_cvt_pk_bf16_f32 v153, v29, v30
    v_cos_f32 v27, v24
    v_add_f32 v24, v24, v25
    v_cos_f32 v28, v24
    v_add_f32 v24, v24, v25
    v_cvt_pk_bf16_f32 v154, v27, v28
    v_cos_f32 v29, v24
    v_add_f32 v24, v24, v25
    v_cos_f32 v30, v24
    v_add_f32 v24, v24, v26
    v_cvt_pk_bf16_f32 v155, v29, v30
    v_cos_f32 v27, v24
    v_add_f32 v24, v24, v25
    v_cos_f32 v28, v24
    v_add_f32 v24, v24, v25
    v_cvt_pk_bf16_f32 v156, v27, v28
    v_cos_f32 v29, v24
    v_add_f32 v24, v24, v25
    v_cos_f32 v30, v24
    v_add_f32 v24, v24, v25
    v_cvt_pk_bf16_f32 v157, v29, v30
    v_cos_f32 v27, v24
    v_add_f32 v24, v24, v25
    v_cos_f32 v28, v24
    v_add_f32 v24, v24, v25
    v_cvt_pk_bf16_f32 v158, v27, v28
    v_cos_f32 v29, v24
    v_add_f32 v24, v24, v25
    v_cos_f32 v30, v24
    v_add_f32 v24, v24, v26
    v_cvt_pk_bf16_f32 v159, v29, v30
    v_cos_f32 v27, v24
    v_add_f32 v24, v24, v25
    v_cos_f32 v28, v24
    v_add_f32 v24, v24, v25
    v_cvt_pk_bf16_f32 v160, v27, v28
    v_cos_f32 v29, v24
    v_add_f32 v24, v24, v25
    v_cos_f32 v30, v24
    v_add_f32 v24, v24, v25
    v_cvt_pk_bf16_f32 v161, v29, v30
    v_cos_f32 v27, v24
    v_add_f32 v24, v24, v25
    v_cos_f32 v28, v24
    v_add_f32 v24, v24, v25
    v_cvt_pk_bf16_f32 v162, v27, v28
    v_cos_f32 v29, v24
    v_add_f32 v24, v24, v25
    v_cos_f32 v30, v24
    v_add_f32 v24, v24, v26
    v_cvt_pk_bf16_f32 v163, v29, v30
    v_cos_f32 v27, v24
    v_add_f32 v24, v24, v25
    v_cos_f32 v28, v24
    v_add_f32 v24, v24, v25
    v_cvt_pk_bf16_f32 v164, v27, v28
    v_cos_f32 v29, v24
    v_add_f32 v24, v24, v25
    v_cos_f32 v30, v24
    v_add_f32 v24, v24, v25
    v_cvt_pk_bf16_f32 v165, v29, v30
    v_cos_f32 v27, v24
    v_add_f32 v24, v24, v25
    v_cos_f32 v28, v24
    v_add_f32 v24, v24, v25
    v_cvt_pk_bf16_f32 v166, v27, v28
    v_cos_f32 v29, v24
    v_add_f32 v24, v24, v25
    v_cos_f32 v30, v24
    v_add_f32 v24, v24, v26
    v_cvt_pk_bf16_f32 v167, v29, v30
    s_barrier
    v_mov_b32 v15, 0
    buffer_load_dword v14, v15, s[20:23], 0 offen sc1
    s_waitcnt vmcnt(14)
    v_and_b32 v99, 0xffff0000, v97
    v_lshlrev_b32 v98, 16, v97
    v_and_b32 v97, 0xffff0000, v96
    v_lshlrev_b32 v96, 16, v96
    v_and_b32 v103, 0xffff0000, v101
    v_lshlrev_b32 v102, 16, v101
    v_and_b32 v101, 0xffff0000, v100
    v_lshlrev_b32 v100, 16, v100
    v_and_b32 v107, 0xffff0000, v105
    v_lshlrev_b32 v106, 16, v105
    v_and_b32 v105, 0xffff0000, v104
    v_lshlrev_b32 v104, 16, v104
    v_and_b32 v111, 0xffff0000, v109
    v_lshlrev_b32 v110, 16, v109
    v_and_b32 v109, 0xffff0000, v108
    v_lshlrev_b32 v108, 16, v108
    v_mov_b32 v196, s43
    v_mov_b32 v197, s43
    v_mov_b32 v198, s43
    v_mov_b32 v199, s43
    v_and_b32 v35, 0xffff0000, v33
    v_lshlrev_b32 v34, 16, v33
    v_and_b32 v33, 0xffff0000, v32
    v_lshlrev_b32 v32, 16, v32
    v_mul_f32 v174, v32, v96
    v_mul_f32 v175, v33, v97
    v_mul_f32 v176, v34, v98
    v_mul_f32 v177, v35, v99
    v_cvt_pk_bf16_f32 v180, v174, v175
    v_cvt_pk_bf16_f32 v181, v176, v177
    v_and_b32 v39, 0xffff0000, v37
    v_lshlrev_b32 v38, 16, v37
    v_and_b32 v37, 0xffff0000, v36
    v_lshlrev_b32 v36, 16, v36
    v_mul_f32 v174, v36, v100
    v_mul_f32 v175, v37, v101
    v_mul_f32 v176, v38, v102
    v_mul_f32 v177, v39, v103
    v_cvt_pk_bf16_f32 v182, v174, v175
    v_cvt_pk_bf16_f32 v183, v176, v177
    v_mov_b32_dpp v36, v36 wave_ror:1 row_mask:0xf bank_mask:0xf
    s_nop 0
    v_mfma_f32_16x16x32_bf16 v[240:243], v[196:199], v[180:183], 0
    v_and_b32 v43, 0xffff0000, v41
    v_lshlrev_b32 v42, 16, v41
    v_and_b32 v41, 0xffff0000, v40
    v_lshlrev_b32 v40, 16, v40
    v_mul_f32 v174, v40, v104
    v_mul_f32 v175, v41, v105
    v_mul_f32 v176, v42, v106
    v_mul_f32 v177, v43, v107
    v_cvt_pk_bf16_f32 v184, v174, v175
    v_cvt_pk_bf16_f32 v185, v176, v177
    v_mov_b32_dpp v40, v40 wave_ror:1 row_mask:0xf bank_mask:0xf
    v_and_b32 v47, 0xffff0000, v45
    v_lshlrev_b32 v46, 16, v45
    v_and_b32 v45, 0xffff0000, v44
    v_lshlrev_b32 v44, 16, v44
    v_mul_f32 v174, v44, v108
    v_mul_f32 v175, v45, v109
    v_mul_f32 v176, v46, v110
    v_mul_f32 v177, v47, v111
    v_cvt_pk_bf16_f32 v186, v174, v175
    v_cvt_pk_bf16_f32 v187, v176, v177
    s_nop 1
    v_mfma_f32_16x16x32_bf16 v[240:243], v[196:199], v[184:187], v[240:243]
    s_barrier
    s_waitcnt vmcnt(10)
    v_and_b32 v51, 0xffff0000, v49
    v_lshlrev_b32 v50, 16, v49
    v_and_b32 v49, 0xffff0000, v48
    v_lshlrev_b32 v48, 16, v48
    v_mul_f32 v174, v48, v96
    v_mul_f32 v175, v49, v97
    v_mul_f32 v176, v50, v98
    v_mul_f32 v177, v51, v99
    v_cvt_pk_bf16_f32 v180, v174, v175
    v_cvt_pk_bf16_f32 v181, v176, v177
    v_and_b32 v55, 0xffff0000, v53
    v_lshlrev_b32 v54, 16, v53
    v_and_b32 v53, 0xffff0000, v52
    v_lshlrev_b32 v52, 16, v52
    v_mul_f32 v174, v52, v100
    v_mul_f32 v175, v53, v101
    v_mul_f32 v176, v54, v102
    v_mul_f32 v177, v55, v103
    v_cvt_pk_bf16_f32 v182, v174, v175
    v_cvt_pk_bf16_f32 v183, v176, v177
    v_mov_b32_dpp v52, v52 wave_ror:1 row_mask:0xf bank_mask:0xf
    s_nop 0
    v_mfma_f32_16x16x32_bf16 v[244:247], v[196:199], v[180:183], 0
    v_and_b32 v59, 0xffff0000, v57
    v_lshlrev_b32 v58, 16, v57
    v_and_b32 v57, 0xffff0000, v56
    v_lshlrev_b32 v56, 16, v56
    v_mul_f32 v174, v56, v104
    v_mul_f32 v175, v57, v105
    v_mul_f32 v176, v58, v106
    v_mul_f32 v177, v59, v107
    v_cvt_pk_bf16_f32 v184, v174, v175
    v_cvt_pk_bf16_f32 v185, v176, v177
    v_mov_b32_dpp v56, v56 wave_ror:1 row_mask:0xf bank_mask:0xf
    v_and_b32 v63, 0xffff0000, v61
    v_lshlrev_b32 v62, 16, v61
    v_and_b32 v61, 0xffff0000, v60
    v_lshlrev_b32 v60, 16, v60
    v_mul_f32 v174, v60, v108
    v_mul_f32 v175, v61, v109
    v_mul_f32 v176, v62, v110
    v_mul_f32 v177, v63, v111
    v_cvt_pk_bf16_f32 v186, v174, v175
    v_cvt_pk_bf16_f32 v187, v176, v177
    s_nop 1
    v_mfma_f32_16x16x32_bf16 v[244:247], v[196:199], v[184:187], v[244:247]
    s_waitcnt vmcnt(6)
    v_and_b32 v67, 0xffff0000, v65
    v_lshlrev_b32 v66, 16, v65
    v_and_b32 v65, 0xffff0000, v64
    v_lshlrev_b32 v64, 16, v64
    v_mul_f32 v174, v64, v96
    v_mul_f32 v175, v65, v97
    v_mul_f32 v176, v66, v98
    v_mul_f32 v177, v67, v99
    v_cvt_pk_bf16_f32 v180, v174, v175
    v_cvt_pk_bf16_f32 v181, v176, v177
    v_and_b32 v71, 0xffff0000, v69
    v_lshlrev_b32 v70, 16, v69
    v_and_b32 v69, 0xffff0000, v68
    v_lshlrev_b32 v68, 16, v68
    v_mul_f32 v174, v68, v100
    v_mul_f32 v175, v69, v101
    v_mul_f32 v176, v70, v102
    v_mul_f32 v177, v71, v103
    v_cvt_pk_bf16_f32 v182, v174, v175
    v_cvt_pk_bf16_f32 v183, v176, v177
    v_mov_b32_dpp v68, v68 wave_ror:1 row_mask:0xf bank_mask:0xf
    s_nop 0
    v_mfma_f32_16x16x32_bf16 v[248:251], v[196:199], v[180:183], 0
    v_and_b32 v75, 0xffff0000, v73
    v_lshlrev_b32 v74, 16, v73
    v_and_b32 v73, 0xffff0000, v72
    v_lshlrev_b32 v72, 16, v72
    v_mul_f32 v174, v72, v104
    v_mul_f32 v175, v73, v105
    v_mul_f32 v176, v74, v106
    v_mul_f32 v177, v75, v107
    v_cvt_pk_bf16_f32 v184, v174, v175
    v_cvt_pk_bf16_f32 v185, v176, v177
    v_mov_b32_dpp v72, v72 wave_ror:1 row_mask:0xf bank_mask:0xf
    v_and_b32 v79, 0xffff0000, v77
    v_lshlrev_b32 v78, 16, v77
    v_and_b32 v77, 0xffff0000, v76
    v_lshlrev_b32 v76, 16, v76
    v_mul_f32 v174, v76, v108
    v_mul_f32 v175, v77, v109
    v_mul_f32 v176, v78, v110
    v_mul_f32 v177, v79, v111
    v_cvt_pk_bf16_f32 v186, v174, v175
    v_cvt_pk_bf16_f32 v187, v176, v177
    s_nop 1
    v_mfma_f32_16x16x32_bf16 v[248:251], v[196:199], v[184:187], v[248:251]
    s_barrier
    s_waitcnt vmcnt(2)
    v_and_b32 v83, 0xffff0000, v81
    v_lshlrev_b32 v82, 16, v81
    v_and_b32 v81, 0xffff0000, v80
    v_lshlrev_b32 v80, 16, v80
    v_mul_f32 v174, v80, v96
    v_mul_f32 v175, v81, v97
    v_mul_f32 v176, v82, v98
    v_mul_f32 v177, v83, v99
    v_cvt_pk_bf16_f32 v180, v174, v175
    v_cvt_pk_bf16_f32 v181, v176, v177
    v_and_b32 v87, 0xffff0000, v85
    v_lshlrev_b32 v86, 16, v85
    v_and_b32 v85, 0xffff0000, v84
    v_lshlrev_b32 v84, 16, v84
    v_mul_f32 v174, v84, v100
    v_mul_f32 v175, v85, v101
    v_mul_f32 v176, v86, v102
    v_mul_f32 v177, v87, v103
    v_cvt_pk_bf16_f32 v182, v174, v175
    v_cvt_pk_bf16_f32 v183, v176, v177
    v_mov_b32_dpp v84, v84 wave_ror:1 row_mask:0xf bank_mask:0xf
    s_nop 0
    v_mfma_f32_16x16x32_bf16 v[252:255], v[196:199], v[180:183], 0
    v_and_b32 v91, 0xffff0000, v89
    v_lshlrev_b32 v90, 16, v89
    v_and_b32 v89, 0xffff0000, v88
    v_lshlrev_b32 v88, 16, v88
    v_mul_f32 v174, v88, v104
    v_mul_f32 v175, v89, v105
    v_mul_f32 v176, v90, v106
    v_mul_f32 v177, v91, v107
    v_cvt_pk_bf16_f32 v184, v174, v175
    v_cvt_pk_bf16_f32 v185, v176, v177
    v_mov_b32_dpp v88, v88 wave_ror:1 row_mask:0xf bank_mask:0xf
    v_and_b32 v95, 0xffff0000, v93
    v_lshlrev_b32 v94, 16, v93
    v_and_b32 v93, 0xffff0000, v92
    v_lshlrev_b32 v92, 16, v92
    v_mul_f32 v174, v92, v108
    v_mul_f32 v175, v93, v109
    v_mul_f32 v176, v94, v110
    v_mul_f32 v177, v95, v111
    v_cvt_pk_bf16_f32 v186, v174, v175
    v_cvt_pk_bf16_f32 v187, v176, v177
    s_nop 1
    v_mfma_f32_16x16x32_bf16 v[252:255], v[196:199], v[184:187], v[252:255]
    v_add_f32_dpp v240, v240, v240 row_shr:1 row_mask:0xf bank_mask:0xf
    v_add_f32_dpp v244, v244, v244 row_shr:1 row_mask:0xf bank_mask:0xf
    v_add_f32_dpp v248, v248, v248 row_shr:1 row_mask:0xf bank_mask:0xf
    s_nop 4
    v_add_f32_dpp v252, v252, v252 row_shr:1 row_mask:0xf bank_mask:0xf
    v_add_f32_dpp v240, v240, v240 row_shr:2 row_mask:0xf bank_mask:0xf
    v_add_f32_dpp v244, v244, v244 row_shr:2 row_mask:0xf bank_mask:0xf
    v_add_f32_dpp v248, v248, v248 row_shr:2 row_mask:0xf bank_mask:0xf
    v_add_f32_dpp v252, v252, v252 row_shr:2 row_mask:0xf bank_mask:0xf
    v_add_f32_dpp v240, v240, v240 row_shr:4 row_mask:0xf bank_mask:0xf
    v_add_f32_dpp v244, v244, v244 row_shr:4 row_mask:0xf bank_mask:0xf
    v_add_f32_dpp v248, v248, v248 row_shr:4 row_mask:0xf bank_mask:0xf
    v_add_f32_dpp v252, v252, v252 row_shr:4 row_mask:0xf bank_mask:0xf
    v_add_f32_dpp v240, v240, v240 row_shr:8 row_mask:0xf bank_mask:0xf
    v_add_f32_dpp v244, v244, v244 row_shr:8 row_mask:0xf bank_mask:0xf
    v_add_f32_dpp v248, v248, v248 row_shr:8 row_mask:0xf bank_mask:0xf
    v_add_f32_dpp v252, v252, v252 row_shr:8 row_mask:0xf bank_mask:0xf
    s_lshr_b32 s26, s98, 9
    s_add_u32 s26, s26, 0x1400000
    buffer_store_dword v240, v21, s[16:19], s26 offen sc1
    s_lshr_b32 s26, s99, 9
    s_add_u32 s26, s26, 0x1400000
    buffer_store_dword v244, v21, s[16:19], s26 offen sc1
    s_lshr_b32 s26, s100, 9
    s_add_u32 s26, s26, 0x1400000
    buffer_store_dword v248, v21, s[16:19], s26 offen sc1
    s_lshr_b32 s26, s101, 9
    s_add_u32 s26, s26, 0x1400000
    buffer_store_dword v252, v21, s[16:19], s26 offen sc1
    v_fma_f32 v174, v48, s42, v32
    v_fma_f32 v175, v64, s42, v80
    v_fma_f32 v176, v48, -s42, v32
    v_fma_f32 v177, v64, -s42, v80
    v_add_f32 v112, v174, v175
    v_sub_f32 v116, v174, v175
    v_add_f32 v120, v176, v177
    v_sub_f32 v124, v176, v177
    v_fma_f32 v174, v52, s42, v36
    v_fma_f32 v175, v68, s42, v84
    v_fma_f32 v176, v52, -s42, v36
    v_fma_f32 v177, v68, -s42, v84
    v_add_f32 v113, v174, v175
    v_sub_f32 v117, v174, v175
    v_add_f32 v121, v176, v177
    v_sub_f32 v125, v176, v177
    v_fma_f32 v174, v56, s42, v40
    v_fma_f32 v175, v72, s42, v88
    v_fma_f32 v176, v56, -s42, v40
    v_fma_f32 v177, v72, -s42, v88
    v_add_f32 v114, v174, v175
    v_sub_f32 v118, v174, v175
    v_add_f32 v122, v176, v177
    v_sub_f32 v126, v176, v177
    v_fma_f32 v174, v60, s42, v44
    v_fma_f32 v175, v76, s42, v92
    v_fma_f32 v176, v60, -s42, v44
    v_fma_f32 v177, v76, -s42, v92
    v_add_f32 v115, v174, v175
    v_sub_f32 v119, v174, v175
    v_add_f32 v123, v176, v177
    v_sub_f32 v127, v176, v177
    v_fma_f32 v174, v113, v194, v112
    v_fma_f32 v175, v114, v194, v115
    v_add_f32 v178, v114, v113
    v_add_f32 v182, v174, v175
    v_sub_f32 v183, v174, v175
    v_mov_b32 v132, v182
    v_fma_f32 v174, v117, v194, v116
    v_fma_f32 v175, v118, v194, v119
    v_add_f32 v179, v118, v117
    v_add_f32 v184, v174, v175
    v_sub_f32 v185, v174, v175
    v_mov_b32 v133, v184
    v_fma_f32 v174, v121, -v194, v120
    v_fma_f32 v175, v122, -v194, v123
    v_sub_f32 v180, v122, v121
    v_add_f32 v186, v174, v175
    v_sub_f32 v187, v174, v175
    v_fma_f32 v174, v125, -v194, v124
    v_fma_f32 v175, v126, -v194, v127
    v_sub_f32 v181, v126, v125
    v_add_f32 v188, v174, v175
    v_sub_f32 v189, v174, v175
    v_cvt_pk_bf16_f32 v190, v178, v179
    v_cvt_pk_bf16_f32 v191, v180, v181
    s_lshl_b32 s24, s7, 1
    s_add_u32 s25, s24, 0x1410000
    buffer_store_short v190, v195, s[16:19], s25 offen sc1
    s_add_u32 s25, s24, 0x1414000
    buffer_store_short_d16_hi v190, v195, s[16:19], s25 offen sc1
    s_add_u32 s25, s24, 0x1418000
    buffer_store_short v191, v195, s[16:19], s25 offen sc1
    s_add_u32 s25, s24, 0x141c000
    buffer_store_short_d16_hi v191, v195, s[16:19], s25 offen sc1
    s_barrier
    v_fma_f32 v174, v49, s42, v33
    v_fma_f32 v175, v65, s42, v81
    v_fma_f32 v176, v49, -s42, v33
    v_fma_f32 v177, v65, -s42, v81
    v_add_f32 v112, v174, v175
    v_sub_f32 v116, v174, v175
    v_add_f32 v120, v176, v177
    v_sub_f32 v124, v176, v177
    v_fma_f32 v174, v55, s42, v39
    v_fma_f32 v175, v71, s42, v87
    v_fma_f32 v176, v55, -s42, v39
    v_fma_f32 v177, v71, -s42, v87
    v_add_f32 v113, v174, v175
    v_sub_f32 v117, v174, v175
    v_add_f32 v121, v176, v177
    v_sub_f32 v125, v176, v177
    v_fma_f32 v174, v59, s42, v43
    v_fma_f32 v175, v75, s42, v91
    v_fma_f32 v176, v59, -s42, v43
    v_fma_f32 v177, v75, -s42, v91
    v_add_f32 v114, v174, v175
    v_sub_f32 v118, v174, v175
    v_add_f32 v122, v176, v177
    v_sub_f32 v126, v176, v177
    v_fma_f32 v174, v61, s42, v45
    v_fma_f32 v175, v77, s42, v93
    v_fma_f32 v176, v61, -s42, v45
    v_fma_f32 v177, v77, -s42, v93
    v_add_f32 v115, v174, v175
    v_sub_f32 v119, v174, v175
    v_add_f32 v123, v176, v177
    v_sub_f32 v127, v176, v177
    v_add_f32 v174, v112, v113
    v_add_f32 v175, v115, v114
    v_add_f32 v176, v174, v175
    v_sub_f32 v177, v174, v175
    v_sub_f32 v132, v132, v176
    v_cvt_pk_bf16_f32 v240, v182, v176
    v_cvt_pk_bf16_f32 v242, v183, v177
    v_add_f32 v174, v116, v117
    v_add_f32 v175, v119, v118
    v_add_f32 v176, v174, v175
    v_sub_f32 v177, v174, v175
    v_sub_f32 v133, v133, v176
    v_cvt_pk_bf16_f32 v244, v184, v176
    v_cvt_pk_bf16_f32 v246, v185, v177
    v_sub_f32 v174, v120, v121
    v_sub_f32 v175, v123, v122
    v_add_f32 v176, v174, v175
    v_sub_f32 v177, v174, v175
    v_cvt_pk_bf16_f32 v248, v186, v176
    v_cvt_pk_bf16_f32 v250, v187, v177
    v_sub_f32 v174, v124, v125
    v_sub_f32 v175, v127, v126
    v_add_f32 v176, v174, v175
    v_sub_f32 v177, v174, v175
    v_cvt_pk_bf16_f32 v252, v188, v176
    v_cvt_pk_bf16_f32 v254, v189, v177
    v_fma_f32 v174, v50, s42, v34
    v_fma_f32 v175, v66, s42, v82
    v_fma_f32 v176, v50, -s42, v34
    v_fma_f32 v177, v66, -s42, v82
    v_add_f32 v112, v174, v175
    v_sub_f32 v116, v174, v175
    v_add_f32 v120, v176, v177
    v_sub_f32 v124, v176, v177
    v_fma_f32 v174, v54, s42, v38
    v_fma_f32 v175, v70, s42, v86
    v_fma_f32 v176, v54, -s42, v38
    v_fma_f32 v177, v70, -s42, v86
    v_add_f32 v113, v174, v175
    v_sub_f32 v117, v174, v175
    v_add_f32 v121, v176, v177
    v_sub_f32 v125, v176, v177
    v_fma_f32 v174, v58, s42, v42
    v_fma_f32 v175, v74, s42, v90
    v_fma_f32 v176, v58, -s42, v42
    v_fma_f32 v177, v74, -s42, v90
    v_add_f32 v114, v174, v175
    v_sub_f32 v118, v174, v175
    v_add_f32 v122, v176, v177
    v_sub_f32 v126, v176, v177
    v_fma_f32 v174, v62, s42, v46
    v_fma_f32 v175, v78, s42, v94
    v_fma_f32 v176, v62, -s42, v46
    v_fma_f32 v177, v78, -s42, v94
    v_add_f32 v115, v174, v175
    v_sub_f32 v119, v174, v175
    v_add_f32 v123, v176, v177
    v_sub_f32 v127, v176, v177
    v_add_f32 v174, v112, v113
    v_add_f32 v175, v115, v114
    v_add_f32 v182, v174, v175
    v_sub_f32 v183, v174, v175
    v_add_f32 v132, v132, v182
    v_add_f32 v174, v116, v117
    v_add_f32 v175, v119, v118
    v_add_f32 v184, v174, v175
    v_sub_f32 v185, v174, v175
    v_add_f32 v133, v133, v184
    v_sub_f32 v174, v120, v121
    v_sub_f32 v175, v123, v122
    v_add_f32 v186, v174, v175
    v_sub_f32 v187, v174, v175
    v_sub_f32 v174, v124, v125
    v_sub_f32 v175, v127, v126
    v_add_f32 v188, v174, v175
    v_sub_f32 v189, v174, v175
    s_barrier
    v_fma_f32 v174, v51, s42, v35
    v_fma_f32 v175, v67, s42, v83
    v_fma_f32 v176, v51, -s42, v35
    v_fma_f32 v177, v67, -s42, v83
    v_add_f32 v112, v174, v175
    v_sub_f32 v116, v174, v175
    v_add_f32 v120, v176, v177
    v_sub_f32 v124, v176, v177
    v_fma_f32 v174, v53, s42, v37
    v_fma_f32 v175, v69, s42, v85
    v_fma_f32 v176, v53, -s42, v37
    v_fma_f32 v177, v69, -s42, v85
    v_add_f32 v113, v174, v175
    v_sub_f32 v117, v174, v175
    v_add_f32 v121, v176, v177
    v_sub_f32 v125, v176, v177
    v_fma_f32 v174, v57, s42, v41
    v_fma_f32 v175, v73, s42, v89
    v_fma_f32 v176, v57, -s42, v41
    v_fma_f32 v177, v73, -s42, v89
    v_add_f32 v114, v174, v175
    v_sub_f32 v118, v174, v175
    v_add_f32 v122, v176, v177
    v_sub_f32 v126, v176, v177
    v_fma_f32 v174, v63, s42, v47
    v_fma_f32 v175, v79, s42, v95
    v_fma_f32 v176, v63, -s42, v47
    v_fma_f32 v177, v79, -s42, v95
    v_add_f32 v115, v174, v175
    v_sub_f32 v119, v174, v175
    v_add_f32 v123, v176, v177
    v_sub_f32 v127, v176, v177
    v_add_f32 v174, v112, v113
    v_add_f32 v175, v115, v114
    v_add_f32 v176, v174, v175
    v_sub_f32 v177, v174, v175
    v_sub_f32 v132, v132, v176
    v_cvt_pk_bf16_f32 v241, v182, v176
    v_cvt_pk_bf16_f32 v243, v183, v177
    s_lshl_b32 s24, s7, 10
    s_add_u32 s25, s24, 0xc00000
    buffer_store_dwordx4 v[240:243], v2, s[16:19], s25 offen sc1
    v_add_f32 v174, v116, v117
    v_add_f32 v175, v119, v118
    v_add_f32 v176, v174, v175
    v_sub_f32 v177, v174, v175
    v_sub_f32 v133, v133, v176
    v_cvt_pk_bf16_f32 v245, v184, v176
    v_cvt_pk_bf16_f32 v247, v185, v177
    s_add_u32 s25, s24, 0xc84000
    buffer_store_dwordx4 v[244:247], v2, s[16:19], s25 offen sc1
    v_sub_f32 v174, v120, v121
    v_sub_f32 v175, v123, v122
    v_add_f32 v176, v174, v175
    v_sub_f32 v177, v174, v175
    v_cvt_pk_bf16_f32 v249, v186, v176
    v_cvt_pk_bf16_f32 v251, v187, v177
    s_add_u32 s25, s24, 0xd08000
    buffer_store_dwordx4 v[248:251], v2, s[16:19], s25 offen sc1
    v_sub_f32 v174, v124, v125
    v_sub_f32 v175, v127, v126
    v_add_f32 v176, v174, v175
    v_sub_f32 v177, v174, v175
    v_cvt_pk_bf16_f32 v253, v188, v176
    v_cvt_pk_bf16_f32 v255, v189, v177
    s_add_u32 s25, s24, 0xd8c000
    buffer_store_dwordx4 v[252:255], v2, s[16:19], s25 offen sc1
    v_add_f32_dpp v132, v132, v132 row_shr:1 row_mask:0xf bank_mask:0xf
    v_add_f32_dpp v133, v133, v133 row_shr:1 row_mask:0xf bank_mask:0xf
    s_nop 0
    v_add_f32_dpp v132, v132, v132 row_shr:2 row_mask:0xf bank_mask:0xf
    v_add_f32_dpp v133, v133, v133 row_shr:2 row_mask:0xf bank_mask:0xf
    s_nop 0
    v_add_f32_dpp v132, v132, v132 row_shr:4 row_mask:0xf bank_mask:0xf
    v_add_f32_dpp v133, v133, v133 row_shr:4 row_mask:0xf bank_mask:0xf
    s_nop 0
    v_add_f32_dpp v132, v132, v132 row_shr:8 row_mask:0xf bank_mask:0xf
    v_add_f32_dpp v133, v133, v133 row_shr:8 row_mask:0xf bank_mask:0xf
    s_nop 0
    v_add_f32_dpp v132, v132, v132 row_bcast:15 row_mask:0xa bank_mask:0xf
    v_add_f32_dpp v133, v133, v133 row_bcast:15 row_mask:0xa bank_mask:0xf
    s_nop 0
    v_add_f32_dpp v132, v132, v132 row_bcast:31 row_mask:0xc bank_mask:0xf
    v_add_f32_dpp v133, v133, v133 row_bcast:31 row_mask:0xc bank_mask:0xf
    v_cvt_pk_bf16_f32 v132, v132, v133
    s_lshl_b32 s24, s7, 1
    s_add_u32 s26, s24, 0x1412000
    buffer_store_short v132, v21, s[16:19], s26 offen sc1
    s_add_u32 s26, s24, 0x1416000
    buffer_store_short_d16_hi v132, v21, s[16:19], s26 offen sc1
    s_barrier
    s_and_b32 s24, s7, 511
    s_cbranch_scc1 L_p0done0
    s_mov_b32 s7, 512
    v_add_f32 v112, v48, v64
    v_add_f32 v116, v48, v64
    v_sub_f32 v120, v48, v64
    v_sub_f32 v124, v48, v64
    v_add_f32 v113, v52, v68
    v_add_f32 v117, v52, v68
    v_sub_f32 v121, v52, v68
    v_sub_f32 v125, v52, v68
    v_add_f32 v114, v56, v72
    v_add_f32 v118, v56, v72
    v_sub_f32 v122, v56, v72
    v_sub_f32 v126, v56, v72
    v_add_f32 v115, v60, v76
    v_add_f32 v119, v60, v76
    v_sub_f32 v123, v60, v76
    v_sub_f32 v127, v60, v76
    v_fma_f32 v174, v113, v194, v112
    v_fma_f32 v175, v114, v194, v115
    v_add_f32 v178, v114, v113
    v_add_f32 v182, v174, v175
    v_sub_f32 v183, v174, v175
    v_mov_b32 v132, v182
    v_fma_f32 v174, v117, v194, v116
    v_fma_f32 v175, v118, v194, v119
    v_add_f32 v179, v118, v117
    v_add_f32 v184, v174, v175
    v_sub_f32 v185, v174, v175
    v_mov_b32 v133, v184
    v_fma_f32 v174, v121, -v194, v120
    v_fma_f32 v175, v122, -v194, v123
    v_sub_f32 v180, v122, v121
    v_add_f32 v186, v174, v175
    v_sub_f32 v187, v174, v175
    v_fma_f32 v174, v125, -v194, v124
    v_fma_f32 v175, v126, -v194, v127
    v_sub_f32 v181, v126, v125
    v_add_f32 v188, v174, v175
    v_sub_f32 v189, v174, v175
    v_cvt_pk_bf16_f32 v190, v178, v179
    v_cvt_pk_bf16_f32 v191, v180, v181
    s_lshl_b32 s24, s7, 1
    s_add_u32 s25, s24, 0x1410000
    buffer_store_short v190, v195, s[16:19], s25 offen sc1
    s_add_u32 s25, s24, 0x1414000
    buffer_store_short_d16_hi v190, v195, s[16:19], s25 offen sc1
    s_add_u32 s25, s24, 0x1418000
    buffer_store_short v191, v195, s[16:19], s25 offen sc1
    s_add_u32 s25, s24, 0x141c000
    buffer_store_short_d16_hi v191, v195, s[16:19], s25 offen sc1
    v_add_f32 v112, v49, v65
    v_add_f32 v116, v49, v65
    v_sub_f32 v120, v49, v65
    v_sub_f32 v124, v49, v65
    v_add_f32 v113, v55, v71
    v_add_f32 v117, v55, v71
    v_sub_f32 v121, v55, v71
    v_sub_f32 v125, v55, v71
    v_add_f32 v114, v59, v75
    v_add_f32 v118, v59, v75
    v_sub_f32 v122, v59, v75
    v_sub_f32 v126, v59, v75
    v_add_f32 v115, v61, v77
    v_add_f32 v119, v61, v77
    v_sub_f32 v123, v61, v77
    v_sub_f32 v127, v61, v77
    v_add_f32 v174, v112, v113
    v_add_f32 v175, v115, v114
    v_add_f32 v176, v174, v175
    v_sub_f32 v177, v174, v175
    v_sub_f32 v132, v132, v176
    v_cvt_pk_bf16_f32 v240, v182, v176
    v_cvt_pk_bf16_f32 v242, v183, v177
    v_add_f32 v174, v116, v117
    v_add_f32 v175, v119, v118
    v_add_f32 v176, v174, v175
    v_sub_f32 v177, v174, v175
    v_sub_f32 v133, v133, v176
    v_cvt_pk_bf16_f32 v244, v184, v176
    v_cvt_pk_bf16_f32 v246, v185, v177
    v_sub_f32 v174, v120, v121
    v_sub_f32 v175, v123, v122
    v_add_f32 v176, v174, v175
    v_sub_f32 v177, v174, v175
    v_cvt_pk_bf16_f32 v248, v186, v176
    v_cvt_pk_bf16_f32 v250, v187, v177
    v_sub_f32 v174, v124, v125
    v_sub_f32 v175, v127, v126
    v_add_f32 v176, v174, v175
    v_sub_f32 v177, v174, v175
    v_cvt_pk_bf16_f32 v252, v188, v176
    v_cvt_pk_bf16_f32 v254, v189, v177
L_p0done0:
    s_mov_b32 s39, 0
    s_waitcnt vmcnt(14)
L_tagspin:
    v_readfirstlane_b32 s6, v14
    s_cmp_lg_u32 s6, 0
    s_cbranch_scc1 L_tagok
    buffer_load_dword v14, v15, s[20:23], 0 offen sc1
    s_waitcnt vmcnt(0)
    s_add_u32 s39, s39, 1
    s_cmp_lt_u32 s39, 0x40000
    s_cbranch_scc1 L_tagspin
L_tagok:
    s_barrier
    s_and_b32 s24, s7, 511
    s_cbranch_scc1 L_p0done1
    s_mov_b32 s7, 512
    v_add_f32 v112, v50, v66
    v_add_f32 v116, v50, v66
    v_sub_f32 v120, v50, v66
    v_sub_f32 v124, v50, v66
    v_add_f32 v113, v54, v70
    v_add_f32 v117, v54, v70
    v_sub_f32 v121, v54, v70
    v_sub_f32 v125, v54, v70
    v_add_f32 v114, v58, v74
    v_add_f32 v118, v58, v74
    v_sub_f32 v122, v58, v74
    v_sub_f32 v126, v58, v74
    v_add_f32 v115, v62, v78
    v_add_f32 v119, v62, v78
    v_sub_f32 v123, v62, v78
    v_sub_f32 v127, v62, v78
    v_add_f32 v174, v112, v113
    v_add_f32 v175, v115, v114
    v_add_f32 v182, v174, v175
    v_sub_f32 v183, v174, v175
    v_add_f32 v132, v132, v182
    v_add_f32 v174, v116, v117
    v_add_f32 v175, v119, v118
    v_add_f32 v184, v174, v175
    v_sub_f32 v185, v174, v175
    v_add_f32 v133, v133, v184
    v_sub_f32 v174, v120, v121
    v_sub_f32 v175, v123, v122
    v_add_f32 v186, v174, v175
    v_sub_f32 v187, v174, v175
    v_sub_f32 v174, v124, v125
    v_sub_f32 v175, v127, v126
    v_add_f32 v188, v174, v175
    v_sub_f32 v189, v174, v175
    v_add_f32 v112, v51, v67
    v_add_f32 v116, v51, v67
    v_sub_f32 v120, v51, v67
    v_sub_f32 v124, v51, v67
    v_add_f32 v113, v53, v69
    v_add_f32 v117, v53, v69
    v_sub_f32 v121, v53, v69
    v_sub_f32 v125, v53, v69
    v_add_f32 v114, v57, v73
    v_add_f32 v118, v57, v73
    v_sub_f32 v122, v57, v73
    v_sub_f32 v126, v57, v73
    v_add_f32 v115, v63, v79
    v_add_f32 v119, v63, v79
    v_sub_f32 v123, v63, v79
    v_sub_f32 v127, v63, v79
    v_add_f32 v174, v112, v113
    v_add_f32 v175, v115, v114
    v_add_f32 v176, v174, v175
    v_sub_f32 v177, v174, v175
    v_sub_f32 v132, v132, v176
    v_cvt_pk_bf16_f32 v241, v182, v176
    v_cvt_pk_bf16_f32 v243, v183, v177
    s_lshl_b32 s24, s7, 10
    s_add_u32 s25, s24, 0xc00000
    buffer_store_dwordx4 v[240:243], v2, s[16:19], s25 offen sc1
    v_add_f32 v174, v116, v117
    v_add_f32 v175, v119, v118
    v_add_f32 v176, v174, v175
    v_sub_f32 v177, v174, v175
    v_sub_f32 v133, v133, v176
    v_cvt_pk_bf16_f32 v245, v184, v176
    v_cvt_pk_bf16_f32 v247, v185, v177
    s_add_u32 s25, s24, 0xc84000
    buffer_store_dwordx4 v[244:247], v2, s[16:19], s25 offen sc1
    v_sub_f32 v174, v120, v121
    v_sub_f32 v175, v123, v122
    v_add_f32 v176, v174, v175
    v_sub_f32 v177, v174, v175
    v_cvt_pk_bf16_f32 v249, v186, v176
    v_cvt_pk_bf16_f32 v251, v187, v177
    s_add_u32 s25, s24, 0xd08000
    buffer_store_dwordx4 v[248:251], v2, s[16:19], s25 offen sc1
    v_sub_f32 v174, v124, v125
    v_sub_f32 v175, v127, v126
    v_add_f32 v176, v174, v175
    v_sub_f32 v177, v174, v175
    v_cvt_pk_bf16_f32 v253, v188, v176
    v_cvt_pk_bf16_f32 v255, v189, v177
    s_add_u32 s25, s24, 0xd8c000
    buffer_store_dwordx4 v[252:255], v2, s[16:19], s25 offen sc1
    v_add_f32_dpp v132, v132, v132 row_shr:1 row_mask:0xf bank_mask:0xf
    v_add_f32_dpp v133, v133, v133 row_shr:1 row_mask:0xf bank_mask:0xf
    s_nop 0
    v_add_f32_dpp v132, v132, v132 row_shr:2 row_mask:0xf bank_mask:0xf
    v_add_f32_dpp v133, v133, v133 row_shr:2 row_mask:0xf bank_mask:0xf
    s_nop 0
    v_add_f32_dpp v132, v132, v132 row_shr:4 row_mask:0xf bank_mask:0xf
    v_add_f32_dpp v133, v133, v133 row_shr:4 row_mask:0xf bank_mask:0xf
    s_nop 0
    v_add_f32_dpp v132, v132, v132 row_shr:8 row_mask:0xf bank_mask:0xf
    v_add_f32_dpp v133, v133, v133 row_shr:8 row_mask:0xf bank_mask:0xf
    s_nop 0
    v_add_f32_dpp v132, v132, v132 row_bcast:15 row_mask:0xa bank_mask:0xf
    v_add_f32_dpp v133, v133, v133 row_bcast:15 row_mask:0xa bank_mask:0xf
    s_nop 0
    v_add_f32_dpp v132, v132, v132 row_bcast:31 row_mask:0xc bank_mask:0xf
    v_add_f32_dpp v133, v133, v133 row_bcast:31 row_mask:0xc bank_mask:0xf
    v_cvt_pk_bf16_f32 v132, v132, v133
    s_lshl_b32 s24, s7, 1
    s_add_u32 s26, s24, 0x1412000
    buffer_store_short v132, v21, s[16:19], s26 offen sc1
    s_add_u32 s26, s24, 0x1416000
    buffer_store_short_d16_hi v132, v21, s[16:19], s26 offen sc1
L_p0done1:
    s_waitcnt vmcnt(0)
    s_barrier
    s_cmp_lg_u32 s3, 6
    s_cbranch_scc1 L_f0
    s_and_b32 s24, s2, 7
    s_lshl_b32 s24, s24, 7
    s_lshr_b32 s25, s2, 3
    s_lshl2_add_u32 s24, s25, s24
    s_add_u32 s24, s24, 0x1508000
    v_mov_b32 v18, s6
    buffer_store_dword v18, v21, s[16:19], s24 offen sc1
L_f0:
    s_barrier
    s_barrier
    s_barrier
    s_barrier
    s_barrier
    s_barrier
    s_barrier
    v_mov_b32 v14, s6
    v_and_b32 v15, 7, v1
    v_mul_u32_u24 v15, 12288, v15
    v_add_u32 v15, 65536, v15
    ds_write_b32 v15, v14 offset:6144
    s_add_u32 s26, s70, 0
    buffer_load_dword v208, v202, s[48:51], s26 offen
    buffer_load_dword v212, v202, s[48:51], s26 offen offset:2048
    s_add_u32 s26, s70, 4096
    buffer_load_dword v209, v202, s[48:51], s26 offen
    buffer_load_dword v213, v202, s[48:51], s26 offen offset:2048
    s_add_u32 s26, s70, 16384
    buffer_load_dword v210, v202, s[48:51], s26 offen
    buffer_load_dword v214, v202, s[48:51], s26 offen offset:2048
    s_add_u32 s26, s70, 20480
    buffer_load_dword v211, v202, s[48:51], s26 offen
    buffer_load_dword v215, v202, s[48:51], s26 offen offset:2048
    s_add_u32 s26, s70, 0
    buffer_load_ushort v224, v204, s[48:51], s26 offen
    buffer_load_ushort v228, v204, s[48:51], s26 offen offset:2048
    s_add_u32 s26, s70, 4096
    buffer_load_ushort v225, v204, s[48:51], s26 offen
    buffer_load_ushort v229, v204, s[48:51], s26 offen offset:2048
    s_add_u32 s26, s70, 16384
    buffer_load_ushort v226, v204, s[48:51], s26 offen
    buffer_load_ushort v230, v204, s[48:51], s26 offen offset:2048
    s_add_u32 s26, s70, 20480
    buffer_load_ushort v227, v204, s[48:51], s26 offen
    buffer_load_ushort v231, v204, s[48:51], s26 offen offset:2048
    s_barrier
    s_add_u32 s26, s70, 0
    buffer_load_ushort v232, v205, s[48:51], s26 offen
    buffer_load_ushort v236, v205, s[48:51], s26 offen offset:2048
    s_add_u32 s26, s70, 4096
    buffer_load_ushort v233, v205, s[48:51], s26 offen
    buffer_load_ushort v237, v205, s[48:51], s26 offen offset:2048
    s_add_u32 s26, s70, 16384
    buffer_load_ushort v234, v205, s[48:51], s26 offen
    buffer_load_ushort v238, v205, s[48:51], s26 offen offset:2048
    s_add_u32 s26, s70, 20480
    buffer_load_ushort v235, v205, s[48:51], s26 offen
    buffer_load_ushort v239, v205, s[48:51], s26 offen offset:2048
    s_branch L_epi
L_fb:
    s_waitcnt vmcnt(0) lgkmcnt(0)
    s_lshl_b32 s24, s5, 18
    s_add_u32 s25, s24, 0x40000
    v_mov_b32 v14, 0xff800000
L_fb1:
    buffer_load_dwordx4 v[104:107], v2, s[16:19], s24 offen offset:0 sc1
    buffer_load_dwordx4 v[108:111], v2, s[16:19], s24 offen offset:1024 sc1
    s_waitcnt vmcnt(0)
    v_mfma_f32_32x32x16_bf16 v[32:47], v[104:107], v[96:99], 0
    v_mfma_f32_32x32x16_bf16 v[32:47], v[108:111], v[100:103], v[32:47]
    s_nop 11
    v_max3_f32 v14, v14, v32, v33
    v_max3_f32 v14, v14, v34, v35
    v_max3_f32 v14, v14, v36, v37
    v_max3_f32 v14, v14, v38, v39
    v_max3_f32 v14, v14, v40, v41
    v_max3_f32 v14, v14, v42, v43
    v_max3_f32 v14, v14, v44, v45
    v_max3_f32 v14, v14, v46, v47
    s_add_u32 s24, s24, 4096
    s_cmp_lt_u32 s24, s25
    s_cbranch_scc1 L_fb1
    v_mov_b32 v15, v14
    s_nop 1
    v_permlane32_swap_b32 v14, v15
    v_max_f32 v14, v14, v15
    v_sub_f32 v80, 0, v14
    v_sub_f32 v81, 0, v14
    v_sub_f32 v82, 0, v14
    v_sub_f32 v83, 0, v14
    v_sub_f32 v84, 0, v14
    v_sub_f32 v85, 0, v14
    v_sub_f32 v86, 0, v14
    v_sub_f32 v87, 0, v14
    v_sub_f32 v88, 0, v14
    v_sub_f32 v89, 0, v14
    v_sub_f32 v90, 0, v14
    v_sub_f32 v91, 0, v14
    v_sub_f32 v92, 0, v14
    v_sub_f32 v93, 0, v14
    v_sub_f32 v94, 0, v14
    v_sub_f32 v95, 0, v14
    v_mov_b32 v64, 0
    v_mov_b32 v65, 0
    v_mov_b32 v66, 0
    v_mov_b32 v67, 0
    v_mov_b32 v68, 0
    v_mov_b32 v69, 0
    v_mov_b32 v70, 0
    v_mov_b32 v71, 0
    v_mov_b32 v72, 0
    v_mov_b32 v73, 0
    v_mov_b32 v74, 0
    v_mov_b32 v75, 0
    v_mov_b32 v76, 0
    v_mov_b32 v77, 0
    v_mov_b32 v78, 0
    v_mov_b32 v79, 0
    v_mov_b32 v128, 0
    v_mov_b32 v129, 0
    v_mov_b32 v130, 0
    v_mov_b32 v131, 0
    s_lshl_b32 s24, s5, 18
L_fb2:
    buffer_load_dwordx4 v[104:107], v2, s[16:19], s24 offen offset:0 sc1
    buffer_load_dwordx4 v[108:111], v2, s[16:19], s24 offen offset:1024 sc1
    buffer_load_dwordx4 v[112:115], v2, s[16:19], s24 offen offset:2048 sc1
    buffer_load_dwordx4 v[116:119], v2, s[16:19], s24 offen offset:3072 sc1
    s_waitcnt vmcnt(0)
    v_mfma_f32_32x32x16_bf16 v[32:47], v[104:107], v[96:99], v[80:95]
    v_mfma_f32_32x32x16_bf16 v[32:47], v[108:111], v[100:103], v[32:47]
    s_nop 11
    v_exp_f32 v32, v32
    v_exp_f32 v33, v33
    v_exp_f32 v34, v34
    v_exp_f32 v35, v35
    v_exp_f32 v36, v36
    v_exp_f32 v37, v37
    v_exp_f32 v38, v38
    v_exp_f32 v39, v39
    v_exp_f32 v40, v40
    v_exp_f32 v41, v41
    v_exp_f32 v42, v42
    v_exp_f32 v43, v43
    v_exp_f32 v44, v44
    v_exp_f32 v45, v45
    v_exp_f32 v46, v46
    v_exp_f32 v47, v47
    v_cvt_pk_bf16_f32 v120, v32, v33
    v_cvt_pk_bf16_f32 v121, v34, v35
    v_cvt_pk_bf16_f32 v122, v36, v37
    v_cvt_pk_bf16_f32 v123, v38, v39
    v_cvt_pk_bf16_f32 v124, v40, v41
    v_cvt_pk_bf16_f32 v125, v42, v43
    v_cvt_pk_bf16_f32 v126, v44, v45
    v_cvt_pk_bf16_f32 v127, v46, v47
    v_mfma_f32_32x32x16_bf16 v[64:79], v[112:115], v[120:123], v[64:79]
    v_mfma_f32_16x16x32_bf16 v[128:131], v[132:135], v[120:123], v[128:131]
    v_mfma_f32_32x32x16_bf16 v[64:79], v[116:119], v[124:127], v[64:79]
    v_mfma_f32_16x16x32_bf16 v[128:131], v[132:135], v[124:127], v[128:131]
    s_add_u32 s24, s24, 4096
    s_cmp_lt_u32 s24, s25
    s_nop 15
    s_cbranch_scc1 L_fb2
    v_rcp_f32 v14, v128
    s_nop 0
    v_mul_f32 v64, v14, v64
    v_mul_f32 v65, v14, v65
    v_mul_f32 v66, v14, v66
    v_mul_f32 v67, v14, v67
    v_mul_f32 v68, v14, v68
    v_mul_f32 v69, v14, v69
    v_mul_f32 v70, v14, v70
    v_mul_f32 v71, v14, v71
    v_mul_f32 v72, v14, v72
    v_mul_f32 v73, v14, v73
    v_mul_f32 v74, v14, v74
    v_mul_f32 v75, v14, v75
    v_mul_f32 v76, v14, v76
    v_mul_f32 v77, v14, v77
    v_mul_f32 v78, v14, v78
    v_mul_f32 v79, v14, v79
    v_cvt_pk_bf16_f32 v120, v64, v65
    v_cvt_pk_bf16_f32 v121, v66, v67
    v_cvt_pk_bf16_f32 v122, v68, v69
    v_cvt_pk_bf16_f32 v123, v70, v71
    v_cvt_pk_bf16_f32 v124, v72, v73
    v_cvt_pk_bf16_f32 v125, v74, v75
    v_cvt_pk_bf16_f32 v126, v76, v77
    v_cvt_pk_bf16_f32 v127, v78, v79
    buffer_store_dwordx4 v[120:123], v2, s[16:19], s36 offen offset:0 sc1
    buffer_store_dwordx4 v[124:127], v2, s[16:19], s36 offen offset:1024 sc1
    s_branch L_fbret
.section .rodata,"a"
.p2align 6
.amdhsa_kernel gated_mix__spectral_fnet__mha_block__prompt_kernel
  .amdhsa_next_free_vgpr 256
  .amdhsa_next_free_sgpr 102
  .amdhsa_accum_offset 256
  .amdhsa_group_segment_fixed_size 0
  .amdhsa_kernarg_size 96
  .amdhsa_user_sgpr_count 2
  .amdhsa_user_sgpr_kernarg_segment_ptr 1
  .amdhsa_system_sgpr_workgroup_id_x 1
.end_amdhsa_kernel
```
